```python
import torch

def _softmax(x, axis=-1):
    return torch.softmax(x, dim=axis)
def _gelu(x):
    return torch.nn.functional.gelu(x, approximate="tanh")
def _silu(x):
    return torch.nn.functional.silu(x)
def _sigmoid(x):
    return torch.sigmoid(x)
def _layernorm(x, axis=-1, eps=1e-5):
    m = x.mean(dim=axis, keepdim=True)
    v = x.var(dim=axis, keepdim=True, unbiased=False)
    return (x - m) / torch.sqrt(v + eps)
def _scatter_add(tgt, idx, src, axis=0):
    return tgt.clone().index_add_(axis, idx, src)
def _segment_sum(src, seg, n):
    out = torch.zeros((n,) + src.shape[1:], dtype=src.dtype)
    return out.index_add_(0, seg, src)
def _pad(x, pw):
    flat = tuple(v for pair in reversed(pw) for v in pair)
    return torch.nn.functional.pad(x, flat)

kernel_name = 'interleave_layers__sliding_block__mixer_channel_mlp__prompt'

def setup_inputs():

    _w = (lambda a: (lambda t: t.to(torch.bfloat16) if t.is_floating_point() else t)(torch.as_tensor(a)))
    def _A_setup():
        B, S, D = 1, 2048, 512
        return {
            "x": _w((lambda *s: torch.randn(*s, dtype=torch.bfloat16) * 0.05)(B, S, D)),
            "wqkv": _w((lambda *s: torch.randn(*s, dtype=torch.bfloat16) * 0.05)(D, 3 * D)),
            "wo": _w((lambda *s: torch.randn(*s, dtype=torch.bfloat16) * 0.05)(D, D)),
        }
    _A_in = _A_setup()

    def _B_setup():
        B, S, D, F = 1, 2048, 512, 1792
        return {
            "x": _w((lambda *s: torch.randn(*s, dtype=torch.bfloat16) * 0.05)(B, S, D)),
            "w1": _w((lambda *s: torch.randn(*s, dtype=torch.bfloat16) * 3.2)(D, F) * (D ** -0.5)),
            "b1": _w((lambda *s: torch.randn(*s, dtype=torch.bfloat16) * 0.8)(F)),
            "w2": _w((lambda *s: torch.randn(*s, dtype=torch.bfloat16) * 0.2)(F, D) * (F ** -0.5)),
            "b2": _w((lambda *s: torch.randn(*s, dtype=torch.bfloat16) * 0.2)(D)),
        }
    _B_in = _B_setup()

    return {
        "A_x": _A_in["x"],
        "A_wqkv": _A_in["wqkv"],
        "A_wo": _A_in["wo"],
        "B_x": _B_in["x"],
        "B_w1": _B_in["w1"],
        "B_b1": _B_in["b1"],
        "B_w2": _B_in["w2"],
        "B_b2": _B_in["b2"],
    }

def reference(A_x, A_wqkv, A_wo, B_x, B_w1, B_b1, B_w2, B_b2):
    def _A_ref(x, wqkv, wo):
        B, S, D = x.shape
        H = 32; Dh = D // H; W = 256
        qkv = (lambda x, *d: x.permute(*d))((x @ wqkv).reshape(B, S, 3, H, Dh), 2, 0, 3, 1, 4)
        q, k, v = qkv[0], qkv[1], qkv[2]
        scores = torch.einsum("bhqd,bhkd->bhqk", q, k) * (Dh ** -0.5)
        idx = torch.arange(S)
        mask = (idx[:, None] - idx[None, :] >= 0) & (idx[:, None] - idx[None, :] < W)
        scores = torch.where(mask[None, None], scores, -1e9)
        p = _softmax(scores, axis=-1)
        o = torch.einsum("bhqk,bhkd->bhqd", p, v)
        return (lambda x, *d: x.permute(*d))(o, 0, 2, 1, 3).reshape(B, S, D) @ wo

    def _B_ref(x, w1, b1, w2, b2):
        y = _layernorm(x, axis=-1)
        h = _gelu(torch.einsum("bsd,df->bsf", y, w1) + b1)
        return torch.einsum("bsf,fd->bsd", h, w2) + b2

    x = A_x
    x = x + _A_ref(_layernorm(x, axis=-1), A_wqkv, A_wo)
    x = x + _B_ref(_layernorm(x, axis=-1), B_w1, B_b1, B_w2, B_b2)
    x = x + _A_ref(_layernorm(x, axis=-1), A_wqkv, A_wo)
    x = x + _B_ref(_layernorm(x, axis=-1), B_w1, B_b1, B_w2, B_b2)
    return x
```

```asm
; @launch grid=(256,1,1) block=(256,1,1) lds=163840
.amdgcn_target "amdgcn-amd-amdhsa--gfx950"
.text
.globl interleave_layers__sliding_block__mixer_channel_mlp__prompt_kernel
.p2align 8
.type interleave_layers__sliding_block__mixer_channel_mlp__prompt_kernel,@function
interleave_layers__sliding_block__mixer_channel_mlp__prompt_kernel:
  s_cmp_ge_u32 s2, 256
  s_cbranch_scc1 L_end
  s_load_dwordx16 s[64:79], s[0:1], 0
  s_load_dwordx4 s[80:83], s[0:1], 64
  s_load_dwordx2 s[84:85], s[0:1], 80
  s_getpc_b64 s[86:87]
L_pc:
  v_lshrrev_b32 v16, 3, v0
  s_lshr_b32 s88, s2, 3
  v_lshl_add_u32 v16, v16, 5, s88
  v_lshlrev_b32 v16, 7, v16
  v_min_u32 v16, L_ce-L_pc, v16
  global_load_dword a235, v16, s[86:87]
  v_lshrrev_b32 v13, 6, v0
  v_and_b32 v0, 63, v0
  v_readfirstlane_b32 s6, v13
  s_and_b32 s3, s2, 7
  s_lshl_b32 s4, s3, 1
  s_bfe_u32 s3, s2, 0x10003
  s_or_b32 s4, s4, s3
  s_lshr_b32 s5, s2, 4
  v_lshlrev_b32 v1, 4, v0
  s_lshl_b32 s48, s4, 2
  s_add_u32 s48, s48, s6
  v_lshrrev_b32 v13, 3, v0
  v_xor_b32 v15, v13, v0
  v_and_b32 v15, 7, v15
  v_lshlrev_b32 v15, 4, v15
  v_lshl_add_u32 v112, v13, 10, v15
  v_xor_b32 v113, 16, v112
  v_lshrrev_b32 v14, 5, v0
  v_lshrrev_b32 v10, 2, v0
  v_mul_u32_u24 v10, 3072, v10
  v_and_b32 v13, 0x30, v1
  v_add_u32 v10, v10, v13
  s_lshl_b32 s59, s3, 1
  s_and_b32 s54, s5, 1
  s_or_b32 s59, s59, s54
  s_bfe_u32 s54, s5, 0x20001
  s_xor_b32 s59, s59, s54
  s_lshl_b32 s59, s59, 1
  s_lshr_b32 s54, s5, 3
  s_or_b32 s59, s59, s54
  s_lshl_b32 s57, s48, 15
  s_mul_i32 s58, s6, 49152
  s_lshl_b32 s62, s5, 6
  s_add_u32 s58, s58, s62
  s_lshl_b32 s62, s6, 10
  s_lshl_b32 s63, s6, 14
  v_accvgpr_write_b32 a236, -1
  v_accvgpr_write_b32 a237, -1
  v_accvgpr_write_b32 a238, -1
  v_accvgpr_write_b32 a239, -1
  s_lshl_b32 s98, s48, 4
  s_add_u32 s98, s98, s5
  s_lshl_b32 s98, s98, 12
  s_add_u32 s98, s98, 1048576
  v_mov_b32 v20, 0
  s_lshl_b32 s96, s4, 4
  s_add_u32 s96, s96, s5
  s_lshl_b32 s53, s96, 7
  s_add_u32 s53, s53, 139264
  s_lshl_b32 s96, s96, 2
  s_add_u32 s52, s96, s6
  s_lshl_b32 s55, s4, 9
  s_lshl_b32 s96, s5, 2
  s_add_u32 s55, s55, s96
  s_add_u32 s55, s55, 196608
  v_lshrrev_b32 v21, 4, v0
  v_and_b32 v7, 15, v0
  v_lshlrev_b32 v7, 2, v7
  v_lshl_add_u32 v22, v21, 7, v7
  s_or_b32 s56, s5, s6
  s_waitcnt lgkmcnt(0)
  s_mov_b64 s[28:29], s[84:85]
  s_mov_b32 s30, 67108864
  s_mov_b32 s31, 0x00020000
  s_mov_b64 s[8:9], s[64:65]
  s_mov_b32 s10, 2097152
  s_mov_b32 s11, 0x00020000
  s_mov_b64 s[12:13], s[66:67]
  s_mov_b32 s14, 1572864
  s_mov_b32 s15, 0x00020000
  s_cmp_lg_u32 s56, 0
  s_cbranch_scc1 L1
  buffer_store_dword v20, v22, s[28:31], s55 offen sc1
L1:
  buffer_store_dword v20, off, s[28:31], s53 sc1
  buffer_store_dwordx4 a[236:239], v1, s[28:31], s98 offen offset:0 sc1
  s_lshr_b32 s1, s2, 3
  s_cmp_ge_u32 s5, 8
  s_cselect_b32 s96, 4, 0
  s_sub_u32 s1, s1, s96
  s_lshl_b32 s1, s1, 2
  s_add_u32 s1, s1, s6
  s_lshr_b32 s96, s5, 1
  s_cmp_eq_u32 s96, 3
  s_cselect_b32 s1, 0x10000, s1
  s_mul_i32 s96, s1, 14336
  v_min_u32 v23, 13, v0
  v_lshlrev_b32 v23, 10, v23
  buffer_load_dword a232, v23, s[12:15], s96 offen offset:384
  s_xor_b32 s61, s59, 0
  s_lshl_b32 s61, s61, 7
  s_add_u32 s61, s61, s57
  s_add_u32 m0, s63, 98304
  s_nop 0
  buffer_load_dwordx4 v112, s[8:11], s61 offen offset:0 lds
  s_add_u32 s61, s61, 7168
  buffer_load_dwordx4 v113, s[8:11], s61 offen offset:1024 lds
  s_add_u32 s61, s61, 7168
  buffer_load_dwordx4 v112, s[8:11], s61 offen offset:2048 lds
  s_add_u32 s61, s61, 7168
  buffer_load_dwordx4 v113, s[8:11], s61 offen offset:3072 lds
  s_xor_b32 s61, s59, 0
  s_mul_i32 s61, s61, 196608
  s_add_u32 s61, s61, s58
  s_add_u32 m0, s62, 0
  s_add_u32 s60, s61, 1024
  buffer_load_dwordx4 v10, s[12:15], s60 offen offset:0 lds
  s_add_u32 m0, s62, 32768
  s_add_u32 s60, s61, 2048
  buffer_load_dwordx4 v10, s[12:15], s60 offen offset:0 lds
  buffer_store_dwordx4 a[236:239], v1, s[28:31], s98 offen offset:1024 sc1
  s_xor_b32 s61, s59, 1
  s_lshl_b32 s61, s61, 7
  s_add_u32 s61, s61, s57
  s_add_u32 m0, s63, 102400
  s_nop 0
  buffer_load_dwordx4 v112, s[8:11], s61 offen offset:0 lds
  s_add_u32 s61, s61, 7168
  buffer_load_dwordx4 v113, s[8:11], s61 offen offset:1024 lds
  s_add_u32 s61, s61, 7168
  buffer_load_dwordx4 v112, s[8:11], s61 offen offset:2048 lds
  s_add_u32 s61, s61, 7168
  buffer_load_dwordx4 v113, s[8:11], s61 offen offset:3072 lds
  s_xor_b32 s61, s59, 1
  s_mul_i32 s61, s61, 196608
  s_add_u32 s61, s61, s58
  s_add_u32 m0, s62, 4096
  s_add_u32 s60, s61, 1024
  buffer_load_dwordx4 v10, s[12:15], s60 offen offset:0 lds
  s_add_u32 m0, s62, 36864
  s_add_u32 s60, s61, 2048
  buffer_load_dwordx4 v10, s[12:15], s60 offen offset:0 lds
  s_mov_b64 s[44:45], s[82:83]
  s_mov_b32 s46, 256
  s_mov_b32 s47, 0x00020000
  s_getreg_b32 s51, hwreg(HW_REG_XCC_ID, 0, 4)
  s_or_b32 s51, s51, 0x10
  s_cmp_lg_u32 s56, 0
  s_cbranch_scc1 L2
  s_min_u32 s96, s4, 2
  v_cmp_ge_u32 vcc, s96, v21
  s_nop 1
  v_cndmask_b32 v7, v7, v22, vcc
  v_lshlrev_b32 v21, 2, v0
  v_lshlrev_b32 v22, 7, v0
  s_lshl_b32 s96, s4, 8
  s_add_u32 s96, s96, 131072
  s_lshl_b32 s97, s4, 13
  buffer_store_dword v20, v21, s[28:31], s96 offen sc1
  buffer_store_dword v20, v22, s[28:31], s97 offen sc1
L2:
  s_mov_b64 s[16:17], s[68:69]
  s_mov_b32 s18, 524288
  s_mov_b32 s19, 0x00020000
  s_mov_b64 s[20:21], s[72:73]
  s_mov_b32 s22, 1835008
  s_mov_b32 s23, 0x00020000
  s_mov_b64 s[24:25], s[76:77]
  s_mov_b32 s26, 1835008
  s_mov_b32 s27, 0x00020000
  s_mov_b64 s[32:33], s[80:81]
  s_mov_b32 s34, 2097152
  s_mov_b32 s35, 0x00020000
  s_mov_b64 s[36:37], s[78:79]
  s_mov_b32 s38, 1024
  s_mov_b32 s39, 0x00020000
  s_mov_b64 s[40:41], s[74:75]
  s_mov_b32 s42, 3584
  s_mov_b32 s43, 0x00020000
  s_lshr_b32 s96, s2, 2
  s_xor_b32 s96, s96, s2
  s_bfe_u32 s0, s96, 0x20003
  v_bfe_u32 v13, v0, 2, 2
  v_lshl_add_u32 v13, v14, 3, v13
  v_lshlrev_b32 v13, 6, v13
  v_bfe_u32 v15, v0, 4, 1
  v_lshl_add_u32 v13, v15, 5, v13
  v_and_b32 v15, 1, v0
  v_lshl_add_u32 v13, v15, 4, v13
  v_bfe_u32 v15, v0, 1, 1
  v_lshl_add_u32 v2, v15, 3, v13
  v_add_u32 v3, 0x10000, v2
  v_lshl_add_u32 v4, v14, 9, v2
  v_add_u32 v5, 0x10000, v4
  s_and_b32 s54, s5, 1
  s_lshl_b32 s54, s54, 1
  s_lshl_b32 s49, s4, 2
  s_add_u32 s49, s49, s54
  s_lshr_b32 s54, s6, 1
  s_add_u32 s49, s49, s54
  s_and_b32 s96, s5, 14
  s_and_b32 s97, s6, 1
  s_add_u32 s50, s96, s97
  s_mul_i32 s3, s54, 917504
  s_lshl_b32 s54, s97, 14
  s_add_u32 s3, s3, s54
  s_lshl_b32 s96, s96, 6
  s_add_u32 s3, s3, s96
  v_bfe_u32 v13, v0, 2, 3
  v_and_b32 v15, 0x30, v1
  v_mul_u32_u24 v11, 3584, v13
  v_lshl_add_u32 v12, v13, 10, v15
  v_add_u32 v11, v11, v15
  v_lshl_add_u32 v11, v14, 6, v11
  v_xor_b32 v13, s97, v14
  v_lshl_add_u32 v12, v13, 6, v12
  v_and_b32 v13, 31, v0
  v_lshlrev_b32 v15, 2, v14
  v_sub_u32 v13, v13, v15
  v_cmp_le_i32_e64 s[64:65], 0, v13
  v_cmp_le_i32_e64 s[66:67], 1, v13
  v_cmp_le_i32_e64 s[68:69], 2, v13
  v_cmp_le_i32_e64 s[70:71], 3, v13
  v_cmp_le_i32_e64 s[72:73], 8, v13
  v_cmp_le_i32_e64 s[74:75], 9, v13
  v_cmp_le_i32_e64 s[76:77], 10, v13
  v_cmp_le_i32_e64 s[78:79], 11, v13
  v_cmp_le_i32_e64 s[80:81], 16, v13
  v_cmp_le_i32_e64 s[82:83], 17, v13
  v_cmp_le_i32_e64 s[84:85], 18, v13
  v_cmp_le_i32_e64 s[86:87], 19, v13
  v_cmp_le_i32_e64 s[88:89], 24, v13
  v_cmp_le_i32_e64 s[90:91], 25, v13
  v_cmp_le_i32_e64 s[92:93], 26, v13
  v_cmp_le_i32_e64 s[94:95], 27, v13
  v_mov_b32 v13, 0xffff
  v_mov_b32 v15, 0xffff0000
  v_cndmask_b32_e64 v16, 0, v13, s[64:65]
  v_cndmask_b32_e64 v17, 0, v15, s[66:67]
  v_or_b32 v16, v16, v17
  v_accvgpr_write_b32 a240, v16
  v_cndmask_b32_e64 v16, 0, v13, s[68:69]
  v_cndmask_b32_e64 v17, 0, v15, s[70:71]
  v_or_b32 v16, v16, v17
  v_accvgpr_write_b32 a241, v16
  v_cndmask_b32_e64 v16, 0, v13, s[72:73]
  v_cndmask_b32_e64 v17, 0, v15, s[74:75]
  v_or_b32 v16, v16, v17
  v_accvgpr_write_b32 a242, v16
  v_cndmask_b32_e64 v16, 0, v13, s[76:77]
  v_cndmask_b32_e64 v17, 0, v15, s[78:79]
  v_or_b32 v16, v16, v17
  v_accvgpr_write_b32 a243, v16
  v_cndmask_b32_e64 v16, 0, v13, s[80:81]
  v_cndmask_b32_e64 v17, 0, v15, s[82:83]
  v_or_b32 v16, v16, v17
  v_accvgpr_write_b32 a244, v16
  v_cndmask_b32_e64 v16, 0, v13, s[84:85]
  v_cndmask_b32_e64 v17, 0, v15, s[86:87]
  v_or_b32 v16, v16, v17
  v_accvgpr_write_b32 a245, v16
  v_cndmask_b32_e64 v16, 0, v13, s[88:89]
  v_cndmask_b32_e64 v17, 0, v15, s[90:91]
  v_or_b32 v16, v16, v17
  v_accvgpr_write_b32 a246, v16
  v_cndmask_b32_e64 v16, 0, v13, s[92:93]
  v_cndmask_b32_e64 v17, 0, v15, s[94:95]
  v_or_b32 v16, v16, v17
  v_accvgpr_write_b32 a247, v16
L_p1_0:
  v_lshrrev_b32 v124, 2, v0
  v_xor_b32 v124, v124, v0
  v_bfe_u32 v124, v124, 2, 1
  v_add_u32 v124, -1, v124
  v_and_b32 v124, 0x3f803f80, v124
  v_mov_b32 v125, v124
  v_mov_b64 v[126:127], v[124:125]
  v_mov_b32 v100, 0
  v_mov_b32 v101, 0
  v_mov_b32 v102, 0
  v_mov_b32 v103, 0
  v_lshrrev_b32 v13, 5, v0
  v_bfe_u32 v14, v0, 3, 1
  v_xor_b32 v13, v13, v14
  v_xor_b32 v13, v13, v0
  v_and_b32 v13, 7, v13
  v_and_b32 v14, 31, v0
  v_lshlrev_b32 v14, 7, v14
  v_lshl_add_u32 v13, v13, 4, v14
  s_add_u32 s54, s63, 98304
  v_add_u32 v120, s54, v13
  v_xor_b32 v121, 32, v120
  v_xor_b32 v122, 64, v120
  v_xor_b32 v123, 96, v120
  v_add_u32 v14, s62, v2
  s_lshr_b32 s96, s6, 1
  s_lshl_b32 s96, s96, 9
  s_and_b32 s97, s6, 1
  s_lshl_b32 s97, s97, 3
  s_add_u32 s96, s96, s97
  s_add_u32 s96, s96, 156160
  v_and_b32 v15, 0x1f0, v1
  v_add_u32 v15, s96, v15
  v_mov_b32 v118, s51
  v_mul_u32_u24 v6, 640, v0
  v_mov_b64 v[18:19], 0
  v_lshlrev_b32 v17, 3, v0
  buffer_store_dwordx4 a[236:239], v1, s[28:31], s98 offen offset:2048 sc1
  buffer_store_dwordx4 a[236:239], v1, s[28:31], s98 offen offset:3072 sc1
  s_lshl_b32 s97, s52, 9
  s_add_u32 s97, s97, 20971520
  buffer_store_dwordx2 v[18:19], v17, s[28:31], s97 offen sc1
  s_xor_b32 s61, s59, 2
  s_lshl_b32 s61, s61, 7
  s_add_u32 s61, s61, s57
  s_add_u32 m0, s63, 106496
  s_nop 0
  buffer_load_dwordx4 v112, s[8:11], s61 offen offset:0 lds
  s_add_u32 s61, s61, 7168
  buffer_load_dwordx4 v113, s[8:11], s61 offen offset:1024 lds
  s_add_u32 s61, s61, 7168
  buffer_load_dwordx4 v112, s[8:11], s61 offen offset:2048 lds
  s_add_u32 s61, s61, 7168
  buffer_load_dwordx4 v113, s[8:11], s61 offen offset:3072 lds
  s_xor_b32 s61, s59, 2
  s_mul_i32 s61, s61, 196608
  s_add_u32 s61, s61, s58
  s_add_u32 m0, s62, 8192
  s_add_u32 s60, s61, 1024
  buffer_load_dwordx4 v10, s[12:15], s60 offen offset:0 lds
  s_add_u32 m0, s62, 40960
  s_add_u32 s60, s61, 2048
  buffer_load_dwordx4 v10, s[12:15], s60 offen offset:0 lds
  s_waitcnt vmcnt(18)
  ds_read_b128 v[128:131], v120 offset:0
  ds_read_b128 v[132:135], v121 offset:0
  ds_read_b128 v[136:139], v122 offset:0
  ds_read_b128 v[140:143], v123 offset:0
  s_waitcnt vmcnt(16)
  ds_read_b64_tr_b16 v[48:49], v14 offset:0
  ds_read_b64_tr_b16 v[50:51], v14 offset:256
  ds_read_b64_tr_b16 v[52:53], v14 offset:32768
  ds_read_b64_tr_b16 v[54:55], v14 offset:33024
  s_barrier
  ds_read_b64_tr_b16 v[64:65], v2 offset:0
  ds_read_b64_tr_b16 v[66:67], v2 offset:256
  ds_read_b64_tr_b16 v[68:69], v2 offset:32768
  ds_read_b64_tr_b16 v[70:71], v2 offset:33024
  ds_read_b64_tr_b16 v[72:73], v2 offset:1024
  ds_read_b64_tr_b16 v[74:75], v2 offset:1280
  ds_read_b64_tr_b16 v[76:77], v2 offset:33792
  ds_read_b64_tr_b16 v[78:79], v2 offset:34048
  ds_read_b64_tr_b16 v[80:81], v2 offset:2048
  ds_read_b64_tr_b16 v[82:83], v2 offset:2304
  ds_read_b64_tr_b16 v[84:85], v2 offset:34816
  ds_read_b64_tr_b16 v[86:87], v2 offset:35072
  s_waitcnt lgkmcnt(14)
  v_mfma_f32_16x16x32_bf16 v[104:107], v[124:127], v[48:51], 0
  s_waitcnt lgkmcnt(12)
  v_mfma_f32_16x16x32_bf16 v[108:111], v[124:127], v[52:55], 0
  v_dot2c_f32_bf16 v100, v128, v128
  v_dot2c_f32_bf16 v101, v129, v129
  v_dot2c_f32_bf16 v102, v130, v130
  v_dot2c_f32_bf16 v103, v131, v131
  v_mfma_f32_16x16x32_bf16 v[96:99], v[124:127], v[128:131], 0
  s_xor_b32 s61, s59, 3
  s_lshl_b32 s61, s61, 7
  s_add_u32 s61, s61, s57
  s_add_u32 m0, s63, 110592
  s_nop 0
  buffer_load_dwordx4 v112, s[8:11], s61 offen offset:0 lds
  s_add_u32 s61, s61, 7168
  buffer_load_dwordx4 v113, s[8:11], s61 offen offset:1024 lds
  s_add_u32 s61, s61, 7168
  buffer_load_dwordx4 v112, s[8:11], s61 offen offset:2048 lds
  s_add_u32 s61, s61, 7168
  buffer_load_dwordx4 v113, s[8:11], s61 offen offset:3072 lds
  v_dot2c_f32_bf16 v100, v132, v132
  v_dot2c_f32_bf16 v101, v133, v133
  v_dot2c_f32_bf16 v102, v134, v134
  v_dot2c_f32_bf16 v103, v135, v135
  v_mfma_f32_16x16x32_bf16 v[96:99], v[124:127], v[132:135], v[96:99]
  v_dot2c_f32_bf16 v100, v136, v136
  v_dot2c_f32_bf16 v101, v137, v137
  v_dot2c_f32_bf16 v102, v138, v138
  v_dot2c_f32_bf16 v103, v139, v139
  v_mfma_f32_16x16x32_bf16 v[96:99], v[124:127], v[136:139], v[96:99]
  s_xor_b32 s61, s59, 3
  s_mul_i32 s61, s61, 196608
  s_add_u32 s61, s61, s58
  s_add_u32 m0, s62, 12288
  s_add_u32 s60, s61, 1024
  buffer_load_dwordx4 v10, s[12:15], s60 offen offset:0 lds
  s_add_u32 m0, s62, 45056
  s_add_u32 s60, s61, 2048
  buffer_load_dwordx4 v10, s[12:15], s60 offen offset:0 lds
  v_dot2c_f32_bf16 v100, v140, v140
  v_dot2c_f32_bf16 v101, v141, v141
  v_dot2c_f32_bf16 v102, v142, v142
  v_dot2c_f32_bf16 v103, v143, v143
  v_mfma_f32_16x16x32_bf16 v[96:99], v[124:127], v[140:143], v[96:99]
  s_waitcnt lgkmcnt(10)
  ds_read_b64_tr_b16 v[88:89], v2 offset:3072
  ds_read_b64_tr_b16 v[90:91], v2 offset:3328
  ds_read_b64_tr_b16 v[92:93], v2 offset:35840
  ds_read_b64_tr_b16 v[94:95], v2 offset:36096
  v_mfma_f32_32x32x16_bf16 v[16:31], v[64:67], v[128:131], 0
  s_waitcnt lgkmcnt(12)
  v_mfma_f32_32x32x16_bf16 v[32:47], v[128:131], v[68:71], 0
  s_waitcnt vmcnt(17)
  ds_read_b128 v[144:147], v120 offset:4096
  ds_read_b128 v[148:151], v121 offset:4096
  ds_read_b128 v[152:155], v122 offset:4096
  ds_read_b128 v[156:159], v123 offset:4096
  s_waitcnt vmcnt(15)
  ds_read_b64_tr_b16 v[56:57], v14 offset:4096
  ds_read_b64_tr_b16 v[58:59], v14 offset:4352
  ds_read_b64_tr_b16 v[60:61], v14 offset:36864
  ds_read_b64_tr_b16 v[62:63], v14 offset:37120
  s_barrier
  ds_read_b64_tr_b16 v[64:65], v2 offset:4096
  ds_read_b64_tr_b16 v[66:67], v2 offset:4352
  ds_read_b64_tr_b16 v[68:69], v2 offset:36864
  ds_read_b64_tr_b16 v[70:71], v2 offset:37120
  s_waitcnt lgkmcnt(15)
  v_mfma_f32_32x32x16_bf16 v[16:31], v[72:75], v[132:135], v[16:31]
  v_mfma_f32_32x32x16_bf16 v[32:47], v[132:135], v[76:79], v[32:47]
  s_add_u32 s98, s98, 20971520
  buffer_store_dwordx4 a[236:239], v1, s[28:31], s98 offen offset:0 sc1
  s_xor_b32 s61, s59, 4
  s_lshl_b32 s61, s61, 7
  s_add_u32 s61, s61, s57
  s_add_u32 m0, s63, 98304
  s_nop 0
  buffer_load_dwordx4 v112, s[8:11], s61 offen offset:0 lds
  s_add_u32 s61, s61, 7168
  buffer_load_dwordx4 v113, s[8:11], s61 offen offset:1024 lds
  s_waitcnt lgkmcnt(6)
  v_mfma_f32_16x16x32_bf16 v[104:107], v[124:127], v[56:59], v[104:107]
  s_waitcnt lgkmcnt(4)
  v_mfma_f32_16x16x32_bf16 v[108:111], v[124:127], v[60:63], v[108:111]
  v_dot2c_f32_bf16 v100, v144, v144
  v_dot2c_f32_bf16 v101, v145, v145
  v_dot2c_f32_bf16 v102, v146, v146
  v_dot2c_f32_bf16 v103, v147, v147
  v_mfma_f32_16x16x32_bf16 v[96:99], v[124:127], v[144:147], v[96:99]
  ds_read_b64_tr_b16 v[72:73], v2 offset:5120
  ds_read_b64_tr_b16 v[74:75], v2 offset:5376
  ds_read_b64_tr_b16 v[76:77], v2 offset:37888
  ds_read_b64_tr_b16 v[78:79], v2 offset:38144
  v_mfma_f32_32x32x16_bf16 v[16:31], v[80:83], v[136:139], v[16:31]
  v_mfma_f32_32x32x16_bf16 v[32:47], v[136:139], v[84:87], v[32:47]
  s_add_u32 s61, s61, 7168
  buffer_load_dwordx4 v112, s[8:11], s61 offen offset:2048 lds
  s_add_u32 s61, s61, 7168
  buffer_load_dwordx4 v113, s[8:11], s61 offen offset:3072 lds
  s_xor_b32 s61, s59, 4
  s_mul_i32 s61, s61, 196608
  s_add_u32 s61, s61, s58
  s_add_u32 m0, s62, 16384
  s_add_u32 s60, s61, 1024
  buffer_load_dwordx4 v10, s[12:15], s60 offen offset:0 lds
  v_dot2c_f32_bf16 v100, v148, v148
  v_dot2c_f32_bf16 v101, v149, v149
  v_dot2c_f32_bf16 v102, v150, v150
  v_dot2c_f32_bf16 v103, v151, v151
  v_mfma_f32_16x16x32_bf16 v[96:99], v[124:127], v[148:151], v[96:99]
  v_dot2c_f32_bf16 v100, v152, v152
  v_dot2c_f32_bf16 v101, v153, v153
  v_dot2c_f32_bf16 v102, v154, v154
  v_dot2c_f32_bf16 v103, v155, v155
  v_mfma_f32_16x16x32_bf16 v[96:99], v[124:127], v[152:155], v[96:99]
  ds_read_b64_tr_b16 v[80:81], v2 offset:6144
  ds_read_b64_tr_b16 v[82:83], v2 offset:6400
  ds_read_b64_tr_b16 v[84:85], v2 offset:38912
  ds_read_b64_tr_b16 v[86:87], v2 offset:39168
  v_mfma_f32_32x32x16_bf16 v[16:31], v[88:91], v[140:143], v[16:31]
  v_mfma_f32_32x32x16_bf16 v[32:47], v[140:143], v[92:95], v[32:47]
  s_add_u32 m0, s62, 49152
  s_add_u32 s60, s61, 2048
  buffer_load_dwordx4 v10, s[12:15], s60 offen offset:0 lds
  v_dot2c_f32_bf16 v100, v156, v156
  v_dot2c_f32_bf16 v101, v157, v157
  v_dot2c_f32_bf16 v102, v158, v158
  v_dot2c_f32_bf16 v103, v159, v159
  v_mfma_f32_16x16x32_bf16 v[96:99], v[124:127], v[156:159], v[96:99]
  s_waitcnt lgkmcnt(10)
  ds_read_b64_tr_b16 v[88:89], v2 offset:7168
  ds_read_b64_tr_b16 v[90:91], v2 offset:7424
  ds_read_b64_tr_b16 v[92:93], v2 offset:39936
  ds_read_b64_tr_b16 v[94:95], v2 offset:40192
  v_mfma_f32_32x32x16_bf16 v[16:31], v[64:67], v[144:147], v[16:31]
  s_waitcnt lgkmcnt(12)
  v_mfma_f32_32x32x16_bf16 v[32:47], v[144:147], v[68:71], v[32:47]
  s_waitcnt vmcnt(15)
  ds_read_b128 v[160:163], v120 offset:8192
  ds_read_b128 v[164:167], v121 offset:8192
  ds_read_b128 v[168:171], v122 offset:8192
  ds_read_b128 v[172:175], v123 offset:8192
  s_waitcnt vmcnt(13)
  ds_read_b64_tr_b16 v[48:49], v14 offset:8192
  ds_read_b64_tr_b16 v[50:51], v14 offset:8448
  ds_read_b64_tr_b16 v[52:53], v14 offset:40960
  ds_read_b64_tr_b16 v[54:55], v14 offset:41216
  s_cmp_lg_u32 s6, 2
  s_barrier
  s_cbranch_scc1 L3
  s_mov_b64 exec, 7
  buffer_store_dword v118, v6, s[28:31], s55 offen sc1
  s_mov_b64 exec, -1
L3:
  ds_read_b64_tr_b16 v[64:65], v2 offset:8192
  ds_read_b64_tr_b16 v[66:67], v2 offset:8448
  ds_read_b64_tr_b16 v[68:69], v2 offset:40960
  ds_read_b64_tr_b16 v[70:71], v2 offset:41216
  s_waitcnt lgkmcnt(15)
  v_mfma_f32_32x32x16_bf16 v[16:31], v[72:75], v[148:151], v[16:31]
  v_mfma_f32_32x32x16_bf16 v[32:47], v[148:151], v[76:79], v[32:47]
  s_waitcnt lgkmcnt(6)
  buffer_store_dwordx4 a[236:239], v1, s[28:31], s98 offen offset:1024 sc1
  s_xor_b32 s61, s59, 5
  s_lshl_b32 s61, s61, 7
  s_add_u32 s61, s61, s57
  s_add_u32 m0, s63, 102400
  s_nop 0
  buffer_load_dwordx4 v112, s[8:11], s61 offen offset:0 lds
  s_add_u32 s61, s61, 7168
  buffer_load_dwordx4 v113, s[8:11], s61 offen offset:1024 lds
  v_mfma_f32_16x16x32_bf16 v[104:107], v[124:127], v[48:51], v[104:107]
  s_waitcnt lgkmcnt(4)
  v_mfma_f32_16x16x32_bf16 v[108:111], v[124:127], v[52:55], v[108:111]
  v_dot2c_f32_bf16 v100, v160, v160
  v_dot2c_f32_bf16 v101, v161, v161
  v_dot2c_f32_bf16 v102, v162, v162
  v_dot2c_f32_bf16 v103, v163, v163
  v_mfma_f32_16x16x32_bf16 v[96:99], v[124:127], v[160:163], v[96:99]
  ds_read_b64_tr_b16 v[72:73], v2 offset:9216
  ds_read_b64_tr_b16 v[74:75], v2 offset:9472
  ds_read_b64_tr_b16 v[76:77], v2 offset:41984
  ds_read_b64_tr_b16 v[78:79], v2 offset:42240
  v_mfma_f32_32x32x16_bf16 v[16:31], v[80:83], v[152:155], v[16:31]
  v_mfma_f32_32x32x16_bf16 v[32:47], v[152:155], v[84:87], v[32:47]
  s_add_u32 s61, s61, 7168
  buffer_load_dwordx4 v112, s[8:11], s61 offen offset:2048 lds
  s_add_u32 s61, s61, 7168
  buffer_load_dwordx4 v113, s[8:11], s61 offen offset:3072 lds
  s_xor_b32 s61, s59, 5
  s_mul_i32 s61, s61, 196608
  s_add_u32 s61, s61, s58
  s_add_u32 m0, s62, 20480
  s_add_u32 s60, s61, 1024
  buffer_load_dwordx4 v10, s[12:15], s60 offen offset:0 lds
  v_dot2c_f32_bf16 v100, v164, v164
  v_dot2c_f32_bf16 v101, v165, v165
  v_dot2c_f32_bf16 v102, v166, v166
  v_dot2c_f32_bf16 v103, v167, v167
  v_mfma_f32_16x16x32_bf16 v[96:99], v[124:127], v[164:167], v[96:99]
  v_dot2c_f32_bf16 v100, v168, v168
  v_dot2c_f32_bf16 v101, v169, v169
  v_dot2c_f32_bf16 v102, v170, v170
  v_dot2c_f32_bf16 v103, v171, v171
  v_mfma_f32_16x16x32_bf16 v[96:99], v[124:127], v[168:171], v[96:99]
  ds_read_b64_tr_b16 v[80:81], v2 offset:10240
  ds_read_b64_tr_b16 v[82:83], v2 offset:10496
  ds_read_b64_tr_b16 v[84:85], v2 offset:43008
  ds_read_b64_tr_b16 v[86:87], v2 offset:43264
  v_mfma_f32_32x32x16_bf16 v[16:31], v[88:91], v[156:159], v[16:31]
  v_mfma_f32_32x32x16_bf16 v[32:47], v[156:159], v[92:95], v[32:47]
  s_add_u32 m0, s62, 53248
  s_add_u32 s60, s61, 2048
  buffer_load_dwordx4 v10, s[12:15], s60 offen offset:0 lds
  v_dot2c_f32_bf16 v100, v172, v172
  v_dot2c_f32_bf16 v101, v173, v173
  v_dot2c_f32_bf16 v102, v174, v174
  v_dot2c_f32_bf16 v103, v175, v175
  v_mfma_f32_16x16x32_bf16 v[96:99], v[124:127], v[172:175], v[96:99]
  s_waitcnt lgkmcnt(10)
  ds_read_b64_tr_b16 v[88:89], v2 offset:11264
  ds_read_b64_tr_b16 v[90:91], v2 offset:11520
  ds_read_b64_tr_b16 v[92:93], v2 offset:44032
  ds_read_b64_tr_b16 v[94:95], v2 offset:44288
  v_mfma_f32_32x32x16_bf16 v[16:31], v[64:67], v[160:163], v[16:31]
  s_waitcnt lgkmcnt(12)
  v_mfma_f32_32x32x16_bf16 v[32:47], v[160:163], v[68:71], v[32:47]
  s_waitcnt vmcnt(16)
  ds_read_b128 v[176:179], v120 offset:12288
  ds_read_b128 v[180:183], v121 offset:12288
  ds_read_b128 v[184:187], v122 offset:12288
  ds_read_b128 v[188:191], v123 offset:12288
  s_cmp_lg_u32 s56, 0
  s_cbranch_scc1 L4
  buffer_load_dword a234, v7, s[28:31], s55 offen sc1
L4:
  s_waitcnt vmcnt(14)
  ds_read_b64_tr_b16 v[56:57], v14 offset:12288
  ds_read_b64_tr_b16 v[58:59], v14 offset:12544
  ds_read_b64_tr_b16 v[60:61], v14 offset:45056
  ds_read_b64_tr_b16 v[62:63], v14 offset:45312
  s_barrier
  ds_read_b64_tr_b16 v[64:65], v2 offset:12288
  ds_read_b64_tr_b16 v[66:67], v2 offset:12544
  ds_read_b64_tr_b16 v[68:69], v2 offset:45056
  ds_read_b64_tr_b16 v[70:71], v2 offset:45312
  s_waitcnt lgkmcnt(15)
  v_mfma_f32_32x32x16_bf16 v[16:31], v[72:75], v[164:167], v[16:31]
  v_mfma_f32_32x32x16_bf16 v[32:47], v[164:167], v[76:79], v[32:47]
  s_waitcnt lgkmcnt(6)
  buffer_store_dwordx4 a[236:239], v1, s[28:31], s98 offen offset:2048 sc1
  s_xor_b32 s61, s59, 6
  s_lshl_b32 s61, s61, 7
  s_add_u32 s61, s61, s57
  s_add_u32 m0, s63, 106496
  s_nop 0
  buffer_load_dwordx4 v112, s[8:11], s61 offen offset:0 lds
  s_add_u32 s61, s61, 7168
  buffer_load_dwordx4 v113, s[8:11], s61 offen offset:1024 lds
  v_mfma_f32_16x16x32_bf16 v[104:107], v[124:127], v[56:59], v[104:107]
  s_waitcnt lgkmcnt(4)
  v_mfma_f32_16x16x32_bf16 v[108:111], v[124:127], v[60:63], v[108:111]
  v_dot2c_f32_bf16 v100, v176, v176
  v_dot2c_f32_bf16 v101, v177, v177
  v_dot2c_f32_bf16 v102, v178, v178
  v_dot2c_f32_bf16 v103, v179, v179
  v_mfma_f32_16x16x32_bf16 v[96:99], v[124:127], v[176:179], v[96:99]
  ds_read_b64_tr_b16 v[72:73], v2 offset:13312
  ds_read_b64_tr_b16 v[74:75], v2 offset:13568
  ds_read_b64_tr_b16 v[76:77], v2 offset:46080
  ds_read_b64_tr_b16 v[78:79], v2 offset:46336
  v_mfma_f32_32x32x16_bf16 v[16:31], v[80:83], v[168:171], v[16:31]
  v_mfma_f32_32x32x16_bf16 v[32:47], v[168:171], v[84:87], v[32:47]
  s_add_u32 s61, s61, 7168
  buffer_load_dwordx4 v112, s[8:11], s61 offen offset:2048 lds
  s_add_u32 s61, s61, 7168
  buffer_load_dwordx4 v113, s[8:11], s61 offen offset:3072 lds
  s_xor_b32 s61, s59, 6
  s_mul_i32 s61, s61, 196608
  s_add_u32 s61, s61, s58
  s_add_u32 m0, s62, 24576
  s_add_u32 s60, s61, 1024
  buffer_load_dwordx4 v10, s[12:15], s60 offen offset:0 lds
  v_dot2c_f32_bf16 v100, v180, v180
  v_dot2c_f32_bf16 v101, v181, v181
  v_dot2c_f32_bf16 v102, v182, v182
  v_dot2c_f32_bf16 v103, v183, v183
  v_mfma_f32_16x16x32_bf16 v[96:99], v[124:127], v[180:183], v[96:99]
  v_dot2c_f32_bf16 v100, v184, v184
  v_dot2c_f32_bf16 v101, v185, v185
  v_dot2c_f32_bf16 v102, v186, v186
  v_dot2c_f32_bf16 v103, v187, v187
  v_mfma_f32_16x16x32_bf16 v[96:99], v[124:127], v[184:187], v[96:99]
  ds_read_b64_tr_b16 v[80:81], v2 offset:14336
  ds_read_b64_tr_b16 v[82:83], v2 offset:14592
  ds_read_b64_tr_b16 v[84:85], v2 offset:47104
  ds_read_b64_tr_b16 v[86:87], v2 offset:47360
  v_mfma_f32_32x32x16_bf16 v[16:31], v[88:91], v[172:175], v[16:31]
  v_mfma_f32_32x32x16_bf16 v[32:47], v[172:175], v[92:95], v[32:47]
  s_add_u32 m0, s62, 57344
  s_add_u32 s60, s61, 2048
  buffer_load_dwordx4 v10, s[12:15], s60 offen offset:0 lds
  v_dot2c_f32_bf16 v100, v188, v188
  v_dot2c_f32_bf16 v101, v189, v189
  v_dot2c_f32_bf16 v102, v190, v190
  v_dot2c_f32_bf16 v103, v191, v191
  v_mfma_f32_16x16x32_bf16 v[96:99], v[124:127], v[188:191], v[96:99]
  s_waitcnt lgkmcnt(10)
  ds_read_b64_tr_b16 v[88:89], v2 offset:15360
  ds_read_b64_tr_b16 v[90:91], v2 offset:15616
  ds_read_b64_tr_b16 v[92:93], v2 offset:48128
  ds_read_b64_tr_b16 v[94:95], v2 offset:48384
  v_mfma_f32_32x32x16_bf16 v[16:31], v[64:67], v[176:179], v[16:31]
  s_waitcnt lgkmcnt(12)
  v_mfma_f32_32x32x16_bf16 v[32:47], v[176:179], v[68:71], v[32:47]
  s_waitcnt vmcnt(16)
  ds_read_b128 v[192:195], v120 offset:0
  ds_read_b128 v[196:199], v121 offset:0
  ds_read_b128 v[200:203], v122 offset:0
  ds_read_b128 v[204:207], v123 offset:0
  s_cmp_lg_u32 s56, 0
  s_cbranch_scc1 L7
  buffer_load_dword a233, v7, s[28:31], s55 offen sc1
L7:
  s_waitcnt vmcnt(14)
  ds_read_b64_tr_b16 v[48:49], v14 offset:16384
  ds_read_b64_tr_b16 v[50:51], v14 offset:16640
  ds_read_b64_tr_b16 v[52:53], v14 offset:49152
  ds_read_b64_tr_b16 v[54:55], v14 offset:49408
  s_cmp_lg_u32 s6, 3
  s_barrier
  s_cbranch_scc1 L10
  s_mov_b64 exec, 7
  buffer_store_dword v118, v6, s[28:31], s55 offen sc1
  s_mov_b64 exec, -1
L10:
  ds_read_b64_tr_b16 v[64:65], v2 offset:16384
  ds_read_b64_tr_b16 v[66:67], v2 offset:16640
  ds_read_b64_tr_b16 v[68:69], v2 offset:49152
  ds_read_b64_tr_b16 v[70:71], v2 offset:49408
  s_waitcnt lgkmcnt(15)
  v_mfma_f32_32x32x16_bf16 v[16:31], v[72:75], v[180:183], v[16:31]
  v_mfma_f32_32x32x16_bf16 v[32:47], v[180:183], v[76:79], v[32:47]
  s_waitcnt lgkmcnt(6)
  buffer_store_dwordx4 a[236:239], v1, s[28:31], s98 offen offset:3072 sc1
  s_xor_b32 s61, s59, 7
  s_lshl_b32 s61, s61, 7
  s_add_u32 s61, s61, s57
  s_add_u32 m0, s63, 110592
  s_nop 0
  buffer_load_dwordx4 v112, s[8:11], s61 offen offset:0 lds
  s_add_u32 s61, s61, 7168
  buffer_load_dwordx4 v113, s[8:11], s61 offen offset:1024 lds
  v_mfma_f32_16x16x32_bf16 v[104:107], v[124:127], v[48:51], v[104:107]
  s_waitcnt lgkmcnt(4)
  v_mfma_f32_16x16x32_bf16 v[108:111], v[124:127], v[52:55], v[108:111]
  v_dot2c_f32_bf16 v100, v192, v192
  v_dot2c_f32_bf16 v101, v193, v193
  v_dot2c_f32_bf16 v102, v194, v194
  v_dot2c_f32_bf16 v103, v195, v195
  v_mfma_f32_16x16x32_bf16 v[96:99], v[124:127], v[192:195], v[96:99]
  ds_read_b64_tr_b16 v[72:73], v2 offset:17408
  ds_read_b64_tr_b16 v[74:75], v2 offset:17664
  ds_read_b64_tr_b16 v[76:77], v2 offset:50176
  ds_read_b64_tr_b16 v[78:79], v2 offset:50432
  v_mfma_f32_32x32x16_bf16 v[16:31], v[80:83], v[184:187], v[16:31]
  v_mfma_f32_32x32x16_bf16 v[32:47], v[184:187], v[84:87], v[32:47]
  s_add_u32 s61, s61, 7168
  buffer_load_dwordx4 v112, s[8:11], s61 offen offset:2048 lds
  s_add_u32 s61, s61, 7168
  buffer_load_dwordx4 v113, s[8:11], s61 offen offset:3072 lds
  s_xor_b32 s61, s59, 7
  s_mul_i32 s61, s61, 196608
  s_add_u32 s61, s61, s58
  s_add_u32 m0, s62, 28672
  s_add_u32 s60, s61, 1024
  buffer_load_dwordx4 v10, s[12:15], s60 offen offset:0 lds
  v_dot2c_f32_bf16 v100, v196, v196
  v_dot2c_f32_bf16 v101, v197, v197
  v_dot2c_f32_bf16 v102, v198, v198
  v_dot2c_f32_bf16 v103, v199, v199
  v_mfma_f32_16x16x32_bf16 v[96:99], v[124:127], v[196:199], v[96:99]
  v_dot2c_f32_bf16 v100, v200, v200
  v_dot2c_f32_bf16 v101, v201, v201
  v_dot2c_f32_bf16 v102, v202, v202
  v_dot2c_f32_bf16 v103, v203, v203
  v_mfma_f32_16x16x32_bf16 v[96:99], v[124:127], v[200:203], v[96:99]
  ds_read_b64_tr_b16 v[80:81], v2 offset:18432
  ds_read_b64_tr_b16 v[82:83], v2 offset:18688
  ds_read_b64_tr_b16 v[84:85], v2 offset:51200
  ds_read_b64_tr_b16 v[86:87], v2 offset:51456
  v_mfma_f32_32x32x16_bf16 v[16:31], v[88:91], v[188:191], v[16:31]
  v_mfma_f32_32x32x16_bf16 v[32:47], v[188:191], v[92:95], v[32:47]
  s_add_u32 m0, s62, 61440
  s_add_u32 s60, s61, 2048
  buffer_load_dwordx4 v10, s[12:15], s60 offen offset:0 lds
  v_dot2c_f32_bf16 v100, v204, v204
  v_dot2c_f32_bf16 v101, v205, v205
  v_dot2c_f32_bf16 v102, v206, v206
  v_dot2c_f32_bf16 v103, v207, v207
  v_mfma_f32_16x16x32_bf16 v[96:99], v[124:127], v[204:207], v[96:99]
  s_waitcnt lgkmcnt(10)
  ds_read_b64_tr_b16 v[88:89], v2 offset:19456
  ds_read_b64_tr_b16 v[90:91], v2 offset:19712
  ds_read_b64_tr_b16 v[92:93], v2 offset:52224
  ds_read_b64_tr_b16 v[94:95], v2 offset:52480
  v_mfma_f32_32x32x16_bf16 v[16:31], v[64:67], v[192:195], v[16:31]
  s_waitcnt lgkmcnt(12)
  v_mfma_f32_32x32x16_bf16 v[32:47], v[192:195], v[68:71], v[32:47]
  s_waitcnt vmcnt(16)
  ds_read_b128 v[208:211], v120 offset:4096
  ds_read_b128 v[212:215], v121 offset:4096
  ds_read_b128 v[216:219], v122 offset:4096
  ds_read_b128 v[220:223], v123 offset:4096
  s_cmp_lg_u32 s56, 0
  s_cbranch_scc1 L11
  s_waitcnt vmcnt(14)
  v_accvgpr_read_b32 v114, a234
  v_cmp_eq_u32 vcc, 0, v114
  s_cbranch_vccnz L12
  v_cmp_ne_u32 vcc, s51, v114
  v_lshlrev_b32 v115, 7, v0
  s_lshl_b32 s97, s4, 2
  s_and_b32 s96, vcc_lo, 0xffff
  s_cselect_b32 s56, 1, 2
  v_mov_b32 v114, s56
  s_mov_b64 exec, 0xffff
  buffer_store_dword v114, v115, s[28:31], s53 offen sc1
  s_mov_b64 exec, 1
  buffer_store_dword v114, off, s[44:47], s97 sc1
  s_mov_b64 exec, -1
  s_branch L11
L12:
  buffer_load_dword a234, v7, s[28:31], s55 offen sc1
L11:
  s_waitcnt vmcnt(14)
  ds_read_b64_tr_b16 v[56:57], v14 offset:20480
  ds_read_b64_tr_b16 v[58:59], v14 offset:20736
  ds_read_b64_tr_b16 v[60:61], v14 offset:53248
  ds_read_b64_tr_b16 v[62:63], v14 offset:53504
  s_barrier
  ds_read_b64_tr_b16 v[64:65], v2 offset:20480
  ds_read_b64_tr_b16 v[66:67], v2 offset:20736
  ds_read_b64_tr_b16 v[68:69], v2 offset:53248
  ds_read_b64_tr_b16 v[70:71], v2 offset:53504
  s_waitcnt lgkmcnt(15)
  v_mfma_f32_32x32x16_bf16 v[16:31], v[72:75], v[196:199], v[16:31]
  v_mfma_f32_32x32x16_bf16 v[32:47], v[196:199], v[76:79], v[32:47]
  s_xor_b32 s61, s59, 0
  s_mul_i32 s61, s61, 196608
  s_add_u32 s61, s61, s58
  s_add_u32 m0, s62, 65536
  s_add_u32 s60, s61, 0
  buffer_load_dwordx4 v10, s[12:15], s60 offen offset:0 lds
  s_xor_b32 s61, s59, 1
  s_mul_i32 s61, s61, 196608
  s_add_u32 s61, s61, s58
  s_add_u32 m0, s62, 69632
  s_add_u32 s60, s61, 0
  buffer_load_dwordx4 v10, s[12:15], s60 offen offset:0 lds
  s_waitcnt lgkmcnt(6)
  v_mfma_f32_16x16x32_bf16 v[104:107], v[124:127], v[56:59], v[104:107]
  s_waitcnt lgkmcnt(4)
  v_mfma_f32_16x16x32_bf16 v[108:111], v[124:127], v[60:63], v[108:111]
  v_dot2c_f32_bf16 v100, v208, v208
  v_dot2c_f32_bf16 v101, v209, v209
  v_dot2c_f32_bf16 v102, v210, v210
  v_dot2c_f32_bf16 v103, v211, v211
  v_mfma_f32_16x16x32_bf16 v[96:99], v[124:127], v[208:211], v[96:99]
  ds_read_b64_tr_b16 v[72:73], v2 offset:21504
  ds_read_b64_tr_b16 v[74:75], v2 offset:21760
  ds_read_b64_tr_b16 v[76:77], v2 offset:54272
  ds_read_b64_tr_b16 v[78:79], v2 offset:54528
  v_mfma_f32_32x32x16_bf16 v[16:31], v[80:83], v[200:203], v[16:31]
  v_mfma_f32_32x32x16_bf16 v[32:47], v[200:203], v[84:87], v[32:47]
  s_xor_b32 s61, s59, 2
  s_mul_i32 s61, s61, 196608
  s_add_u32 s61, s61, s58
  s_add_u32 m0, s62, 73728
  s_add_u32 s60, s61, 0
  buffer_load_dwordx4 v10, s[12:15], s60 offen offset:0 lds
  s_xor_b32 s61, s59, 3
  s_mul_i32 s61, s61, 196608
  s_add_u32 s61, s61, s58
  s_add_u32 m0, s62, 77824
  s_add_u32 s60, s61, 0
  buffer_load_dwordx4 v10, s[12:15], s60 offen offset:0 lds
  v_dot2c_f32_bf16 v100, v212, v212
  v_dot2c_f32_bf16 v101, v213, v213
  v_dot2c_f32_bf16 v102, v214, v214
  v_dot2c_f32_bf16 v103, v215, v215
  v_mfma_f32_16x16x32_bf16 v[96:99], v[124:127], v[212:215], v[96:99]
  v_dot2c_f32_bf16 v100, v216, v216
  v_dot2c_f32_bf16 v101, v217, v217
  v_dot2c_f32_bf16 v102, v218, v218
  v_dot2c_f32_bf16 v103, v219, v219
  v_mfma_f32_16x16x32_bf16 v[96:99], v[124:127], v[216:219], v[96:99]
  ds_read_b64_tr_b16 v[80:81], v2 offset:22528
  ds_read_b64_tr_b16 v[82:83], v2 offset:22784
  ds_read_b64_tr_b16 v[84:85], v2 offset:55296
  ds_read_b64_tr_b16 v[86:87], v2 offset:55552
  v_mfma_f32_32x32x16_bf16 v[16:31], v[88:91], v[204:207], v[16:31]
  v_mfma_f32_32x32x16_bf16 v[32:47], v[204:207], v[92:95], v[32:47]
  s_xor_b32 s61, s59, 4
  s_mul_i32 s61, s61, 196608
  s_add_u32 s61, s61, s58
  s_add_u32 m0, s62, 81920
  s_add_u32 s60, s61, 0
  buffer_load_dwordx4 v10, s[12:15], s60 offen offset:0 lds
  v_dot2c_f32_bf16 v100, v220, v220
  v_dot2c_f32_bf16 v101, v221, v221
  v_dot2c_f32_bf16 v102, v222, v222
  v_dot2c_f32_bf16 v103, v223, v223
  v_mfma_f32_16x16x32_bf16 v[96:99], v[124:127], v[220:223], v[96:99]
  s_waitcnt lgkmcnt(10)
  ds_read_b64_tr_b16 v[88:89], v2 offset:23552
  ds_read_b64_tr_b16 v[90:91], v2 offset:23808
  ds_read_b64_tr_b16 v[92:93], v2 offset:56320
  ds_read_b64_tr_b16 v[94:95], v2 offset:56576
  v_mfma_f32_32x32x16_bf16 v[16:31], v[64:67], v[208:211], v[16:31]
  s_waitcnt lgkmcnt(12)
  v_mfma_f32_32x32x16_bf16 v[32:47], v[208:211], v[68:71], v[32:47]
  s_waitcnt vmcnt(14)
  ds_read_b128 v[224:227], v120 offset:8192
  ds_read_b128 v[228:231], v121 offset:8192
  ds_read_b128 v[232:235], v122 offset:8192
  ds_read_b128 v[236:239], v123 offset:8192
  s_cmp_lg_u32 s56, 0
  s_cbranch_scc1 L14
  s_waitcnt vmcnt(12)
  v_accvgpr_read_b32 v114, a233
  v_cmp_eq_u32 vcc, 0, v114
  s_cbranch_vccnz L15
  v_cmp_ne_u32 vcc, s51, v114
  v_lshlrev_b32 v115, 7, v0
  s_lshl_b32 s97, s4, 2
  s_and_b32 s96, vcc_lo, 0xffff
  s_cselect_b32 s56, 1, 2
  v_mov_b32 v114, s56
  s_mov_b64 exec, 0xffff
  buffer_store_dword v114, v115, s[28:31], s53 offen sc1
  s_mov_b64 exec, 1
  buffer_store_dword v114, off, s[44:47], s97 sc1
  s_mov_b64 exec, -1
  s_branch L14
L15:
  buffer_load_dword a233, v7, s[28:31], s55 offen sc1
L14:
  s_waitcnt vmcnt(12)
  ds_read_b64_tr_b16 v[48:49], v14 offset:24576
  ds_read_b64_tr_b16 v[50:51], v14 offset:24832
  ds_read_b64_tr_b16 v[52:53], v14 offset:57344
  ds_read_b64_tr_b16 v[54:55], v14 offset:57600
  s_cmp_lg_u32 s6, 1
  s_barrier
  s_cbranch_scc1 L17
  s_mov_b64 exec, 7
  buffer_store_dword v118, v6, s[28:31], s55 offen sc1
  s_mov_b64 exec, -1
L17:
  ds_read_b64_tr_b16 v[64:65], v2 offset:24576
  ds_read_b64_tr_b16 v[66:67], v2 offset:24832
  ds_read_b64_tr_b16 v[68:69], v2 offset:57344
  ds_read_b64_tr_b16 v[70:71], v2 offset:57600
  s_waitcnt lgkmcnt(15)
  v_mfma_f32_32x32x16_bf16 v[16:31], v[72:75], v[212:215], v[16:31]
  v_mfma_f32_32x32x16_bf16 v[32:47], v[212:215], v[76:79], v[32:47]
  s_xor_b32 s61, s59, 5
  s_mul_i32 s61, s61, 196608
  s_add_u32 s61, s61, s58
  s_add_u32 m0, s62, 86016
  s_add_u32 s60, s61, 0
  buffer_load_dwordx4 v10, s[12:15], s60 offen offset:0 lds
  s_waitcnt lgkmcnt(6)
  v_mfma_f32_16x16x32_bf16 v[104:107], v[124:127], v[48:51], v[104:107]
  s_waitcnt lgkmcnt(4)
  v_mfma_f32_16x16x32_bf16 v[108:111], v[124:127], v[52:55], v[108:111]
  v_dot2c_f32_bf16 v100, v224, v224
  v_dot2c_f32_bf16 v101, v225, v225
  v_dot2c_f32_bf16 v102, v226, v226
  v_dot2c_f32_bf16 v103, v227, v227
  v_mfma_f32_16x16x32_bf16 v[96:99], v[124:127], v[224:227], v[96:99]
  ds_read_b64_tr_b16 v[72:73], v2 offset:25600
  ds_read_b64_tr_b16 v[74:75], v2 offset:25856
  ds_read_b64_tr_b16 v[76:77], v2 offset:58368
  ds_read_b64_tr_b16 v[78:79], v2 offset:58624
  v_mfma_f32_32x32x16_bf16 v[16:31], v[80:83], v[216:219], v[16:31]
  v_mfma_f32_32x32x16_bf16 v[32:47], v[216:219], v[84:87], v[32:47]
  s_xor_b32 s61, s59, 6
  s_mul_i32 s61, s61, 196608
  s_add_u32 s61, s61, s58
  s_add_u32 m0, s62, 90112
  s_add_u32 s60, s61, 0
  buffer_load_dwordx4 v10, s[12:15], s60 offen offset:0 lds
  v_dot2c_f32_bf16 v100, v228, v228
  v_dot2c_f32_bf16 v101, v229, v229
  v_dot2c_f32_bf16 v102, v230, v230
  v_dot2c_f32_bf16 v103, v231, v231
  v_mfma_f32_16x16x32_bf16 v[96:99], v[124:127], v[228:231], v[96:99]
  v_dot2c_f32_bf16 v100, v232, v232
  v_dot2c_f32_bf16 v101, v233, v233
  v_dot2c_f32_bf16 v102, v234, v234
  v_dot2c_f32_bf16 v103, v235, v235
  v_mfma_f32_16x16x32_bf16 v[96:99], v[124:127], v[232:235], v[96:99]
  ds_read_b64_tr_b16 v[80:81], v2 offset:26624
  ds_read_b64_tr_b16 v[82:83], v2 offset:26880
  ds_read_b64_tr_b16 v[84:85], v2 offset:59392
  ds_read_b64_tr_b16 v[86:87], v2 offset:59648
  v_mfma_f32_32x32x16_bf16 v[16:31], v[88:91], v[220:223], v[16:31]
  v_mfma_f32_32x32x16_bf16 v[32:47], v[220:223], v[92:95], v[32:47]
  s_xor_b32 s61, s59, 7
  s_mul_i32 s61, s61, 196608
  s_add_u32 s61, s61, s58
  s_add_u32 m0, s62, 94208
  s_add_u32 s60, s61, 0
  buffer_load_dwordx4 v10, s[12:15], s60 offen offset:0 lds
  v_dot2c_f32_bf16 v100, v236, v236
  v_dot2c_f32_bf16 v101, v237, v237
  v_dot2c_f32_bf16 v102, v238, v238
  v_dot2c_f32_bf16 v103, v239, v239
  v_mfma_f32_16x16x32_bf16 v[96:99], v[124:127], v[236:239], v[96:99]
  s_waitcnt lgkmcnt(10)
  ds_read_b64_tr_b16 v[88:89], v2 offset:27648
  ds_read_b64_tr_b16 v[90:91], v2 offset:27904
  ds_read_b64_tr_b16 v[92:93], v2 offset:60416
  ds_read_b64_tr_b16 v[94:95], v2 offset:60672
  v_mfma_f32_32x32x16_bf16 v[16:31], v[64:67], v[224:227], v[16:31]
  s_waitcnt lgkmcnt(12)
  v_mfma_f32_32x32x16_bf16 v[32:47], v[224:227], v[68:71], v[32:47]
  s_waitcnt vmcnt(10)
  ds_read_b128 v[240:243], v120 offset:12288
  ds_read_b128 v[244:247], v121 offset:12288
  ds_read_b128 v[248:251], v122 offset:12288
  ds_read_b128 v[252:255], v123 offset:12288
  s_cmp_lg_u32 s56, 0
  s_cbranch_scc1 L18
  s_waitcnt vmcnt(8)
  v_accvgpr_read_b32 v114, a234
  v_cmp_eq_u32 vcc, 0, v114
  s_cbranch_vccnz L19
  v_cmp_ne_u32 vcc, s51, v114
  v_lshlrev_b32 v115, 7, v0
  s_lshl_b32 s97, s4, 2
  s_and_b32 s96, vcc_lo, 0xffff
  s_cselect_b32 s56, 1, 2
  v_mov_b32 v114, s56
  s_mov_b64 exec, 0xffff
  buffer_store_dword v114, v115, s[28:31], s53 offen sc1
  s_mov_b64 exec, 1
  buffer_store_dword v114, off, s[44:47], s97 sc1
  s_mov_b64 exec, -1
  s_branch L18
L19:
  buffer_load_dword a234, v7, s[28:31], s55 offen sc1
L18:
  s_waitcnt vmcnt(8)
  ds_read_b64_tr_b16 v[56:57], v14 offset:28672
  ds_read_b64_tr_b16 v[58:59], v14 offset:28928
  ds_read_b64_tr_b16 v[60:61], v14 offset:61440
  ds_read_b64_tr_b16 v[62:63], v14 offset:61696
  s_barrier
  ds_read_b64_tr_b16 v[64:65], v2 offset:28672
  ds_read_b64_tr_b16 v[66:67], v2 offset:28928
  ds_read_b64_tr_b16 v[68:69], v2 offset:61440
  ds_read_b64_tr_b16 v[70:71], v2 offset:61696
  s_waitcnt lgkmcnt(15)
  v_mfma_f32_32x32x16_bf16 v[16:31], v[72:75], v[228:231], v[16:31]
  v_mfma_f32_32x32x16_bf16 v[32:47], v[228:231], v[76:79], v[32:47]
  s_lshr_b32 s54, s2, 3
  s_lshl_b32 s54, s54, 2
  s_add_u32 s54, s54, s6
  s_mul_i32 s54, s54, 14336
  v_lshlrev_b32 v8, 5, v0
  s_waitcnt lgkmcnt(6)
  v_mfma_f32_16x16x32_bf16 v[104:107], v[124:127], v[56:59], v[104:107]
  s_waitcnt lgkmcnt(4)
  buffer_load_dword a232, v8, s[24:27], s54 offen offset:0
  v_mfma_f32_16x16x32_bf16 v[108:111], v[124:127], v[60:63], v[108:111]
  v_dot2c_f32_bf16 v100, v240, v240
  v_dot2c_f32_bf16 v101, v241, v241
  v_dot2c_f32_bf16 v102, v242, v242
  v_dot2c_f32_bf16 v103, v243, v243
  v_mfma_f32_16x16x32_bf16 v[96:99], v[124:127], v[240:243], v[96:99]
  ds_read_b64_tr_b16 v[72:73], v2 offset:29696
  ds_read_b64_tr_b16 v[74:75], v2 offset:29952
  ds_read_b64_tr_b16 v[76:77], v2 offset:62464
  ds_read_b64_tr_b16 v[78:79], v2 offset:62720
  v_mfma_f32_32x32x16_bf16 v[16:31], v[80:83], v[232:235], v[16:31]
  v_mfma_f32_32x32x16_bf16 v[32:47], v[232:235], v[84:87], v[32:47]
  buffer_load_dword a232, v8, s[24:27], s54 offen offset:2048
  v_dot2c_f32_bf16 v100, v244, v244
  v_dot2c_f32_bf16 v101, v245, v245
  v_dot2c_f32_bf16 v102, v246, v246
  v_dot2c_f32_bf16 v103, v247, v247
  v_mfma_f32_16x16x32_bf16 v[96:99], v[124:127], v[244:247], v[96:99]
  v_dot2c_f32_bf16 v100, v248, v248
  v_dot2c_f32_bf16 v101, v249, v249
  v_dot2c_f32_bf16 v102, v250, v250
  v_dot2c_f32_bf16 v103, v251, v251
  v_mfma_f32_16x16x32_bf16 v[96:99], v[124:127], v[248:251], v[96:99]
  ds_read_b64_tr_b16 v[80:81], v2 offset:30720
  ds_read_b64_tr_b16 v[82:83], v2 offset:30976
  ds_read_b64_tr_b16 v[84:85], v2 offset:63488
  ds_read_b64_tr_b16 v[86:87], v2 offset:63744
  v_cvt_pk_bf16_f32 v106, v104, v104
  v_lshlrev_b32 v105, 16, v106
  v_mfma_f32_32x32x16_bf16 v[16:31], v[88:91], v[236:239], v[16:31]
  v_mfma_f32_32x32x16_bf16 v[32:47], v[236:239], v[92:95], v[32:47]
  s_add_u32 s54, s54, 4096
  buffer_load_dword a232, v8, s[24:27], s54 offen offset:0
  v_dot2c_f32_bf16 v100, v252, v252
  v_dot2c_f32_bf16 v101, v253, v253
  v_dot2c_f32_bf16 v102, v254, v254
  v_dot2c_f32_bf16 v103, v255, v255
  v_mfma_f32_16x16x32_bf16 v[96:99], v[124:127], v[252:255], v[96:99]
  s_waitcnt lgkmcnt(10)
  ds_read_b64_tr_b16 v[88:89], v2 offset:31744
  ds_read_b64_tr_b16 v[90:91], v2 offset:32000
  ds_read_b64_tr_b16 v[92:93], v2 offset:64512
  ds_read_b64_tr_b16 v[94:95], v2 offset:64768
  v_sub_f32 v105, v104, v105
  v_and_b32 v107, 0xffff, v106
  v_cvt_pk_bf16_f32 v106, v104, v105
  v_mfma_f32_32x32x16_bf16 v[16:31], v[64:67], v[240:243], v[16:31]
  s_waitcnt lgkmcnt(12)
  v_mfma_f32_32x32x16_bf16 v[32:47], v[240:243], v[68:71], v[32:47]
  s_waitcnt lgkmcnt(10)
  ds_write_b64 v15, v[106:107] offset:0
  v_cvt_pk_bf16_f32 v110, v108, v108
  v_lshlrev_b32 v109, 16, v110
  v_sub_f32 v109, v108, v109
  v_and_b32 v111, 0xffff, v110
  v_cvt_pk_bf16_f32 v110, v108, v109
  v_mfma_f32_32x32x16_bf16 v[16:31], v[72:75], v[244:247], v[16:31]
  s_waitcnt lgkmcnt(9)
  ds_write_b64 v15, v[110:111] offset:1024
  v_mfma_f32_32x32x16_bf16 v[32:47], v[244:247], v[76:79], v[32:47]
  s_cmp_lg_u32 s56, 0
  s_cbranch_scc1 L21
  s_waitcnt vmcnt(6)
  v_accvgpr_read_b32 v114, a233
  v_cmp_eq_u32 vcc, 0, v114
  s_cbranch_vccnz L22
  v_cmp_ne_u32 vcc, s51, v114
  v_lshlrev_b32 v115, 7, v0
  s_lshl_b32 s97, s4, 2
  s_and_b32 s96, vcc_lo, 0xffff
  s_cselect_b32 s56, 1, 2
  v_mov_b32 v114, s56
  s_mov_b64 exec, 0xffff
  buffer_store_dword v114, v115, s[28:31], s53 offen sc1
  s_mov_b64 exec, 1
  buffer_store_dword v114, off, s[44:47], s97 sc1
  s_mov_b64 exec, -1
L22:
L21:
  s_waitcnt lgkmcnt(8)
  v_mfma_f32_32x32x16_bf16 v[16:31], v[80:83], v[248:251], v[16:31]
  s_waitcnt lgkmcnt(6)
  v_mfma_f32_32x32x16_bf16 v[32:47], v[248:251], v[84:87], v[32:47]
  s_waitcnt lgkmcnt(4)
  v_add_f32 v100, v100, v101
  v_add_f32 v102, v102, v103
  v_add_f32 v100, v100, v102
  v_mov_b32 v101, v100
  s_nop 1
  v_permlane32_swap_b32 v100, v101
  v_mfma_f32_32x32x16_bf16 v[16:31], v[88:91], v[252:255], v[16:31]
  s_waitcnt lgkmcnt(2)
  v_mfma_f32_32x32x16_bf16 v[32:47], v[252:255], v[92:95], v[32:47]
  v_add_f32 v100, v100, v101
  s_waitcnt lgkmcnt(0)
  s_barrier
  v_add_u32 v15, 156160, v1
  ds_read_b128 v[116:119], v15 offset:0
  ds_read_b128 v[120:123], v15 offset:1024
  s_mov_b32 s99, 0x3b000000
  v_mul_f32 v96, 0xbb000000, v96
  v_mul_f32 v101, v96, v96
  v_fma_f32 v100, v100, s99, -v101
  v_cvt_pk_bf16_f32 v112, v96, v96
  v_max_f32 v100, 0, v100
  v_add_f32 v101, 0x3727c5ac, v100
  v_rsq_f32 v13, v101
  v_lshlrev_b32 v102, 16, v112
  v_sub_f32 v102, v96, v102
  v_mov_b32 v114, v112
  v_cvt_pk_bf16_f32 v113, v102, v102
  v_mov_b32 v115, v113
  s_lshl_b32 s96, s6, 7
  s_add_u32 s96, s96, 163328
  v_and_b32 v14, 31, v0
  v_lshl_add_u32 v14, v14, 2, s96
  ds_write_b32 v14, v13
  v_lshrrev_b32 v15, 5, v0
  v_lshl_add_u32 v14, v15, 4, s96
  ds_read_b128 v[96:99], v14 offset:0
  ds_read_b128 v[100:103], v14 offset:32
  ds_read_b128 v[104:107], v14 offset:64
  ds_read_b128 v[108:111], v14 offset:96
  v_lshlrev_b32 v15, 8, v15
  v_and_b32 v14, 0xf0, v1
  v_add_u32 v15, v15, v14
  v_bfe_u32 v14, v0, 4, 1
  v_lshl_add_u32 v15, v14, 11, v15
  s_waitcnt lgkmcnt(6)
  v_mfma_f32_32x32x16_bf16 v[16:31], v[116:119], v[112:115], v[16:31]
  s_waitcnt lgkmcnt(5)
  v_mfma_f32_32x32x16_bf16 v[32:47], v[112:115], v[120:123], v[32:47]
  s_nop 9
  v_pk_mul_f32 v[16:17], v[16:17], v[12:13] op_sel:[0,1]
  v_pk_mul_f32 v[18:19], v[18:19], v[12:13] op_sel:[0,1]
  v_pk_mul_f32 v[20:21], v[20:21], v[12:13] op_sel:[0,1]
  v_pk_mul_f32 v[22:23], v[22:23], v[12:13] op_sel:[0,1]
  v_pk_mul_f32 v[24:25], v[24:25], v[12:13] op_sel:[0,1]
  v_pk_mul_f32 v[26:27], v[26:27], v[12:13] op_sel:[0,1]
  v_pk_mul_f32 v[28:29], v[28:29], v[12:13] op_sel:[0,1]
  v_pk_mul_f32 v[30:31], v[30:31], v[12:13] op_sel:[0,1]
  v_cvt_pk_bf16_f32 v16, v16, v17
  v_cvt_pk_bf16_f32 v17, v18, v19
  v_cvt_pk_bf16_f32 v18, v20, v21
  v_cvt_pk_bf16_f32 v19, v22, v23
  v_cvt_pk_bf16_f32 v20, v24, v25
  v_cvt_pk_bf16_f32 v21, v26, v27
  v_cvt_pk_bf16_f32 v22, v28, v29
  v_cvt_pk_bf16_f32 v23, v30, v31
  s_lshl_b32 s96, s48, 4
  s_add_u32 s96, s96, s5
  s_lshl_b32 s96, s96, 12
  s_add_u32 s96, s96, 1048576
  buffer_store_dwordx4 v[16:19], v1, s[28:31], s96 offen sc1
  buffer_store_dwordx4 v[20:23], v1, s[28:31], s96 offen offset:2048 sc1
  s_waitcnt lgkmcnt(3)
  v_pk_mul_f32 v[32:33], v[32:33], v[96:97]
  v_pk_mul_f32 v[34:35], v[34:35], v[98:99]
  s_waitcnt lgkmcnt(2)
  v_pk_mul_f32 v[36:37], v[36:37], v[100:101]
  v_pk_mul_f32 v[38:39], v[38:39], v[102:103]
  s_waitcnt lgkmcnt(1)
  v_pk_mul_f32 v[40:41], v[40:41], v[104:105]
  v_pk_mul_f32 v[42:43], v[42:43], v[106:107]
  s_waitcnt lgkmcnt(0)
  v_pk_mul_f32 v[44:45], v[44:45], v[108:109]
  v_pk_mul_f32 v[46:47], v[46:47], v[110:111]
  v_cvt_pk_bf16_f32 v32, v32, v33
  v_cvt_pk_bf16_f32 v33, v34, v35
  v_cvt_pk_bf16_f32 v34, v36, v37
  v_cvt_pk_bf16_f32 v35, v38, v39
  v_cvt_pk_bf16_f32 v36, v40, v41
  v_cvt_pk_bf16_f32 v37, v42, v43
  v_cvt_pk_bf16_f32 v38, v44, v45
  v_cvt_pk_bf16_f32 v39, v46, v47
  buffer_store_dwordx4 v[32:35], v15, s[28:31], s96 offen offset:1024 sc1
  buffer_store_dwordx4 v[36:39], v15, s[28:31], s96 offen offset:1536 sc1
  s_mul_i32 s97, s6, 4112
  s_add_u32 s97, s97, 131200
  v_add_u32 v14, s97, v1
  v_add_u32 v15, s97, v15
  ds_write_b128 v14, v[16:19]
  ds_write_b128 v14, v[20:23] offset:2048
  ds_write_b128 v15, v[32:35] offset:1024
  ds_write_b128 v15, v[36:39] offset:1536
  v_mul_f32 v13, 0x3eb8aa3b, v13
  s_buffer_load_dword s57, s[28:31], s53 glc
  s_cmp_lg_u32 s56, 0
  s_cbranch_scc1 L24
  s_mov_b32 s7, 30000
  s_waitcnt vmcnt(7)
  v_accvgpr_read_b32 v116, a234
L26:
  v_cmp_eq_u32 vcc, 0, v116
  s_cbranch_vccnz L25
  v_cmp_ne_u32 vcc, s51, v116
  v_lshlrev_b32 v117, 7, v0
  s_lshl_b32 s97, s4, 2
  s_and_b32 s96, vcc_lo, 0xffff
  s_cselect_b32 s56, 1, 2
  v_mov_b32 v116, s56
  s_mov_b64 exec, 0xffff
  buffer_store_dword v116, v117, s[28:31], s53 offen sc1
  s_mov_b64 exec, 1
  buffer_store_dword v116, off, s[44:47], s97 sc1
  s_mov_b64 exec, -1
L24:
  v_add_u32 v14, s62, v3
  s_lshr_b32 s96, s6, 1
  s_lshl_b32 s96, s96, 9
  s_and_b32 s97, s6, 1
  s_lshl_b32 s97, s97, 3
  s_add_u32 s96, s96, s97
  s_add_u32 s96, s96, 156160
  v_and_b32 v15, 0x1f0, v1
  v_add_u32 v15, s96, v15
  s_waitcnt vmcnt(7)
  ds_read_b64_tr_b16 v[16:17], v14 offset:0
  ds_read_b64_tr_b16 v[18:19], v14 offset:256
  ds_read_b64_tr_b16 v[20:21], v14 offset:4096
  ds_read_b64_tr_b16 v[22:23], v14 offset:4352
  ds_read_b64_tr_b16 v[24:25], v14 offset:8192
  ds_read_b64_tr_b16 v[26:27], v14 offset:8448
  ds_read_b64_tr_b16 v[28:29], v14 offset:12288
  ds_read_b64_tr_b16 v[30:31], v14 offset:12544
  ds_read_b64_tr_b16 v[32:33], v14 offset:16384
  ds_read_b64_tr_b16 v[34:35], v14 offset:16640
  ds_read_b64_tr_b16 v[36:37], v14 offset:20480
  ds_read_b64_tr_b16 v[38:39], v14 offset:20736
  ds_read_b64_tr_b16 v[40:41], v14 offset:24576
  ds_read_b64_tr_b16 v[42:43], v14 offset:24832
  ds_read_b64_tr_b16 v[44:45], v14 offset:28672
  ds_read_b64_tr_b16 v[46:47], v14 offset:28928
  s_barrier
  ds_read_b64_tr_b16 v[64:65], v3 offset:0
  ds_read_b64_tr_b16 v[66:67], v3 offset:256
  ds_read_b64_tr_b16 v[68:69], v3 offset:1024
  ds_read_b64_tr_b16 v[70:71], v3 offset:1280
  ds_read_b64_tr_b16 v[72:73], v3 offset:2048
  ds_read_b64_tr_b16 v[74:75], v3 offset:2304
  ds_read_b64_tr_b16 v[76:77], v3 offset:3072
  ds_read_b64_tr_b16 v[78:79], v3 offset:3328
  ds_read_b64_tr_b16 v[80:81], v3 offset:4096
  ds_read_b64_tr_b16 v[82:83], v3 offset:4352
  ds_read_b64_tr_b16 v[84:85], v3 offset:5120
  ds_read_b64_tr_b16 v[86:87], v3 offset:5376
  s_waitcnt lgkmcnt(15)
  v_mfma_f32_16x16x32_bf16 v[104:107], v[124:127], v[16:19], 0
  v_mfma_f32_16x16x32_bf16 v[104:107], v[124:127], v[20:23], v[104:107]
  v_mfma_f32_16x16x32_bf16 v[104:107], v[124:127], v[24:27], v[104:107]
  v_mfma_f32_16x16x32_bf16 v[104:107], v[124:127], v[28:31], v[104:107]
  v_mfma_f32_16x16x32_bf16 v[104:107], v[124:127], v[32:35], v[104:107]
  v_mfma_f32_16x16x32_bf16 v[104:107], v[124:127], v[36:39], v[104:107]
  s_waitcnt lgkmcnt(14)
  v_mfma_f32_16x16x32_bf16 v[104:107], v[124:127], v[40:43], v[104:107]
  s_waitcnt lgkmcnt(12)
  v_mfma_f32_16x16x32_bf16 v[104:107], v[124:127], v[44:47], v[104:107]
  s_waitcnt lgkmcnt(10)
  ds_read_b64_tr_b16 v[88:89], v3 offset:6144
  ds_read_b64_tr_b16 v[90:91], v3 offset:6400
  v_mfma_f32_32x32x16_bf16 v[48:63], v[64:67], v[128:131], 0
  s_waitcnt lgkmcnt(10)
  ds_read_b64_tr_b16 v[92:93], v3 offset:7168
  ds_read_b64_tr_b16 v[94:95], v3 offset:7424
  v_mfma_f32_32x32x16_bf16 v[48:63], v[68:71], v[132:135], v[48:63]
  s_waitcnt lgkmcnt(10)
  v_cvt_pk_bf16_f32 v106, v104, v104
  v_lshlrev_b32 v105, 16, v106
  v_sub_f32 v105, v104, v105
  v_and_b32 v107, 0xffff, v106
  v_cvt_pk_bf16_f32 v106, v104, v105
  v_mfma_f32_32x32x16_bf16 v[48:63], v[72:75], v[136:139], v[48:63]
  s_waitcnt lgkmcnt(8)
  ds_write_b64 v15, v[106:107] offset:2048
  ds_read_b64_tr_b16 v[64:65], v3 offset:8192
  ds_read_b64_tr_b16 v[66:67], v3 offset:8448
  s_mul_i32 s96, s6, 4112
  s_add_u32 s96, s96, 98304
  v_add_u32 v24, s96, v1
  v_and_b32 v30, 0xf0, v1
  v_lshrrev_b32 v31, 5, v0
  v_lshl_add_u32 v30, v31, 8, v30
  v_add_u32 v30, s96, v30
  v_bfe_i32 v31, v0, 4, 1
  v_mfma_f32_32x32x16_bf16 v[48:63], v[76:79], v[140:143], v[48:63]
  s_waitcnt lgkmcnt(9)
  ds_read_b64_tr_b16 v[68:69], v3 offset:9216
  ds_read_b64_tr_b16 v[70:71], v3 offset:9472
  s_mul_i32 s96, s6, 4112
  s_add_u32 s96, s96, 98304
  s_add_u32 s97, s96, 3072
  v_bfi_b32 v25, v31, s97, v30
  s_add_u32 s97, s96, 2560
  v_bfi_b32 v26, v31, s97, v30
  s_add_u32 s97, s96, 1024
  v_bfi_b32 v27, v31, s97, v30
  s_add_u32 s97, s96, 512
  v_bfi_b32 v28, v31, s97, v30
  v_mfma_f32_32x32x16_bf16 v[48:63], v[80:83], v[144:147], v[48:63]
  ds_read_b64_tr_b16 v[72:73], v3 offset:10240
  ds_read_b64_tr_b16 v[74:75], v3 offset:10496
  s_sub_u32 s96, s48, 8
  s_cselect_b32 s96, 0, s96
  s_cselect_b32 s97, 0x200, -1
  s_cselect_b32 s98, 1073741824, 0
  s_lshl_b32 s96, s96, 4
  s_add_u32 s96, s96, s5
  s_lshl_b32 s96, s96, 12
  s_add_u32 s61, s96, 1048576
  s_add_u32 s62, s61, s98
  v_and_b32 v96, s97, v1
  s_sub_u32 s96, s48, 4
  s_cselect_b32 s96, 0, s96
  s_cselect_b32 s97, 0x200, -1
  s_cselect_b32 s98, 1073741824, 0
  s_lshl_b32 s96, s96, 4
  s_add_u32 s96, s96, s5
  s_lshl_b32 s96, s96, 12
  s_add_u32 s63, s96, 1048576
  s_add_u32 s59, s63, s98
  v_and_b32 v97, s97, v1
  s_waitcnt lgkmcnt(11)
  v_mfma_f32_32x32x16_bf16 v[48:63], v[84:87], v[148:151], v[48:63]
  ds_read_b64_tr_b16 v[76:77], v3 offset:11264
  ds_read_b64_tr_b16 v[78:79], v3 offset:11520
  s_mul_i32 s96, s6, 4112
  s_add_u32 s96, s96, 98304
  v_lshrrev_b32 v30, 2, v0
  v_min_u32 v30, 2, v30
  v_lshlrev_b32 v31, 2, v30
  v_add_u32 v31, s48, v31
  v_cmp_le_u32 vcc, 8, v31
  v_mul_u32_u24 v30, 16448, v30
  v_and_b32 v31, 3, v0
  v_lshl_add_u32 v30, v31, 2, v30
  v_add_u32 v30, s96, v30
  v_mov_b32 v31, 0x3f803f80
  v_cndmask_b32 v31, 0, v31, vcc
  s_waitcnt lgkmcnt(11)
  v_mfma_f32_32x32x16_bf16 v[48:63], v[88:91], v[152:155], v[48:63]
  s_waitcnt lgkmcnt(9)
  ds_write_b32 v30, v31 offset:4096
  ds_read_b64_tr_b16 v[80:81], v3 offset:12288
  ds_read_b64_tr_b16 v[82:83], v3 offset:12544
  ds_read_b64_tr_b16 v[84:85], v3 offset:13312
  ds_read_b64_tr_b16 v[86:87], v3 offset:13568
  v_mfma_f32_32x32x16_bf16 v[48:63], v[92:95], v[156:159], v[48:63]
  s_waitcnt lgkmcnt(11)
  ds_read_b64_tr_b16 v[88:89], v3 offset:14336
  ds_read_b64_tr_b16 v[90:91], v3 offset:14592
  v_accvgpr_read_b32 v32, a240
  v_accvgpr_read_b32 v33, a241
  v_accvgpr_read_b32 v34, a242
  v_accvgpr_read_b32 v35, a243
  v_mfma_f32_32x32x16_bf16 v[48:63], v[64:67], v[160:163], v[48:63]
  s_waitcnt lgkmcnt(0)
  s_barrier
  s_cmp_eq_u32 s57, 0
  s_cbranch_scc1 L27
L28:
  v_add_u32 v15, 156160, v1
  v_mfma_f32_32x32x16_bf16 v[48:63], v[68:71], v[164:167], v[48:63]
  ds_read_b128 v[124:127], v15 offset:2048
  ds_read_b64_tr_b16 v[92:93], v3 offset:15360
  ds_read_b64_tr_b16 v[94:95], v3 offset:15616
  ds_read_b64_tr_b16 v[64:65], v3 offset:16384
  ds_read_b64_tr_b16 v[66:67], v3 offset:16640
  v_accvgpr_read_b32 v36, a244
  v_accvgpr_read_b32 v37, a245
  v_accvgpr_read_b32 v38, a246
  v_accvgpr_read_b32 v39, a247
  v_mfma_f32_32x32x16_bf16 v[48:63], v[72:75], v[168:171], v[48:63]
  s_cmp_eq_u32 s57, 1
  s_cselect_b32 s51, 0, 1
  s_cselect_b32 s96, 7, 2
  s_cselect_b32 s97, 0, 131072
  s_lshl_b32 s52, s52, s96
  s_add_u32 s52, s52, s97
  s_lshl_b32 s53, s4, 6
  s_lshl_b32 s53, s53, s96
  s_add_u32 s53, s53, s97
  buffer_load_dwordx4 v[128:131], v96, s[28:31], s61 offen offset:0 sc1
  buffer_load_dwordx4 v[132:135], v1, s[28:31], s62 offen offset:1024 sc1
  buffer_load_dwordx4 v[136:139], v96, s[28:31], s61 offen offset:2048 sc1
  buffer_load_dwordx4 v[140:143], v1, s[28:31], s62 offen offset:3072 sc1
  ds_read_b64_tr_b16 v[68:69], v3 offset:17408
  ds_read_b64_tr_b16 v[70:71], v3 offset:17664
  v_mfma_f32_32x32x16_bf16 v[48:63], v[76:79], v[172:175], v[48:63]
  s_lshr_b32 s97, s6, 1
  s_lshl_b32 s97, s97, 2
  s_and_b32 s98, s6, 1
  s_lshl_b32 s99, s98, 1
  s_add_u32 s97, s97, s99
  v_and_b32 v99, 14, v0
  v_and_b32 v100, 1, v0
  v_lshl_add_u32 v99, v99, 2, v100
  v_add_u32 v99, s97, v99
  v_lshlrev_b32 v6, s96, v99
  v_mfma_f32_32x32x16_bf16 v[48:63], v[80:83], v[176:179], v[48:63]
  buffer_load_dwordx4 v[144:147], v97, s[28:31], s63 offen offset:0 sc1
  buffer_load_dwordx4 v[148:151], v1, s[28:31], s59 offen offset:1024 sc1
  buffer_load_dwordx4 v[152:155], v97, s[28:31], s63 offen offset:2048 sc1
  buffer_load_dwordx4 v[156:159], v1, s[28:31], s59 offen offset:3072 sc1
  ds_read_b64_tr_b16 v[72:73], v3 offset:18432
  ds_read_b64_tr_b16 v[74:75], v3 offset:18688
  s_lshl_b32 s98, s98, 5
  s_and_b32 s97, s49, 3
  s_add_u32 s97, s97, s98
  v_and_b32 v99, 7, v0
  v_lshl_add_u32 v99, v99, 2, s97
  v_lshlrev_b32 v7, s96, v99
  v_mfma_f32_32x32x16_bf16 v[48:63], v[84:87], v[180:183], v[48:63]
  ds_read_b64_tr_b16 v[76:77], v3 offset:19456
  ds_read_b64_tr_b16 v[78:79], v3 offset:19712
  s_lshr_b32 s97, s6, 1
  s_mul_i32 s97, s97, 28
  s_and_b32 s98, s49, 2
  s_add_u32 s97, s97, s98
  v_bfe_u32 v99, v0, 1, 3
  v_min_u32 v99, 6, v99
  v_lshl_add_u32 v99, v99, 2, v100
  v_add_u32 v99, s97, v99
  v_lshlrev_b32 v8, s96, v99
  v_mfma_f32_32x32x16_bf16 v[48:63], v[88:91], v[184:187], v[48:63]
  s_waitcnt lgkmcnt(10)
  ds_read_b64_tr_b16 v[80:81], v3 offset:20480
  ds_read_b64_tr_b16 v[82:83], v3 offset:20736
  v_mfma_f32_32x32x16_bf16 v[48:63], v[124:127], v[112:115], v[48:63]
  s_waitcnt lgkmcnt(10)
  v_and_b32 v21, 31, v0
  v_lshrrev_b32 v22, 5, v0
  v_lshlrev_b32 v21, 10, v21
  v_lshlrev_b32 v22, 4, v22
  v_add_u32 v21, v21, v22
  s_lshl_b32 s96, s49, 15
  s_lshl_b32 s97, s50, 6
  s_add_u32 s96, s96, s97
  buffer_load_dwordx4 a[224:227], v21, s[8:11], s96 offen
  buffer_load_dwordx4 a[228:231], v21, s[8:11], s96 offen offset:32
  buffer_load_dwordx4 a[248:251], v22, s[36:39], s97 offen
  buffer_load_dwordx4 a[252:255], v22, s[36:39], s97 offen offset:32
  ds_read_b64_tr_b16 v[84:85], v3 offset:21504
  ds_read_b64_tr_b16 v[86:87], v3 offset:21760
  v_mfma_f32_32x32x16_bf16 v[48:63], v[92:95], v[188:191], v[48:63]
  s_waitcnt lgkmcnt(10)
  v_lshlrev_b32 v23, 5, v0
  v_mfma_f32_32x32x16_bf16 v[48:63], v[64:67], v[192:195], v[48:63]
  s_waitcnt lgkmcnt(8)
  buffer_load_dword a232, v23, s[24:27], s54 offen offset:2048
  ds_read_b64_tr_b16 v[88:89], v3 offset:22528
  ds_read_b64_tr_b16 v[90:91], v3 offset:22784
  s_add_u32 s54, s54, 4096
  buffer_load_dword a232, v23, s[24:27], s54 offen offset:0
  ds_read_b64_tr_b16 v[92:93], v3 offset:23552
  ds_read_b64_tr_b16 v[94:95], v3 offset:23808
  v_mfma_f32_32x32x16_bf16 v[48:63], v[68:71], v[196:199], v[48:63]
  s_waitcnt lgkmcnt(10)
  buffer_load_dword a232, v23, s[24:27], s54 offen offset:2048
  ds_read_b64_tr_b16 v[64:65], v3 offset:24576
  ds_read_b64_tr_b16 v[66:67], v3 offset:24832
  v_mfma_f32_32x32x16_bf16 v[48:63], v[72:75], v[200:203], v[48:63]
  s_add_u32 s54, s54, 4096
  buffer_load_dword a232, v23, s[24:27], s54 offen offset:0
  ds_read_b64_tr_b16 v[68:69], v3 offset:25600
  ds_read_b64_tr_b16 v[70:71], v3 offset:25856
  s_waitcnt lgkmcnt(12)
  v_mfma_f32_32x32x16_bf16 v[48:63], v[76:79], v[204:207], v[48:63]
  s_lshr_b32 s54, s2, 3
  s_lshl_b32 s54, s54, 2
  s_add_u32 s54, s54, s6
  s_mul_i32 s54, s54, 4096
  v_lshlrev_b32 v23, 5, v0
  s_waitcnt lgkmcnt(10)
  v_mfma_f32_32x32x16_bf16 v[48:63], v[80:83], v[208:211], v[48:63]
  s_waitcnt lgkmcnt(8)
  buffer_load_dword a232, v23, s[16:19], s54 offen offset:0
  ds_read_b64_tr_b16 v[72:73], v3 offset:26624
  ds_read_b64_tr_b16 v[74:75], v3 offset:26880
  buffer_load_dword a232, v23, s[16:19], s54 offen offset:2048
  ds_read_b64_tr_b16 v[76:77], v3 offset:27648
  ds_read_b64_tr_b16 v[78:79], v3 offset:27904
  v_mfma_f32_32x32x16_bf16 v[48:63], v[84:87], v[212:215], v[48:63]
  s_waitcnt lgkmcnt(10)
  ds_read_b64_tr_b16 v[80:81], v3 offset:28672
  ds_read_b64_tr_b16 v[82:83], v3 offset:28928
  v_mfma_f32_32x32x16_bf16 v[48:63], v[88:91], v[216:219], v[48:63]
  s_waitcnt lgkmcnt(10)
  ds_read_b64_tr_b16 v[84:85], v3 offset:29696
  ds_read_b64_tr_b16 v[86:87], v3 offset:29952
  v_mfma_f32_32x32x16_bf16 v[48:63], v[92:95], v[220:223], v[48:63]
  s_waitcnt lgkmcnt(10)
  ds_read_b64_tr_b16 v[88:89], v3 offset:30720
  ds_read_b64_tr_b16 v[90:91], v3 offset:30976
  v_mfma_f32_32x32x16_bf16 v[48:63], v[64:67], v[224:227], v[48:63]
  s_waitcnt lgkmcnt(10)
  ds_read_b64_tr_b16 v[92:93], v3 offset:31744
  ds_read_b64_tr_b16 v[94:95], v3 offset:32000
  v_mfma_f32_32x32x16_bf16 v[48:63], v[68:71], v[228:231], v[48:63]
  s_waitcnt lgkmcnt(10)
  v_mfma_f32_32x32x16_bf16 v[48:63], v[72:75], v[232:235], v[48:63]
  s_waitcnt lgkmcnt(8)
  ds_read_b128 v[192:195], v24 offset:32896
  ds_read_b128 v[196:199], v24 offset:34944
  ds_read_b128 v[112:115], v25 offset:33920
  ds_read_b128 v[116:119], v26 offset:34432
  ds_read_b128 v[200:203], v27 offset:35968
  ds_read_b128 v[204:207], v28 offset:36480
  v_mfma_f32_32x32x16_bf16 v[48:63], v[76:79], v[236:239], v[48:63]
  s_waitcnt lgkmcnt(12)
  v_mfma_f32_32x32x16_bf16 v[48:63], v[80:83], v[240:243], v[48:63]
  s_waitcnt lgkmcnt(10)
  v_mfma_f32_32x32x16_bf16 v[48:63], v[84:87], v[244:247], v[48:63]
  s_waitcnt lgkmcnt(8)
  v_mfma_f32_32x32x16_bf16 v[48:63], v[88:91], v[248:251], v[48:63]
  s_waitcnt lgkmcnt(6)
  v_mfma_f32_32x32x16_bf16 v[48:63], v[92:95], v[252:255], v[48:63]
  s_waitcnt lgkmcnt(5)
  s_nop 10
  v_pk_mul_f32 v[48:49], v[48:49], v[12:13] op_sel:[0,1]
  v_pk_mul_f32 v[50:51], v[50:51], v[12:13] op_sel:[0,1]
  v_pk_mul_f32 v[52:53], v[52:53], v[12:13] op_sel:[0,1]
  v_pk_mul_f32 v[54:55], v[54:55], v[12:13] op_sel:[0,1]
  v_cvt_pk_bf16_f32 v16, v48, v49
  v_cvt_pk_bf16_f32 v17, v50, v51
  v_cvt_pk_bf16_f32 v18, v52, v53
  v_cvt_pk_bf16_f32 v19, v54, v55
  s_nop 1
  v_mfma_f32_32x32x16_bf16 v[160:175], v[192:195], v[16:19], 0
  s_waitcnt lgkmcnt(4)
  v_pk_mul_f32 v[56:57], v[56:57], v[12:13] op_sel:[0,1]
  v_pk_mul_f32 v[58:59], v[58:59], v[12:13] op_sel:[0,1]
  v_pk_mul_f32 v[60:61], v[60:61], v[12:13] op_sel:[0,1]
  v_pk_mul_f32 v[62:63], v[62:63], v[12:13] op_sel:[0,1]
  v_cvt_pk_bf16_f32 v20, v56, v57
  v_cvt_pk_bf16_f32 v21, v58, v59
  v_cvt_pk_bf16_f32 v22, v60, v61
  v_cvt_pk_bf16_f32 v23, v62, v63
  s_nop 1
  v_mfma_f32_32x32x16_bf16 v[176:191], v[196:199], v[20:23], 0
  s_lshl_b32 s54, s48, 4
  s_add_u32 s54, s54, s5
  s_lshl_b32 s54, s54, 11
  s_add_u32 s54, s54, 5242880
  s_mov_b32 s7, 20000
L31:
  s_waitcnt vmcnt(17)
  v_mfma_f32_32x32x16_bf16 v[64:79], v[128:131], v[16:19], 0
  ds_write_b128 v24, v[128:131] offset:0
  s_waitcnt vmcnt(16)
  ds_write_b128 v24, v[132:135] offset:1024
  v_max3_u32 v14, v128, v129, v130
  v_max_u32 v14, v14, v131
  v_max3_u32 v14, v14, v132, v133
  v_max3_u32 v14, v14, v134, v135
  s_waitcnt vmcnt(15)
  v_mfma_f32_32x32x16_bf16 v[80:95], v[136:139], v[20:23], 0
  ds_write_b128 v24, v[136:139] offset:2048
  s_waitcnt vmcnt(14)
  ds_write_b128 v24, v[140:143] offset:3072
  ds_read_b128 v[120:123], v25 offset:1024
  ds_read_b128 v[124:127], v26 offset:1536
  ds_read_b128 v[208:211], v27 offset:3072
  ds_read_b128 v[212:215], v28 offset:3584
  s_waitcnt vmcnt(13)
  ds_write_b128 v24, v[144:147] offset:16448
  s_waitcnt vmcnt(12)
  ds_write_b128 v24, v[148:151] offset:17472
  s_waitcnt vmcnt(11)
  ds_write_b128 v24, v[152:155] offset:18496
  s_waitcnt vmcnt(10)
  ds_write_b128 v24, v[156:159] offset:19520
  v_max3_u32 v14, v14, v136, v137
  v_max3_u32 v14, v14, v138, v139
  v_max3_u32 v14, v14, v140, v141
  v_max3_u32 v14, v14, v142, v143
  v_max3_u32 v14, v14, v144, v145
  v_max3_u32 v14, v14, v146, v147
  v_max3_u32 v14, v14, v148, v149
  v_max3_u32 v14, v14, v150, v151
  v_max3_u32 v14, v14, v152, v153
  v_max3_u32 v14, v14, v154, v155
  v_max3_u32 v14, v14, v156, v157
  v_max3_u32 v14, v14, v158, v159
  v_cmp_eq_u32 vcc, -1, v14
  s_cbranch_vccnz L33
L32:
  v_mfma_f32_32x32x16_bf16 v[96:111], v[144:147], v[16:19], 0
  v_cndmask_b32_e64 v64, v64, v160, s[64:65]
  v_cndmask_b32_e64 v65, v65, v161, s[66:67]
  v_cndmask_b32_e64 v66, v66, v162, s[68:69]
  v_cndmask_b32_e64 v67, v67, v163, s[70:71]
  v_cndmask_b32_e64 v68, v68, v164, s[72:73]
  v_cndmask_b32_e64 v69, v69, v165, s[74:75]
  v_cndmask_b32_e64 v70, v70, v166, s[76:77]
  v_cndmask_b32_e64 v71, v71, v167, s[78:79]
  v_cndmask_b32_e64 v72, v72, v168, s[80:81]
  v_cndmask_b32_e64 v73, v73, v169, s[82:83]
  v_cndmask_b32_e64 v74, v74, v170, s[84:85]
  v_cndmask_b32_e64 v75, v75, v171, s[86:87]
  v_cndmask_b32_e64 v76, v76, v172, s[88:89]
  v_cndmask_b32_e64 v77, v77, v173, s[90:91]
  v_cndmask_b32_e64 v78, v78, v174, s[92:93]
  v_cndmask_b32_e64 v79, v79, v175, s[94:95]
  v_exp_f32 v64, v64
  v_exp_f32 v65, v65
  v_exp_f32 v66, v66
  v_exp_f32 v67, v67
  v_exp_f32 v68, v68
  v_exp_f32 v69, v69
  v_exp_f32 v70, v70
  v_exp_f32 v71, v71
  v_exp_f32 v72, v72
  v_exp_f32 v73, v73
  v_exp_f32 v74, v74
  v_exp_f32 v75, v75
  v_exp_f32 v76, v76
  v_exp_f32 v77, v77
  v_exp_f32 v78, v78
  v_exp_f32 v79, v79
  v_cvt_pk_bf16_f32 v64, v64, v65
  v_cvt_pk_bf16_f32 v65, v66, v67
  v_cvt_pk_bf16_f32 v66, v68, v69
  v_cvt_pk_bf16_f32 v67, v70, v71
  v_cvt_pk_bf16_f32 v68, v72, v73
  v_cvt_pk_bf16_f32 v69, v74, v75
  v_cvt_pk_bf16_f32 v70, v76, v77
  v_cvt_pk_bf16_f32 v71, v78, v79
  v_and_b32 v72, v64, v32
  v_xor_b32 v64, v64, v72
  v_and_b32 v73, v65, v33
  v_xor_b32 v65, v65, v73
  v_and_b32 v74, v66, v34
  v_xor_b32 v66, v66, v74
  v_and_b32 v75, v67, v35
  v_xor_b32 v67, v67, v75
  v_and_b32 v76, v68, v36
  v_xor_b32 v68, v68, v76
  v_and_b32 v77, v69, v37
  v_xor_b32 v69, v69, v77
  v_and_b32 v78, v70, v38
  v_xor_b32 v70, v70, v78
  v_and_b32 v79, v71, v39
  v_xor_b32 v71, v71, v79
  s_waitcnt lgkmcnt(0)
  s_barrier
  v_mfma_f32_32x32x16_bf16 v[224:239], v[112:115], v[72:75], 0
  s_mul_i32 s62, s6, 16384
  s_add_u32 m0, s62, 0
  s_add_u32 s60, s3, 0
  buffer_load_dwordx4 v12, s[24:27], s60 offen offset:0 lds
  s_add_u32 s60, s3, 7168
  buffer_load_dwordx4 v12, s[24:27], s60 offen offset:1024 lds
  v_cndmask_b32_e64 v80, v80, v176, s[64:65]
  v_cndmask_b32_e64 v81, v81, v177, s[66:67]
  v_cndmask_b32_e64 v82, v82, v178, s[68:69]
  v_cndmask_b32_e64 v83, v83, v179, s[70:71]
  v_cndmask_b32_e64 v84, v84, v180, s[72:73]
  v_cndmask_b32_e64 v85, v85, v181, s[74:75]
  v_cndmask_b32_e64 v86, v86, v182, s[76:77]
  v_mfma_f32_32x32x16_bf16 v[224:239], v[116:119], v[76:79], v[224:239]
  s_add_u32 s60, s3, 129024
  buffer_load_dwordx4 v12, s[24:27], s60 offen offset:2048 lds
  v_cndmask_b32_e64 v87, v87, v183, s[78:79]
  v_cndmask_b32_e64 v88, v88, v184, s[80:81]
  v_cndmask_b32_e64 v89, v89, v185, s[82:83]
  v_cndmask_b32_e64 v90, v90, v186, s[84:85]
  v_cndmask_b32_e64 v91, v91, v187, s[86:87]
  v_cndmask_b32_e64 v92, v92, v188, s[88:89]
  v_cndmask_b32_e64 v93, v93, v189, s[90:91]
  v_mfma_f32_32x32x16_bf16 v[224:239], v[120:123], v[64:67], v[224:239]
  ds_read_b128 v[216:219], v25 offset:17472
  s_add_u32 s60, s3, 136192
  buffer_load_dwordx4 v12, s[24:27], s60 offen offset:3072 lds
  v_cndmask_b32_e64 v94, v94, v190, s[92:93]
  v_cndmask_b32_e64 v95, v95, v191, s[94:95]
  v_exp_f32 v80, v80
  v_exp_f32 v81, v81
  v_mfma_f32_32x32x16_bf16 v[224:239], v[124:127], v[68:71], v[224:239]
  ds_read_b128 v[220:223], v26 offset:17984
  v_exp_f32 v82, v82
  s_add_u32 m0, s62, 4096
  s_add_u32 s60, s3, 262144
  buffer_load_dwordx4 v12, s[24:27], s60 offen offset:0 lds
  v_exp_f32 v83, v83
  v_exp_f32 v84, v84
  v_mfma_f32_32x32x16_bf16 v[64:79], v[152:155], v[20:23], 0
  ds_read_b128 v[40:43], v24 offset:4112
  s_add_u32 s60, s3, 269312
  buffer_load_dwordx4 v12, s[24:27], s60 offen offset:1024 lds
  s_add_u32 s60, s3, 391168
  buffer_load_dwordx4 v12, s[24:27], s60 offen offset:2048 lds
  s_add_u32 s60, s3, 398336
  buffer_load_dwordx4 v12, s[24:27], s60 offen offset:3072 lds
  v_exp_f32 v85, v85
  v_exp_f32 v86, v86
  v_exp_f32 v87, v87
  v_exp_f32 v88, v88
  v_exp_f32 v89, v89
  v_exp_f32 v90, v90
  v_exp_f32 v91, v91
  v_exp_f32 v92, v92
  v_exp_f32 v93, v93
  v_exp_f32 v94, v94
  v_exp_f32 v95, v95
  s_add_u32 m0, s62, 8192
  s_add_u32 s60, s3, 524288
  buffer_load_dwordx4 v12, s[24:27], s60 offen offset:0 lds
  s_add_u32 s60, s3, 531456
  buffer_load_dwordx4 v12, s[24:27], s60 offen offset:1024 lds
  v_cvt_pk_bf16_f32 v80, v80, v81
  v_cvt_pk_bf16_f32 v81, v82, v83
  v_cvt_pk_bf16_f32 v82, v84, v85
  v_cvt_pk_bf16_f32 v83, v86, v87
  v_cvt_pk_bf16_f32 v84, v88, v89
  v_cvt_pk_bf16_f32 v85, v90, v91
  v_cvt_pk_bf16_f32 v86, v92, v93
  v_cvt_pk_bf16_f32 v87, v94, v95
  v_and_b32 v88, v80, v32
  v_xor_b32 v80, v80, v88
  v_and_b32 v89, v81, v33
  v_xor_b32 v81, v81, v89
  v_and_b32 v90, v82, v34
  v_xor_b32 v82, v82, v90
  v_and_b32 v91, v83, v35
  s_add_u32 s60, s3, 653312
  buffer_load_dwordx4 v12, s[24:27], s60 offen offset:2048 lds
  v_xor_b32 v83, v83, v91
  v_and_b32 v92, v84, v36
  v_xor_b32 v84, v84, v92
  v_and_b32 v93, v85, v37
  v_xor_b32 v85, v85, v93
  v_and_b32 v94, v86, v38
  v_xor_b32 v86, v86, v94
  s_lshl_b32 s96, s4, 4
  s_add_u32 s96, s96, s5
  s_lshl_b32 s96, s96, 2
  s_add_u32 s96, s96, s6
  s_lshl_b32 s96, s96, 9
  s_add_u32 s96, s96, 20971520
  v_and_b32 v14, 0x180, v1
  v_and_b32 v95, v87, v39
  v_xor_b32 v87, v87, v95
  v_mfma_f32_32x32x16_bf16 v[240:255], v[200:203], v[88:91], 0
  buffer_load_dword a232, v14, s[28:31], s96 offen sc1
  s_add_u32 s60, s3, 660480
  buffer_load_dwordx4 v12, s[24:27], s60 offen offset:3072 lds
  v_exp_f32 v96, v96
  v_exp_f32 v97, v97
  s_add_u32 m0, s62, 12288
  s_add_u32 s60, s3, 786432
  buffer_load_dwordx4 v12, s[24:27], s60 offen offset:0 lds
  v_exp_f32 v98, v98
  v_exp_f32 v99, v99
  v_mfma_f32_32x32x16_bf16 v[240:255], v[204:207], v[92:95], v[240:255]
  s_add_u32 s60, s3, 793600
  buffer_load_dwordx4 v12, s[24:27], s60 offen offset:1024 lds
  v_exp_f32 v100, v100
  v_exp_f32 v101, v101
  v_exp_f32 v102, v102
  v_exp_f32 v103, v103
  v_mfma_f32_32x32x16_bf16 v[240:255], v[208:211], v[80:83], v[240:255]
  ds_read_b128 v[112:115], v27 offset:19520
  s_add_u32 s60, s3, 30720
  buffer_load_dwordx4 v12, s[24:27], s60 offen offset:2048 lds
  s_add_u32 s60, s3, 37888
  buffer_load_dwordx4 v12, s[24:27], s60 offen offset:3072 lds
  v_exp_f32 v104, v104
  v_exp_f32 v105, v105
  v_exp_f32 v106, v106
  v_mfma_f32_32x32x16_bf16 v[240:255], v[212:215], v[84:87], v[240:255]
  ds_read_b128 v[116:119], v28 offset:20032
  v_exp_f32 v107, v107
  v_exp_f32 v108, v108
  s_mul_i32 s62, s6, 8192
  s_add_u32 m0, s62, 65536
  s_add_u32 s60, s3, 163840
  buffer_load_dwordx4 v12, s[24:27], s60 offen offset:0 lds
  v_exp_f32 v109, v109
  s_lshr_b32 s96, s2, 3
  s_lshl_b32 s96, s96, 2
  s_add_u32 s96, s96, s6
  s_lshl_b32 s96, s96, 8
  v_and_b32 v14, 0x80, v1
  v_add_u32 v14, s96, v14
  v_add_u32 v14, L_p3_0-L34, v14
  v_min_u32 v14, L_p1_1-L34, v14
  s_getpc_b64 s[96:97]
L34:
  global_load_dword a232, v14, s[96:97]
  s_waitcnt lgkmcnt(2)
  v_mfma_f32_32x32x16_bf16 v[80:95], v[40:43], v[16:19], 0
  ds_read_b128 v[44:47], v24 offset:8224
  s_add_u32 s60, s3, 171008
  buffer_load_dwordx4 v12, s[24:27], s60 offen offset:1024 lds
  s_add_u32 s60, s3, 292864
  buffer_load_dwordx4 v12, s[24:27], s60 offen offset:2048 lds
  v_exp_f32 v110, v110
  v_exp_f32 v111, v111
  v_cvt_pk_bf16_f32 v96, v96, v97
  v_cvt_pk_bf16_f32 v97, v98, v99
  v_cvt_pk_bf16_f32 v98, v100, v101
  v_cvt_pk_bf16_f32 v99, v102, v103
  v_cvt_pk_bf16_f32 v100, v104, v105
  v_cvt_pk_bf16_f32 v101, v106, v107
  v_cvt_pk_bf16_f32 v102, v108, v109
  v_cvt_pk_bf16_f32 v103, v110, v111
  v_mfma_f32_32x32x16_bf16 v[224:239], v[216:219], v[96:99], v[224:239]
  ds_read_b128 v[120:123], v25 offset:5136
  s_add_u32 s60, s3, 300032
  buffer_load_dwordx4 v12, s[24:27], s60 offen offset:3072 lds
  v_exp_f32 v64, v64
  v_exp_f32 v65, v65
  v_exp_f32 v66, v66
  v_mfma_f32_32x32x16_bf16 v[224:239], v[220:223], v[100:103], v[224:239]
  ds_read_b128 v[124:127], v26 offset:5648
  v_exp_f32 v67, v67
  s_add_u32 m0, s62, 69632
  s_add_u32 s60, s3, 425984
  buffer_load_dwordx4 v12, s[24:27], s60 offen offset:0 lds
  v_exp_f32 v68, v68
  v_exp_f32 v69, v69
  s_waitcnt lgkmcnt(2)
  v_mfma_f32_32x32x16_bf16 v[96:111], v[44:47], v[16:19], 0
  ds_read_b128 v[48:51], v24 offset:12336
  s_add_u32 s60, s3, 433152
  buffer_load_dwordx4 v12, s[24:27], s60 offen offset:1024 lds
  s_add_u32 s60, s3, 555008
  buffer_load_dwordx4 v12, s[24:27], s60 offen offset:2048 lds
  s_add_u32 s60, s3, 562176
  buffer_load_dwordx4 v12, s[24:27], s60 offen offset:3072 lds
  s_lshr_b32 s98, s2, 3
  s_lshl_b32 s98, s98, 2
  s_add_u32 s98, s98, s6
  s_mul_i32 s98, s98, 14336
  v_exp_f32 v70, v70
  v_exp_f32 v71, v71
  v_exp_f32 v72, v72
  v_exp_f32 v73, v73
  v_exp_f32 v74, v74
  v_exp_f32 v75, v75
  v_exp_f32 v76, v76
  v_exp_f32 v77, v77
  v_lshlrev_b32 v14, 7, v0
  s_bitcmp1_b32 s2, 3
  s_cselect_b32 s98, s98, 1073741824
  buffer_load_dword a232, v14, s[20:23], s98 offen offset:0
  v_exp_f32 v78, v78
  v_exp_f32 v79, v79
  v_cvt_pk_bf16_f32 v64, v64, v65
  v_cvt_pk_bf16_f32 v65, v66, v67
  v_cvt_pk_bf16_f32 v66, v68, v69
  s_mul_i32 s62, s6, 2048
  s_add_u32 m0, s62, 147648
  s_add_u32 s60, s3, 688128
  buffer_load_dwordx4 v12, s[24:27], s60 offen offset:0 lds
  s_add_u32 s98, s98, 6144
  buffer_load_dword a232, v14, s[20:23], s98 offen offset:0
  v_cvt_pk_bf16_f32 v67, v70, v71
  v_cvt_pk_bf16_f32 v68, v72, v73
  v_cvt_pk_bf16_f32 v69, v74, v75
  v_cvt_pk_bf16_f32 v70, v76, v77
  v_cvt_pk_bf16_f32 v71, v78, v79
  v_mfma_f32_32x32x16_bf16 v[240:255], v[112:115], v[64:67], v[240:255]
  ds_read_b128 v[200:203], v25 offset:9248
  s_add_u32 s60, s3, 695296
  buffer_load_dwordx4 v12, s[24:27], s60 offen offset:1024 lds
  v_exp_f32 v80, v80
  v_exp_f32 v81, v81
  v_exp_f32 v82, v82
  v_mfma_f32_32x32x16_bf16 v[240:255], v[116:119], v[68:71], v[240:255]
  ds_read_b128 v[204:207], v26 offset:9760
  v_exp_f32 v83, v83
  v_exp_f32 v84, v84
  v_exp_f32 v85, v85
  s_waitcnt lgkmcnt(2)
  v_mfma_f32_32x32x16_bf16 v[64:79], v[48:51], v[16:19], 0
  ds_read_b128 v[52:55], v24 offset:20560
  v_exp_f32 v86, v86
  v_exp_f32 v87, v87
  v_exp_f32 v88, v88
  v_exp_f32 v89, v89
  v_exp_f32 v90, v90
  v_exp_f32 v91, v91
  v_exp_f32 v92, v92
  v_exp_f32 v93, v93
  v_exp_f32 v94, v94
  v_exp_f32 v95, v95
  v_cvt_pk_bf16_f32 v80, v80, v81
  v_cvt_pk_bf16_f32 v81, v82, v83
  v_cvt_pk_bf16_f32 v82, v84, v85
  v_cvt_pk_bf16_f32 v83, v86, v87
  v_cvt_pk_bf16_f32 v84, v88, v89
  v_cvt_pk_bf16_f32 v85, v90, v91
  v_cvt_pk_bf16_f32 v86, v92, v93
  s_mul_i32 s96, s6, 16384
  s_add_u32 s96, s96, 0
  v_add_u32 v13, s96, v4
  s_waitcnt vmcnt(13)
  v_cvt_pk_bf16_f32 v87, v94, v95
  v_mfma_f32_32x32x16_bf16 v[224:239], v[120:123], v[80:83], v[224:239]
  ds_read_b128 v[208:211], v25 offset:13360
  v_exp_f32 v96, v96
  s_lshl_b32 s96, s4, 15
  s_add_u32 s96, s96, 20971520
  s_cmp_eq_u32 s51, 0
  s_cselect_b32 s96, 1073741824, s96
  s_and_b32 s97, s49, 3
  s_lshl_b32 s97, s97, 13
  s_add_u32 s97, s97, s96
  s_and_b32 s98, s6, 1
  s_lshl_b32 s99, s98, 12
  s_add_u32 s36, s97, s99
  s_lshl_b32 s99, s98, 8
  s_add_u32 s37, s97, s99
  s_add_u32 s9, s97, s50
  s_sub_u32 s9, s9, 16711680
  s_lshl_b32 s99, s6, 13
  s_add_u32 s38, s96, s99
  s_buffer_load_dword s44, s[28:31], s38 offset:7680
  ds_read_b64_tr_b16 a[0:1], v13 offset:0
  ds_read_b64_tr_b16 a[2:3], v13 offset:256
  ds_read_b64_tr_b16 a[4:5], v13 offset:512
  ds_read_b64_tr_b16 a[6:7], v13 offset:768
  v_exp_f32 v97, v97
  v_exp_f32 v98, v98
  v_mfma_f32_32x32x16_bf16 v[224:239], v[124:127], v[84:87], v[224:239]
  ds_read_b128 v[212:215], v26 offset:13872
  ds_read_b64_tr_b16 a[8:9], v13 offset:2048
  ds_read_b64_tr_b16 a[10:11], v13 offset:2304
  ds_read_b64_tr_b16 a[12:13], v13 offset:2560
  ds_read_b64_tr_b16 a[14:15], v13 offset:2816
  s_lshr_b32 s97, s5, 3
  s_lshl_b32 s97, s97, 12
  s_and_b32 s98, s5, 7
  s_add_u32 s97, s97, s98
  s_add_u32 s8, s38, s97
  s_sub_u32 s8, s8, 16711680
  s_cmp_ge_u32 s5, 7
  s_cselect_b32 s97, 8178, 0
  s_lshl_b32 s98, s5, 1
  s_add_u32 s97, s97, s98
  s_and_b32 s98, s6, 1
  s_add_u32 s97, s97, s98
  s_andn2_b32 s98, s38, 8192
  s_add_u32 s97, s97, s98
  s_sub_u32 s10, s97, 16711680
  s_cmp_ge_u32 s5, 14
  s_cselect_b32 s10, 1073741824, s10
  v_exp_f32 v99, v99
  v_exp_f32 v100, v100
  v_exp_f32 v101, v101
  s_waitcnt lgkmcnt(10)
  v_mfma_f32_32x32x16_bf16 v[80:95], v[52:55], v[16:19], 0
  ds_read_b128 v[40:43], v24 offset:24672
  ds_read_b64_tr_b16 a[16:17], v13 offset:4096
  ds_read_b64_tr_b16 a[18:19], v13 offset:4352
  ds_read_b64_tr_b16 a[20:21], v13 offset:4608
  ds_read_b64_tr_b16 a[22:23], v13 offset:4864
  ds_read_b64_tr_b16 a[24:25], v13 offset:6144
  ds_read_b64_tr_b16 a[26:27], v13 offset:6400
  ds_read_b64_tr_b16 a[28:29], v13 offset:6656
  ds_read_b64_tr_b16 a[30:31], v13 offset:6912
  ds_read_b64_tr_b16 a[32:33], v13 offset:8192
  ds_read_b64_tr_b16 a[34:35], v13 offset:8448
  v_exp_f32 v102, v102
  v_exp_f32 v103, v103
  v_exp_f32 v104, v104
  v_exp_f32 v105, v105
  v_exp_f32 v106, v106
  v_exp_f32 v107, v107
  v_exp_f32 v108, v108
  v_exp_f32 v109, v109
  v_exp_f32 v110, v110
  v_exp_f32 v111, v111
  v_cvt_pk_bf16_f32 v96, v96, v97
  v_cvt_pk_bf16_f32 v97, v98, v99
  v_cvt_pk_bf16_f32 v98, v100, v101
  v_cvt_pk_bf16_f32 v99, v102, v103
  v_cvt_pk_bf16_f32 v100, v104, v105
  v_cvt_pk_bf16_f32 v101, v106, v107
  v_cvt_pk_bf16_f32 v102, v108, v109
  v_cvt_pk_bf16_f32 v103, v110, v111
  v_mfma_f32_32x32x16_bf16 v[224:239], v[200:203], v[96:99], v[224:239]
  ds_read_b64_tr_b16 a[36:37], v13 offset:8704
  ds_read_b64_tr_b16 a[38:39], v13 offset:8960
  ds_read_b128 v[216:219], v25 offset:21584
  ds_read_b64_tr_b16 a[40:41], v13 offset:10240
  ds_read_b64_tr_b16 a[42:43], v13 offset:10496
  ds_read_b64_tr_b16 a[44:45], v13 offset:10752
  ds_read_b64_tr_b16 a[46:47], v13 offset:11008
  v_exp_f32 v64, v64
  v_exp_f32 v65, v65
  v_exp_f32 v66, v66
  v_mfma_f32_32x32x16_bf16 v[224:239], v[204:207], v[100:103], v[224:239]
  s_waitcnt lgkmcnt(10)
  ds_read_b128 v[220:223], v26 offset:22096
  ds_read_b64_tr_b16 a[48:49], v13 offset:12288
  ds_read_b64_tr_b16 a[50:51], v13 offset:12544
  ds_read_b64_tr_b16 a[52:53], v13 offset:12800
  ds_read_b64_tr_b16 a[54:55], v13 offset:13056
  v_exp_f32 v67, v67
  v_exp_f32 v68, v68
  v_exp_f32 v69, v69
  v_mfma_f32_32x32x16_bf16 v[96:111], v[40:43], v[16:19], 0
  ds_read_b128 v[44:47], v24 offset:28784
  ds_read_b64_tr_b16 a[56:57], v13 offset:14336
  ds_read_b64_tr_b16 a[58:59], v13 offset:14592
  ds_read_b64_tr_b16 a[60:61], v13 offset:14848
  ds_read_b64_tr_b16 a[62:63], v13 offset:15104
  v_exp_f32 v70, v70
  v_exp_f32 v71, v71
  v_exp_f32 v72, v72
  v_exp_f32 v73, v73
  s_mul_i32 s96, s6, 8192
  s_add_u32 s96, s96, 65536
  v_add_u32 v13, s96, v4
  s_waitcnt vmcnt(4)
  v_exp_f32 v74, v74
  v_exp_f32 v75, v75
  v_exp_f32 v76, v76
  v_exp_f32 v77, v77
  v_exp_f32 v78, v78
  v_exp_f32 v79, v79
  v_cvt_pk_bf16_f32 v64, v64, v65
  v_cvt_pk_bf16_f32 v65, v66, v67
  v_cvt_pk_bf16_f32 v66, v68, v69
  v_cvt_pk_bf16_f32 v67, v70, v71
  v_cvt_pk_bf16_f32 v68, v72, v73
  v_cvt_pk_bf16_f32 v69, v74, v75
  v_cvt_pk_bf16_f32 v70, v76, v77
  v_cvt_pk_bf16_f32 v71, v78, v79
  v_mfma_f32_32x32x16_bf16 v[224:239], v[208:211], v[64:67], v[224:239]
  ds_read_b64_tr_b16 a[64:65], v13 offset:0
  ds_read_b64_tr_b16 a[66:67], v13 offset:256
  ds_read_b64_tr_b16 a[68:69], v13 offset:512
  ds_read_b64_tr_b16 a[70:71], v13 offset:768
  ds_read_b64_tr_b16 a[72:73], v13 offset:2048
  ds_read_b64_tr_b16 a[74:75], v13 offset:2304
  ds_read_b64_tr_b16 a[76:77], v13 offset:2560
  ds_read_b64_tr_b16 a[78:79], v13 offset:2816
  ds_read_b128 v[112:115], v25 offset:25696
  ds_read_b64_tr_b16 a[80:81], v13 offset:4096
  ds_read_b64_tr_b16 a[82:83], v13 offset:4352
  ds_read_b64_tr_b16 a[84:85], v13 offset:4608
  ds_read_b64_tr_b16 a[86:87], v13 offset:4864
  v_exp_f32 v80, v80
  v_exp_f32 v81, v81
  v_exp_f32 v82, v82
  v_mfma_f32_32x32x16_bf16 v[224:239], v[212:215], v[68:71], v[224:239]
  s_waitcnt lgkmcnt(10)
  ds_read_b128 v[116:119], v26 offset:26208
  ds_read_b64_tr_b16 a[88:89], v13 offset:6144
  ds_read_b64_tr_b16 a[90:91], v13 offset:6400
  ds_read_b64_tr_b16 a[92:93], v13 offset:6656
  ds_read_b64_tr_b16 a[94:95], v13 offset:6912
  v_exp_f32 v83, v83
  v_exp_f32 v84, v84
  v_exp_f32 v85, v85
  v_mfma_f32_32x32x16_bf16 v[64:79], v[44:47], v[16:19], 0
  ds_read_b128 v[48:51], v24 offset:6160
  s_mul_i32 s96, s6, 2048
  s_add_u32 s96, s96, 147648
  v_add_u32 v13, s96, v4
  s_waitcnt vmcnt(0)
  v_exp_f32 v86, v86
  v_exp_f32 v87, v87
  v_exp_f32 v88, v88
  v_exp_f32 v89, v89
  v_exp_f32 v90, v90
  ds_read_b64_tr_b16 a[96:97], v13 offset:0
  ds_read_b64_tr_b16 a[98:99], v13 offset:256
  ds_read_b64_tr_b16 a[100:101], v13 offset:512
  ds_read_b64_tr_b16 a[102:103], v13 offset:768
  v_exp_f32 v91, v91
  v_exp_f32 v92, v92
  s_waitcnt lgkmcnt(0)
  v_exp_f32 v93, v93
  v_exp_f32 v94, v94
  s_mul_i32 s62, s6, 16384
  s_add_u32 m0, s62, 0
  s_add_u32 s60, s3, 819200
  buffer_load_dwordx4 v12, s[24:27], s60 offen offset:0 lds
  s_add_u32 s60, s3, 826368
  buffer_load_dwordx4 v12, s[24:27], s60 offen offset:1024 lds
  s_add_u32 s60, s3, 63488
  buffer_load_dwordx4 v12, s[24:27], s60 offen offset:2048 lds
  v_exp_f32 v95, v95
  v_cvt_pk_bf16_f32 v80, v80, v81
  v_cvt_pk_bf16_f32 v81, v82, v83
  v_cvt_pk_bf16_f32 v82, v84, v85
  v_cvt_pk_bf16_f32 v83, v86, v87
  v_cvt_pk_bf16_f32 v84, v88, v89
  v_cvt_pk_bf16_f32 v85, v90, v91
  v_cvt_pk_bf16_f32 v86, v92, v93
  v_cvt_pk_bf16_f32 v87, v94, v95
  v_mfma_f32_32x32x16_bf16 v[224:239], v[216:219], v[80:83], v[224:239]
  ds_read_b128 v[120:123], v25 offset:29808
  s_add_u32 s60, s3, 70656
  buffer_load_dwordx4 v12, s[24:27], s60 offen offset:3072 lds
  v_exp_f32 v96, v96
  v_exp_f32 v97, v97
  v_exp_f32 v98, v98
  s_add_u32 m0, s62, 4096
  s_add_u32 s60, s3, 196608
  buffer_load_dwordx4 v12, s[24:27], s60 offen offset:0 lds
  v_mfma_f32_32x32x16_bf16 v[224:239], v[220:223], v[84:87], v[224:239]
  ds_read_b128 v[124:127], v26 offset:30320
  s_add_u32 s60, s3, 203776
  buffer_load_dwordx4 v12, s[24:27], s60 offen offset:1024 lds
  s_add_u32 s60, s3, 325632
  buffer_load_dwordx4 v12, s[24:27], s60 offen offset:2048 lds
  v_exp_f32 v99, v99
  v_exp_f32 v100, v100
  v_exp_f32 v101, v101
  v_mfma_f32_32x32x16_bf16 v[80:95], v[48:51], v[20:23], 0
  ds_read_b128 v[52:55], v24 offset:10272
  s_add_u32 s60, s3, 332800
  buffer_load_dwordx4 v12, s[24:27], s60 offen offset:3072 lds
  v_exp_f32 v102, v102
  v_exp_f32 v103, v103
  v_exp_f32 v104, v104
  s_add_u32 m0, s62, 8192
  s_add_u32 s60, s3, 458752
  buffer_load_dwordx4 v12, s[24:27], s60 offen offset:0 lds
  s_add_u32 s60, s3, 465920
  buffer_load_dwordx4 v12, s[24:27], s60 offen offset:1024 lds
  v_exp_f32 v105, v105
  v_exp_f32 v106, v106
  v_exp_f32 v107, v107
  v_exp_f32 v108, v108
  s_mul_i32 s62, s6, 8192
  s_add_u32 m0, s62, 65536
  s_add_u32 s60, s3, 589824
  buffer_load_dwordx4 v12, s[24:27], s60 offen offset:0 lds
  s_add_u32 s60, s3, 596992
  buffer_load_dwordx4 v12, s[24:27], s60 offen offset:1024 lds
  s_add_u32 s60, s3, 718848
  buffer_load_dwordx4 v12, s[24:27], s60 offen offset:2048 lds
  s_add_u32 s60, s3, 726016
  buffer_load_dwordx4 v12, s[24:27], s60 offen offset:3072 lds
  v_exp_f32 v109, v109
  v_exp_f32 v110, v110
  v_exp_f32 v111, v111
  v_cvt_pk_bf16_f32 v96, v96, v97
  v_cvt_pk_bf16_f32 v97, v98, v99
  v_cvt_pk_bf16_f32 v98, v100, v101
  v_cvt_pk_bf16_f32 v99, v102, v103
  v_cvt_pk_bf16_f32 v100, v104, v105
  v_cvt_pk_bf16_f32 v101, v106, v107
  v_cvt_pk_bf16_f32 v102, v108, v109
  v_cvt_pk_bf16_f32 v103, v110, v111
  v_mfma_f32_32x32x16_bf16 v[224:239], v[112:115], v[96:99], v[224:239]
  ds_read_b128 v[200:203], v27 offset:7184
  v_exp_f32 v64, v64
  s_add_u32 m0, s62, 69632
  s_add_u32 s60, s3, 851968
  buffer_load_dwordx4 v12, s[24:27], s60 offen offset:0 lds
  s_add_u32 s60, s3, 859136
  buffer_load_dwordx4 v12, s[24:27], s60 offen offset:1024 lds
  v_exp_f32 v65, v65
  v_exp_f32 v66, v66
  v_mfma_f32_32x32x16_bf16 v[224:239], v[116:119], v[100:103], v[224:239]
  ds_read_b128 v[204:207], v28 offset:7696
  s_add_u32 s60, s3, 96256
  buffer_load_dwordx4 v12, s[24:27], s60 offen offset:2048 lds
  v_exp_f32 v67, v67
  v_exp_f32 v68, v68
  v_exp_f32 v69, v69
  s_waitcnt lgkmcnt(2)
  v_mfma_f32_32x32x16_bf16 v[96:111], v[52:55], v[20:23], 0
  ds_read_b128 v[40:43], v24 offset:14384
  s_add_u32 s60, s3, 103424
  buffer_load_dwordx4 v12, s[24:27], s60 offen offset:3072 lds
  v_exp_f32 v70, v70
  s_mul_i32 s62, s6, 2048
  s_add_u32 m0, s62, 147648
  s_add_u32 s60, s3, 229376
  buffer_load_dwordx4 v12, s[24:27], s60 offen offset:0 lds
  s_add_u32 s60, s3, 236544
  buffer_load_dwordx4 v12, s[24:27], s60 offen offset:1024 lds
  v_exp_f32 v71, v71
  v_exp_f32 v72, v72
  v_exp_f32 v73, v73
  v_exp_f32 v74, v74
  v_exp_f32 v75, v75
  v_exp_f32 v76, v76
  v_exp_f32 v77, v77
  v_exp_f32 v78, v78
  v_exp_f32 v79, v79
  v_cvt_pk_bf16_f32 v64, v64, v65
  v_cvt_pk_bf16_f32 v65, v66, v67
  v_cvt_pk_bf16_f32 v66, v68, v69
  v_cvt_pk_bf16_f32 v67, v70, v71
  v_cvt_pk_bf16_f32 v68, v72, v73
  v_cvt_pk_bf16_f32 v69, v74, v75
  v_cvt_pk_bf16_f32 v70, v76, v77
  v_cvt_pk_bf16_f32 v71, v78, v79
  v_mfma_f32_32x32x16_bf16 v[224:239], v[120:123], v[64:67], v[224:239]
  ds_read_b128 v[208:211], v27 offset:11296
  v_exp_f32 v80, v80
  v_exp_f32 v81, v81
  v_exp_f32 v82, v82
  v_mfma_f32_32x32x16_bf16 v[224:239], v[124:127], v[68:71], v[224:239]
  ds_read_b128 v[212:215], v28 offset:11808
  v_exp_f32 v83, v83
  v_exp_f32 v84, v84
  v_exp_f32 v85, v85
  s_waitcnt lgkmcnt(2)
  v_mfma_f32_32x32x16_bf16 v[64:79], v[40:43], v[20:23], 0
  ds_read_b128 v[44:47], v24 offset:22608
  v_exp_f32 v86, v86
  v_exp_f32 v87, v87
  v_exp_f32 v88, v88
  v_exp_f32 v89, v89
  v_exp_f32 v90, v90
  v_exp_f32 v91, v91
  v_exp_f32 v92, v92
  v_exp_f32 v93, v93
  s_mul_i32 s96, s6, 16384
  s_add_u32 s96, s96, 0
  v_add_u32 v13, s96, v4
  s_waitcnt vmcnt(10)
  v_exp_f32 v94, v94
  v_exp_f32 v95, v95
  v_cvt_pk_bf16_f32 v80, v80, v81
  v_cvt_pk_bf16_f32 v81, v82, v83
  v_cvt_pk_bf16_f32 v82, v84, v85
  v_cvt_pk_bf16_f32 v83, v86, v87
  v_cvt_pk_bf16_f32 v84, v88, v89
  v_cvt_pk_bf16_f32 v85, v90, v91
  v_cvt_pk_bf16_f32 v86, v92, v93
  v_cvt_pk_bf16_f32 v87, v94, v95
  v_mfma_f32_32x32x16_bf16 v[240:255], v[200:203], v[80:83], v[240:255]
  ds_read_b64_tr_b16 a[104:105], v13 offset:0
  ds_read_b64_tr_b16 a[106:107], v13 offset:256
  ds_read_b64_tr_b16 a[108:109], v13 offset:512
  ds_read_b64_tr_b16 a[110:111], v13 offset:768
  ds_read_b128 v[216:219], v27 offset:15408
  ds_read_b64_tr_b16 a[112:113], v13 offset:2048
  ds_read_b64_tr_b16 a[114:115], v13 offset:2304
  v_exp_f32 v96, v96
  v_exp_f32 v97, v97
  v_exp_f32 v98, v98
  v_mfma_f32_32x32x16_bf16 v[240:255], v[204:207], v[84:87], v[240:255]
  s_waitcnt lgkmcnt(7)
  ds_read_b128 v[220:223], v28 offset:15920
  ds_read_b64_tr_b16 a[116:117], v13 offset:2560
  ds_read_b64_tr_b16 a[118:119], v13 offset:2816
  v_exp_f32 v99, v99
  v_exp_f32 v100, v100
  v_exp_f32 v101, v101
  v_mfma_f32_32x32x16_bf16 v[80:95], v[44:47], v[20:23], 0
  ds_read_b128 v[48:51], v24 offset:26720
  ds_read_b64_tr_b16 a[120:121], v13 offset:4096
  ds_read_b64_tr_b16 a[122:123], v13 offset:4352
  ds_read_b64_tr_b16 a[124:125], v13 offset:4608
  ds_read_b64_tr_b16 a[126:127], v13 offset:4864
  ds_read_b64_tr_b16 a[128:129], v13 offset:6144
  ds_read_b64_tr_b16 a[130:131], v13 offset:6400
  ds_read_b64_tr_b16 a[132:133], v13 offset:6656
  ds_read_b64_tr_b16 a[134:135], v13 offset:6912
  v_exp_f32 v102, v102
  v_exp_f32 v103, v103
  v_exp_f32 v104, v104
  v_exp_f32 v105, v105
  v_exp_f32 v106, v106
  v_exp_f32 v107, v107
  v_exp_f32 v108, v108
  v_rcp_f32 v31, v232
  v_exp_f32 v109, v109
  v_add_u32 v29, 0xe0800000, v232
  v_exp_f32 v110, v110
  v_mul_f32 v224, v224, v31
  v_exp_f32 v111, v111
  v_mul_f32 v225, v225, v31
  v_cvt_pk_bf16_f32 v96, v96, v97
  v_mul_f32 v226, v226, v31
  v_cvt_pk_bf16_f32 v97, v98, v99
  v_mul_f32 v227, v227, v31
  v_cvt_pk_bf16_f32 v98, v100, v101
  ds_read_b64_tr_b16 a[136:137], v13 offset:8192
  ds_read_b64_tr_b16 a[138:139], v13 offset:8448
  ds_read_b64_tr_b16 a[140:141], v13 offset:8704
  ds_read_b64_tr_b16 a[142:143], v13 offset:8960
  v_mul_f32 v228, v228, v31
  v_cvt_pk_bf16_f32 v99, v102, v103
  v_mul_f32 v229, v229, v31
  v_cvt_pk_bf16_f32 v100, v104, v105
  v_mul_f32 v230, v230, v31
  v_cvt_pk_bf16_f32 v101, v106, v107
  v_mul_f32 v231, v231, v31
  s_waitcnt lgkmcnt(0)
  v_cvt_pk_bf16_f32 v102, v108, v109
  v_cvt_pk_bf16_f32 v232, v224, v225
  v_cvt_pk_bf16_f32 v103, v110, v111
  v_cvt_pk_bf16_f32 v233, v226, v227
  v_cvt_pk_bf16_f32 v234, v228, v229
  v_cvt_pk_bf16_f32 v235, v230, v231
  s_and_b32 s61, s6, 1
  s_lshl_b32 s61, s61, 18
  s_lshr_b32 s62, s6, 1
  s_xor_b32 s62, s62, s0
  s_and_b32 s62, s62, 1
  s_lshl_b32 s62, s62, 17
  s_add_u32 s61, s61, s62
  s_and_b32 s62, s50, 14
  s_lshl_b32 s62, s62, 6
  s_add_u32 s61, s61, s62
  s_lshl_b32 s62, s6, 14
  s_add_u32 m0, s62, 0
  s_add_u32 s60, s61, 0
  buffer_load_dwordx4 v12, s[16:19], s60 offen offset:0 lds
  buffer_store_dwordx4 v[232:235], v1, s[28:31], s54 offen offset:0 sc1
  v_mfma_f32_32x32x16_bf16 v[240:255], v[208:211], v[96:99], v[240:255]
  ds_read_b128 v[112:115], v27 offset:23632
  s_add_u32 s60, s61, 7168
  buffer_load_dwordx4 v12, s[16:19], s60 offen offset:1024 lds
  v_exp_f32 v64, v64
  v_exp_f32 v65, v65
  v_exp_f32 v66, v66
  v_mfma_f32_32x32x16_bf16 v[240:255], v[212:215], v[100:103], v[240:255]
  ds_read_b128 v[116:119], v28 offset:24144
  s_add_u32 s60, s61, 14336
  buffer_load_dwordx4 v12, s[16:19], s60 offen offset:2048 lds
  s_add_u32 s60, s61, 21504
  buffer_load_dwordx4 v12, s[16:19], s60 offen offset:3072 lds
  v_exp_f32 v67, v67
  v_exp_f32 v68, v68
  v_exp_f32 v69, v69
  v_mfma_f32_32x32x16_bf16 v[96:111], v[48:51], v[20:23], 0
  ds_read_b128 v[52:55], v24 offset:30832
  v_exp_f32 v70, v70
  v_exp_f32 v71, v71
  s_add_u32 m0, s62, 4096
  s_add_u32 s60, s61, 32768
  buffer_load_dwordx4 v12, s[16:19], s60 offen offset:0 lds
  s_add_u32 s60, s61, 39936
  buffer_load_dwordx4 v12, s[16:19], s60 offen offset:1024 lds
  s_add_u32 s60, s61, 47104
  buffer_load_dwordx4 v12, s[16:19], s60 offen offset:2048 lds
  s_add_u32 s60, s61, 54272
  buffer_load_dwordx4 v12, s[16:19], s60 offen offset:3072 lds
  v_exp_f32 v72, v72
  v_exp_f32 v73, v73
  v_exp_f32 v74, v74
  v_exp_f32 v75, v75
  v_exp_f32 v76, v76
  v_exp_f32 v77, v77
  v_exp_f32 v78, v78
  v_exp_f32 v79, v79
  v_cvt_pk_bf16_f32 v64, v64, v65
  v_cvt_pk_bf16_f32 v65, v66, v67
  v_cvt_pk_bf16_f32 v66, v68, v69
  v_cvt_pk_bf16_f32 v67, v70, v71
  v_cvt_pk_bf16_f32 v68, v72, v73
  v_cvt_pk_bf16_f32 v69, v74, v75
  v_cvt_pk_bf16_f32 v70, v76, v77
  v_cvt_pk_bf16_f32 v71, v78, v79
  v_mfma_f32_32x32x16_bf16 v[240:255], v[216:219], v[64:67], v[240:255]
  s_add_u32 m0, s62, 8192
  s_add_u32 s60, s61, 65536
  buffer_load_dwordx4 v12, s[16:19], s60 offen offset:0 lds
  s_add_u32 s60, s61, 72704
  buffer_load_dwordx4 v12, s[16:19], s60 offen offset:1024 lds
  v_exp_f32 v80, v80
  v_exp_f32 v81, v81
  v_exp_f32 v82, v82
  v_exp_f32 v83, v83
  v_mfma_f32_32x32x16_bf16 v[240:255], v[220:223], v[68:71], v[240:255]
  ds_read_b128 v[120:123], v27 offset:27744
  s_add_u32 s60, s61, 79872
  buffer_load_dwordx4 v12, s[16:19], s60 offen offset:2048 lds
  v_exp_f32 v84, v84
  v_exp_f32 v85, v85
  v_exp_f32 v86, v86
  s_waitcnt lgkmcnt(1)
  v_mfma_f32_32x32x16_bf16 v[64:79], v[52:55], v[20:23], 0
  ds_read_b128 v[124:127], v28 offset:28256
  s_add_u32 s60, s61, 87040
  buffer_load_dwordx4 v12, s[16:19], s60 offen offset:3072 lds
  v_exp_f32 v87, v87
  v_exp_f32 v88, v88
  v_exp_f32 v89, v89
  s_add_u32 m0, s62, 12288
  s_add_u32 s60, s61, 98304
  buffer_load_dwordx4 v12, s[16:19], s60 offen offset:0 lds
  s_add_u32 s60, s61, 105472
  buffer_load_dwordx4 v12, s[16:19], s60 offen offset:1024 lds
  s_add_u32 s60, s61, 112640
  buffer_load_dwordx4 v12, s[16:19], s60 offen offset:2048 lds
  s_add_u32 s60, s61, 119808
  buffer_load_dwordx4 v12, s[16:19], s60 offen offset:3072 lds
  v_exp_f32 v90, v90
  v_exp_f32 v91, v91
  v_exp_f32 v92, v92
  v_exp_f32 v93, v93
  v_exp_f32 v94, v94
  v_exp_f32 v95, v95
  v_cvt_pk_bf16_f32 v80, v80, v81
  v_cvt_pk_bf16_f32 v81, v82, v83
  v_cvt_pk_bf16_f32 v82, v84, v85
  v_cvt_pk_bf16_f32 v83, v86, v87
  v_cvt_pk_bf16_f32 v84, v88, v89
  v_cvt_pk_bf16_f32 v85, v90, v91
  v_cvt_pk_bf16_f32 v86, v92, v93
  v_cvt_pk_bf16_f32 v87, v94, v95
  v_mfma_f32_32x32x16_bf16 v[240:255], v[112:115], v[80:83], v[240:255]
  ds_read_b128 v[200:203], v27 offset:31856
  v_exp_f32 v96, v96
  s_lshr_b32 s98, s2, 3
  s_lshl_b32 s98, s98, 2
  s_add_u32 s98, s98, s6
  s_mul_i32 s98, s98, 14336
  v_lshlrev_b32 v14, 7, v0
  s_bitcmp0_b32 s2, 3
  s_cselect_b32 s98, s98, 1073741824
  buffer_load_dword a232, v14, s[20:23], s98 offen offset:0
  v_exp_f32 v97, v97
  v_exp_f32 v98, v98
  v_mfma_f32_32x32x16_bf16 v[240:255], v[116:119], v[84:87], v[240:255]
  ds_read_b128 v[204:207], v28 offset:32368
  s_add_u32 s98, s98, 6144
  buffer_load_dword a232, v14, s[20:23], s98 offen offset:0
  v_exp_f32 v99, v99
  v_exp_f32 v100, v100
  v_exp_f32 v101, v101
  v_exp_f32 v102, v102
  v_exp_f32 v103, v103
  v_exp_f32 v104, v104
  v_exp_f32 v105, v105
  v_exp_f32 v106, v106
  v_exp_f32 v107, v107
  v_exp_f32 v108, v108
  v_exp_f32 v109, v109
  v_exp_f32 v110, v110
  v_exp_f32 v111, v111
  v_cvt_pk_bf16_f32 v96, v96, v97
  v_cvt_pk_bf16_f32 v97, v98, v99
  v_cvt_pk_bf16_f32 v98, v100, v101
  v_cvt_pk_bf16_f32 v99, v102, v103
  v_cvt_pk_bf16_f32 v100, v104, v105
  v_cvt_pk_bf16_f32 v101, v106, v107
  v_cvt_pk_bf16_f32 v102, v108, v109
  v_cvt_pk_bf16_f32 v103, v110, v111
  s_waitcnt lgkmcnt(3)
  v_mfma_f32_32x32x16_bf16 v[240:255], v[120:123], v[96:99], v[240:255]
  s_waitcnt lgkmcnt(2)
  v_exp_f32 v64, v64
  v_exp_f32 v65, v65
  v_exp_f32 v66, v66
  v_exp_f32 v67, v67
  v_mfma_f32_32x32x16_bf16 v[240:255], v[124:127], v[100:103], v[240:255]
  v_exp_f32 v68, v68
  v_exp_f32 v69, v69
  v_exp_f32 v70, v70
  v_exp_f32 v71, v71
  v_cvt_pk_bf16_f32 v64, v64, v65
  v_cvt_pk_bf16_f32 v65, v66, v67
  v_cvt_pk_bf16_f32 v66, v68, v69
  v_cvt_pk_bf16_f32 v67, v70, v71
  v_exp_f32 v72, v72
  v_exp_f32 v73, v73
  s_waitcnt lgkmcnt(1)
  v_mfma_f32_32x32x16_bf16 v[240:255], v[200:203], v[64:67], v[240:255]
  v_exp_f32 v74, v74
  v_exp_f32 v75, v75
  v_exp_f32 v76, v76
  v_exp_f32 v77, v77
  v_exp_f32 v78, v78
  v_exp_f32 v79, v79
  v_cvt_pk_bf16_f32 v68, v72, v73
  v_cvt_pk_bf16_f32 v69, v74, v75
  v_cvt_pk_bf16_f32 v70, v76, v77
  v_cvt_pk_bf16_f32 v71, v78, v79
  s_waitcnt lgkmcnt(0)
  s_nop 0
  v_mfma_f32_32x32x16_bf16 v[240:255], v[204:207], v[68:71], v[240:255]
  s_nop 11
  v_rcp_f32 v31, v248
  v_add_u32 v14, 0xe0800000, v248
  v_max_u32 v14, v14, v29
  v_cmp_le_u32 vcc, 0x40000000, v14
  v_mul_f32 v240, v240, v31
  v_mul_f32 v241, v241, v31
  v_mul_f32 v242, v242, v31
  v_mul_f32 v243, v243, v31
  s_cbranch_vccnz L35
  v_mul_f32 v244, v244, v31
  v_mul_f32 v245, v245, v31
  v_mul_f32 v246, v246, v31
  v_mul_f32 v247, v247, v31
  v_cvt_pk_bf16_f32 v248, v240, v241
  v_cvt_pk_bf16_f32 v249, v242, v243
  v_cvt_pk_bf16_f32 v250, v244, v245
  v_cvt_pk_bf16_f32 v251, v246, v247
  buffer_store_dwordx4 v[248:251], v1, s[28:31], s54 offen offset:1024 sc1
L36:
  v_and_b32 v14, 0x1c0, v1
  v_or_b32 v14, 16711680, v14
  s_cmp_eq_u32 s51, 0
  s_waitcnt vmcnt(0)
  buffer_store_byte_d16_hi v14, v14, s[28:31], s8 offen offset:0
  v_mov_b32 v14, 1
  s_cbranch_scc1 L37
  buffer_store_dword v14, off, s[28:31], s52
L38:
L_p3_0:
  s_and_b32 s54, s6, 1
  s_lshl_b32 s54, s54, 14
  v_add_u32 v14, s54, v4
  s_lshl_b32 s57, s49, 15
  s_add_u32 s57, s57, s54
  s_add_u32 s57, s57, 5242880
  s_and_b32 s58, s0, 1
  s_lshl_b32 s58, s58, 13
  s_add_u32 s57, s57, s58
  s_barrier
  ds_read_b64_tr_b16 v[128:129], v14 offset:0
  ds_read_b64_tr_b16 v[130:131], v14 offset:256
  ds_read_b64_tr_b16 v[132:133], v14 offset:512
  ds_read_b64_tr_b16 v[134:135], v14 offset:768
  ds_read_b64_tr_b16 v[136:137], v14 offset:2048
  ds_read_b64_tr_b16 v[138:139], v14 offset:2304
  ds_read_b64_tr_b16 v[140:141], v14 offset:2560
  ds_read_b64_tr_b16 v[142:143], v14 offset:2816
  ds_read_b64_tr_b16 v[144:145], v14 offset:4096
  ds_read_b64_tr_b16 v[146:147], v14 offset:4352
  ds_read_b64_tr_b16 v[148:149], v14 offset:4608
  ds_read_b64_tr_b16 v[150:151], v14 offset:4864
  s_buffer_load_dwordx2 s[44:45], s[28:31], s36 offset:0
  ds_read_b64_tr_b16 v[152:153], v14 offset:6144
  ds_read_b64_tr_b16 v[154:155], v14 offset:6400
  ds_read_b64_tr_b16 v[156:157], v14 offset:6656
  ds_read_b64_tr_b16 v[158:159], v14 offset:6912
  ds_read_b64_tr_b16 v[160:161], v14 offset:8192
  ds_read_b64_tr_b16 v[162:163], v14 offset:8448
  ds_read_b64_tr_b16 v[164:165], v14 offset:8704
  ds_read_b64_tr_b16 v[166:167], v14 offset:8960
  ds_read_b64_tr_b16 v[168:169], v14 offset:10240
  ds_read_b64_tr_b16 v[170:171], v14 offset:10496
  ds_read_b64_tr_b16 v[172:173], v14 offset:10752
  ds_read_b64_tr_b16 v[174:175], v14 offset:11008
  ds_read_b64_tr_b16 v[176:177], v14 offset:12288
  ds_read_b64_tr_b16 v[178:179], v14 offset:12544
  ds_read_b64_tr_b16 v[180:181], v14 offset:12800
  ds_read_b64_tr_b16 v[182:183], v14 offset:13056
  v_accvgpr_read_b32 v15, a224
  v_lshlrev_b32 v16, 16, v15
  v_and_b32 v17, 0xffff0000, v15
  v_accvgpr_read_b32 v15, a225
  v_lshlrev_b32 v18, 16, v15
  v_and_b32 v19, 0xffff0000, v15
  v_accvgpr_read_b32 v15, a226
  v_lshlrev_b32 v20, 16, v15
  v_and_b32 v21, 0xffff0000, v15
  v_accvgpr_read_b32 v15, a227
  v_lshlrev_b32 v22, 16, v15
  v_and_b32 v23, 0xffff0000, v15
  v_accvgpr_read_b32 v15, a228
  v_lshlrev_b32 v24, 16, v15
  v_and_b32 v25, 0xffff0000, v15
  v_accvgpr_read_b32 v15, a229
  v_lshlrev_b32 v26, 16, v15
  v_and_b32 v27, 0xffff0000, v15
  v_accvgpr_read_b32 v15, a230
  v_lshlrev_b32 v28, 16, v15
  v_and_b32 v29, 0xffff0000, v15
  v_accvgpr_read_b32 v15, a231
  v_lshlrev_b32 v30, 16, v15
  v_and_b32 v31, 0xffff0000, v15
  s_waitcnt lgkmcnt(0)
  s_nand_b32 s44, s44, s45
  s_cbranch_scc1 L39
L40:
  s_xor_b32 s58, s57, 0
  buffer_load_dwordx4 v[64:67], v1, s[28:31], s58 offen offset:0 sc1
  buffer_load_dwordx4 v[68:71], v1, s[28:31], s58 offen offset:1024 sc1
  buffer_load_dwordx4 v[72:75], v1, s[28:31], s58 offen offset:2048 sc1
  buffer_load_dwordx4 v[76:79], v1, s[28:31], s58 offen offset:3072 sc1
  s_xor_b32 s58, s57, 4096
  buffer_load_dwordx4 v[80:83], v1, s[28:31], s58 offen offset:0 sc1
  buffer_load_dwordx4 v[84:87], v1, s[28:31], s58 offen offset:1024 sc1
  buffer_load_dwordx4 v[88:91], v1, s[28:31], s58 offen offset:2048 sc1
  buffer_load_dwordx4 v[92:95], v1, s[28:31], s58 offen offset:3072 sc1
  s_xor_b32 s58, s57, 8192
  buffer_load_dwordx4 v[96:99], v1, s[28:31], s58 offen offset:0 sc1
  buffer_load_dwordx4 v[100:103], v1, s[28:31], s58 offen offset:1024 sc1
  buffer_load_dwordx4 v[104:107], v1, s[28:31], s58 offen offset:2048 sc1
  buffer_load_dwordx4 v[108:111], v1, s[28:31], s58 offen offset:3072 sc1
  s_xor_b32 s58, s57, 12288
  buffer_load_dwordx4 v[112:115], v1, s[28:31], s58 offen offset:0 sc1
  buffer_load_dwordx4 v[116:119], v1, s[28:31], s58 offen offset:1024 sc1
  buffer_load_dwordx4 v[120:123], v1, s[28:31], s58 offen offset:2048 sc1
  buffer_load_dwordx4 v[124:127], v1, s[28:31], s58 offen offset:3072 sc1
  ds_read_b64_tr_b16 v[184:185], v14 offset:14336
  ds_read_b64_tr_b16 v[186:187], v14 offset:14592
  ds_read_b64_tr_b16 v[188:189], v14 offset:14848
  ds_read_b64_tr_b16 v[190:191], v14 offset:15104
  ds_read_b64_tr_b16 v[192:193], v14 offset:32768
  ds_read_b64_tr_b16 v[194:195], v14 offset:33024
  ds_read_b64_tr_b16 v[196:197], v14 offset:33280
  ds_read_b64_tr_b16 v[198:199], v14 offset:33536
  ds_read_b64_tr_b16 v[200:201], v14 offset:34816
  ds_read_b64_tr_b16 v[202:203], v14 offset:35072
  ds_read_b64_tr_b16 v[204:205], v14 offset:35328
  ds_read_b64_tr_b16 v[206:207], v14 offset:35584
  ds_read_b64_tr_b16 v[208:209], v14 offset:36864
  ds_read_b64_tr_b16 v[210:211], v14 offset:37120
  ds_read_b64_tr_b16 v[212:213], v14 offset:37376
  ds_read_b64_tr_b16 v[214:215], v14 offset:37632
  ds_read_b64_tr_b16 v[216:217], v14 offset:38912
  ds_read_b64_tr_b16 v[218:219], v14 offset:39168
  ds_read_b64_tr_b16 v[220:221], v14 offset:39424
  ds_read_b64_tr_b16 v[222:223], v14 offset:39680
  ds_read_b64_tr_b16 v[224:225], v14 offset:40960
  ds_read_b64_tr_b16 v[226:227], v14 offset:41216
  ds_read_b64_tr_b16 v[228:229], v14 offset:41472
  ds_read_b64_tr_b16 v[230:231], v14 offset:41728
  ds_read_b64_tr_b16 v[232:233], v14 offset:43008
  ds_read_b64_tr_b16 v[234:235], v14 offset:43264
  ds_read_b64_tr_b16 v[236:237], v14 offset:43520
  ds_read_b64_tr_b16 v[238:239], v14 offset:43776
  ds_read_b64_tr_b16 v[240:241], v14 offset:45056
  ds_read_b64_tr_b16 v[242:243], v14 offset:45312
  ds_read_b64_tr_b16 v[244:245], v14 offset:45568
  ds_read_b64_tr_b16 v[246:247], v14 offset:45824
  ds_read_b64_tr_b16 v[248:249], v14 offset:47104
  ds_read_b64_tr_b16 v[250:251], v14 offset:47360
  ds_read_b64_tr_b16 v[252:253], v14 offset:47616
  ds_read_b64_tr_b16 v[254:255], v14 offset:47872
  s_mul_i32 s96, s6, 8192
  s_add_u32 s96, s96, 65536
  v_add_u32 v13, s96, v4
  ds_read_b64_tr_b16 a[144:145], v13 offset:0
  ds_read_b64_tr_b16 a[146:147], v13 offset:256
  ds_read_b64_tr_b16 a[148:149], v13 offset:512
  ds_read_b64_tr_b16 a[150:151], v13 offset:768
  ds_read_b64_tr_b16 a[152:153], v13 offset:2048
  ds_read_b64_tr_b16 a[154:155], v13 offset:2304
  ds_read_b64_tr_b16 a[156:157], v13 offset:2560
  ds_read_b64_tr_b16 a[158:159], v13 offset:2816
  ds_read_b64_tr_b16 a[160:161], v13 offset:4096
  ds_read_b64_tr_b16 a[162:163], v13 offset:4352
  ds_read_b64_tr_b16 a[164:165], v13 offset:4608
  ds_read_b64_tr_b16 a[166:167], v13 offset:4864
  ds_read_b64_tr_b16 a[168:169], v13 offset:6144
  ds_read_b64_tr_b16 a[170:171], v13 offset:6400
  ds_read_b64_tr_b16 a[172:173], v13 offset:6656
  ds_read_b64_tr_b16 a[174:175], v13 offset:6912
  s_mul_i32 s96, s6, 2048
  s_add_u32 s96, s96, 147648
  v_add_u32 v13, s96, v4
  v_and_b32 v14, 0x13, v0
  v_bfe_u32 v15, v0, 2, 1
  v_lshl_add_u32 v14, v15, 3, v14
  v_bfe_u32 v15, v0, 3, 1
  v_lshl_add_u32 v14, v15, 2, v14
  v_lshlrev_b32 v14, 1, v14
  ds_read_b64_tr_b16 a[176:177], v13 offset:0
  ds_read_b64_tr_b16 a[178:179], v13 offset:256
  ds_read_b64_tr_b16 a[180:181], v13 offset:512
  ds_read_b64_tr_b16 a[182:183], v13 offset:768
  s_mul_i32 s62, s6, 8192
  s_add_u32 m0, s62, 98304
  s_add_u32 s60, s3, 360448
  buffer_load_dwordx4 v12, s[24:27], s60 offen offset:0 lds
  s_add_u32 s60, s3, 367616
  buffer_load_dwordx4 v12, s[24:27], s60 offen offset:1024 lds
  s_add_u32 s60, s3, 489472
  buffer_load_dwordx4 v12, s[24:27], s60 offen offset:2048 lds
  s_add_u32 s60, s3, 496640
  buffer_load_dwordx4 v12, s[24:27], s60 offen offset:3072 lds
  s_add_u32 m0, s62, 102400
  s_add_u32 s60, s3, 622592
  buffer_load_dwordx4 v12, s[24:27], s60 offen offset:0 lds
  s_add_u32 s60, s3, 629760
  buffer_load_dwordx4 v12, s[24:27], s60 offen offset:1024 lds
  s_add_u32 s60, s3, 751616
  buffer_load_dwordx4 v12, s[24:27], s60 offen offset:2048 lds
  s_add_u32 s60, s3, 758784
  buffer_load_dwordx4 v12, s[24:27], s60 offen offset:3072 lds
  s_lshl_b32 s55, s5, 8
  s_cmp_ge_u32 s6, 2
  s_cselect_b32 s55, 1073741824, s55
  buffer_load_ushort v48, v14, s[40:43], s55 offen offset:0
  buffer_load_ushort v49, v14, s[40:43], s55 offen offset:64
  buffer_load_ushort v50, v14, s[40:43], s55 offen offset:128
  buffer_load_ushort v51, v14, s[40:43], s55 offen offset:192
  s_waitcnt lgkmcnt(0)
  s_mul_i32 s62, s6, 2048
  s_add_u32 m0, s62, 147648
  s_add_u32 s60, s3, 884736
  buffer_load_dwordx4 v12, s[24:27], s60 offen offset:0 lds
  s_add_u32 s60, s3, 891904
  buffer_load_dwordx4 v12, s[24:27], s60 offen offset:1024 lds
  s_xor_b32 s54, s6, 1
  s_lshl_b32 s54, s54, 12
  s_add_u32 s54, s54, 131072
  v_add_u32 v52, s54, v1
  s_lshl_b32 s56, s49, 4
  s_add_u32 s56, s56, s50
  s_lshl_b32 s55, s56, 11
  s_add_u32 s55, s55, 0
  s_lshl_b32 s56, s56, 8
  s_add_u32 s56, s56, 11534336
  v_lshlrev_b32 v15, 2, v0
  s_barrier
L44:
  s_waitcnt vmcnt(29)
  v_mfma_f32_32x32x16_bf16 v[32:47], v[132:135], v[64:67], 0
  v_mfma_f32_32x32x16_bf16 v[16:31], v[128:131], v[64:67], v[16:31]
  s_xor_b32 s61, s6, s0
  s_mul_i32 s61, s61, 458752
  s_lshl_b32 s62, s5, 8
  s_add_u32 s61, s61, s62
  s_cmp_ge_u32 s5, 14
  s_cselect_b32 s61, 1073741824, s61
  s_lshl_b32 s62, s6, 14
  s_add_u32 m0, s62, 0
  s_add_u32 s60, s61, 0
  buffer_load_dwordx4 v11, s[20:23], s60 offen offset:0 lds
  s_add_u32 s60, s61, 27648
  buffer_load_dwordx4 v11, s[20:23], s60 offen offset:1024 lds
  s_waitcnt vmcnt(30)
  v_mfma_f32_32x32x16_bf16 v[32:47], v[140:143], v[68:71], v[32:47]
  v_mfma_f32_32x32x16_bf16 v[16:31], v[136:139], v[68:71], v[16:31]
  s_add_u32 s60, s61, 55296
  buffer_load_dwordx4 v11, s[20:23], s60 offen offset:2048 lds
  s_add_u32 s60, s61, 82944
  buffer_load_dwordx4 v11, s[20:23], s60 offen offset:3072 lds
  s_waitcnt vmcnt(31)
  v_mfma_f32_32x32x16_bf16 v[32:47], v[148:151], v[72:75], v[32:47]
  v_mfma_f32_32x32x16_bf16 v[16:31], v[144:147], v[72:75], v[16:31]
  s_add_u32 m0, s62, 4096
  s_add_u32 s60, s61, 114688
  buffer_load_dwordx4 v11, s[20:23], s60 offen offset:0 lds
  s_add_u32 s60, s61, 142336
  buffer_load_dwordx4 v11, s[20:23], s60 offen offset:1024 lds
  s_waitcnt vmcnt(32)
  v_mfma_f32_32x32x16_bf16 v[32:47], v[156:159], v[76:79], v[32:47]
  v_mfma_f32_32x32x16_bf16 v[16:31], v[152:155], v[76:79], v[16:31]
  s_add_u32 s60, s61, 169984
  buffer_load_dwordx4 v11, s[20:23], s60 offen offset:2048 lds
  s_waitcnt vmcnt(32)
  v_mfma_f32_32x32x16_bf16 v[32:47], v[164:167], v[80:83], v[32:47]
  v_mfma_f32_32x32x16_bf16 v[16:31], v[160:163], v[80:83], v[16:31]
  s_add_u32 s60, s61, 197632
  buffer_load_dwordx4 v11, s[20:23], s60 offen offset:3072 lds
  s_add_u32 m0, s62, 8192
  s_add_u32 s60, s61, 229376
  buffer_load_dwordx4 v11, s[20:23], s60 offen offset:0 lds
  s_waitcnt vmcnt(33)
  v_mfma_f32_32x32x16_bf16 v[32:47], v[172:175], v[84:87], v[32:47]
  v_mfma_f32_32x32x16_bf16 v[16:31], v[168:171], v[84:87], v[16:31]
  s_add_u32 s60, s61, 257024
  buffer_load_dwordx4 v11, s[20:23], s60 offen offset:1024 lds
  s_add_u32 s60, s61, 284672
  buffer_load_dwordx4 v11, s[20:23], s60 offen offset:2048 lds
  s_waitcnt vmcnt(34)
  v_mfma_f32_32x32x16_bf16 v[32:47], v[180:183], v[88:91], v[32:47]
  v_mfma_f32_32x32x16_bf16 v[16:31], v[176:179], v[88:91], v[16:31]
  s_add_u32 s60, s61, 312320
  buffer_load_dwordx4 v11, s[20:23], s60 offen offset:3072 lds
  s_add_u32 m0, s62, 12288
  s_add_u32 s60, s61, 344064
  buffer_load_dwordx4 v11, s[20:23], s60 offen offset:0 lds
  s_waitcnt vmcnt(35)
  v_mfma_f32_32x32x16_bf16 v[32:47], v[188:191], v[92:95], v[32:47]
  v_mfma_f32_32x32x16_bf16 v[16:31], v[184:187], v[92:95], v[16:31]
  s_add_u32 s60, s61, 371712
  buffer_load_dwordx4 v11, s[20:23], s60 offen offset:1024 lds
  s_waitcnt vmcnt(35)
  v_mfma_f32_32x32x16_bf16 v[32:47], v[196:199], v[96:99], v[32:47]
  v_mfma_f32_32x32x16_bf16 v[16:31], v[192:195], v[96:99], v[16:31]
  s_add_u32 s60, s61, 399360
  buffer_load_dwordx4 v11, s[20:23], s60 offen offset:2048 lds
  s_add_u32 s60, s61, 427008
  buffer_load_dwordx4 v11, s[20:23], s60 offen offset:3072 lds
  s_waitcnt vmcnt(36)
  v_mfma_f32_32x32x16_bf16 v[32:47], v[204:207], v[100:103], v[32:47]
  v_mfma_f32_32x32x16_bf16 v[16:31], v[200:203], v[100:103], v[16:31]
  s_lshl_b32 s61, s0, 1
  s_xor_b32 s61, s61, s6
  s_mul_i32 s61, s61, 229376
  s_lshl_b32 s62, s5, 8
  s_add_u32 s61, s61, s62
  s_cmp_ge_u32 s5, 14
  s_cselect_b32 s61, 1073741824, s61
  s_lshl_b32 s62, s6, 13
  s_add_u32 m0, s62, 65536
  s_add_u32 s60, s61, 128
  buffer_load_dwordx4 v11, s[20:23], s60 offen offset:0 lds
  s_add_u32 s60, s61, 27776
  buffer_load_dwordx4 v11, s[20:23], s60 offen offset:1024 lds
  s_waitcnt vmcnt(37)
  v_mfma_f32_32x32x16_bf16 v[32:47], v[212:215], v[104:107], v[32:47]
  v_mfma_f32_32x32x16_bf16 v[16:31], v[208:211], v[104:107], v[16:31]
  s_add_u32 s60, s61, 55424
  buffer_load_dwordx4 v11, s[20:23], s60 offen offset:2048 lds
  s_waitcnt vmcnt(37)
  v_mfma_f32_32x32x16_bf16 v[32:47], v[220:223], v[108:111], v[32:47]
  v_mfma_f32_32x32x16_bf16 v[16:31], v[216:219], v[108:111], v[16:31]
  s_add_u32 s60, s61, 83072
  buffer_load_dwordx4 v11, s[20:23], s60 offen offset:3072 lds
  s_add_u32 m0, s62, 69632
  s_add_u32 s60, s61, 114816
  buffer_load_dwordx4 v11, s[20:23], s60 offen offset:0 lds
  s_waitcnt vmcnt(38)
  v_mfma_f32_32x32x16_bf16 v[32:47], v[228:231], v[112:115], v[32:47]
  s_add_u32 s60, s61, 142464
  buffer_load_dwordx4 v11, s[20:23], s60 offen offset:1024 lds
  s_waitcnt vmcnt(38)
  v_mfma_f32_32x32x16_bf16 v[32:47], v[236:239], v[116:119], v[32:47]
  s_add_u32 s60, s61, 170112
  buffer_load_dwordx4 v11, s[20:23], s60 offen offset:2048 lds
  s_waitcnt vmcnt(38)
  v_mfma_f32_32x32x16_bf16 v[32:47], v[244:247], v[120:123], v[32:47]
  s_add_u32 s60, s61, 197760
  buffer_load_dwordx4 v11, s[20:23], s60 offen offset:3072 lds
  s_waitcnt vmcnt(38)
  v_mfma_f32_32x32x16_bf16 v[32:47], v[252:255], v[124:127], v[32:47]
  v_mfma_f32_32x32x16_bf16 v[16:31], v[224:227], v[112:115], v[16:31]
  v_mfma_f32_32x32x16_bf16 v[16:31], v[232:235], v[116:119], v[16:31]
  s_nop 9
  ds_write_b128 v52, v[32:35] offset:0
  v_mfma_f32_32x32x16_bf16 v[16:31], v[240:243], v[120:123], v[16:31]
  ds_write_b128 v52, v[36:39] offset:1024
  v_mfma_f32_32x32x16_bf16 v[16:31], v[248:251], v[124:127], v[16:31]
  ds_write_b128 v52, v[40:43] offset:2048
  ds_write_b128 v52, v[44:47] offset:3072
  v_xor_b32 v52, 0x1000, v52
  s_waitcnt lgkmcnt(0)
  s_barrier
  ds_read_b128 v[64:67], v52 offset:0
  ds_read_b128 v[68:71], v52 offset:1024
  ds_read_b128 v[72:75], v52 offset:2048
  ds_read_b128 v[76:79], v52 offset:3072
  s_waitcnt lgkmcnt(3)
  s_nop 1
  v_pk_add_f32 v[16:17], v[16:17], v[64:65]
  v_pk_add_f32 v[18:19], v[18:19], v[66:67]
  s_waitcnt lgkmcnt(2)
  v_pk_add_f32 v[20:21], v[20:21], v[68:69]
  v_pk_add_f32 v[22:23], v[22:23], v[70:71]
  s_waitcnt lgkmcnt(1)
  v_pk_add_f32 v[24:25], v[24:25], v[72:73]
  v_pk_add_f32 v[26:27], v[26:27], v[74:75]
  s_waitcnt lgkmcnt(0)
  v_pk_add_f32 v[28:29], v[28:29], v[76:77]
  v_pk_add_f32 v[30:31], v[30:31], v[78:79]
  v_cvt_pk_bf16_f32 v80, v16, v17
  v_cvt_pk_bf16_f32 v81, v18, v19
  v_cvt_pk_bf16_f32 v82, v20, v21
  v_cvt_pk_bf16_f32 v83, v22, v23
  v_cvt_pk_bf16_f32 v84, v24, v25
  v_cvt_pk_bf16_f32 v85, v26, v27
  v_cvt_pk_bf16_f32 v86, v28, v29
  v_cvt_pk_bf16_f32 v87, v30, v31
  buffer_store_dwordx4 v[80:83], v1, s[32:35], s55 offen sc1
  buffer_store_dwordx4 v[84:87], v1, s[32:35], s55 offen offset:1024 sc1
  v_pk_add_f32 v[88:89], v[16:17], v[18:19]
  v_pk_mul_f32 v[90:91], v[16:17], v[16:17]
  v_pk_fma_f32 v[90:91], v[18:19], v[18:19], v[90:91]
  v_pk_add_f32 v[88:89], v[88:89], v[20:21]
  v_pk_fma_f32 v[90:91], v[20:21], v[20:21], v[90:91]
  v_pk_add_f32 v[88:89], v[88:89], v[22:23]
  v_pk_fma_f32 v[90:91], v[22:23], v[22:23], v[90:91]
  v_pk_add_f32 v[88:89], v[88:89], v[24:25]
  v_pk_fma_f32 v[90:91], v[24:25], v[24:25], v[90:91]
  v_pk_add_f32 v[88:89], v[88:89], v[26:27]
  v_pk_fma_f32 v[90:91], v[26:27], v[26:27], v[90:91]
  v_pk_add_f32 v[88:89], v[88:89], v[28:29]
  v_pk_fma_f32 v[90:91], v[28:29], v[28:29], v[90:91]
  v_pk_add_f32 v[88:89], v[88:89], v[30:31]
  v_pk_fma_f32 v[90:91], v[30:31], v[30:31], v[90:91]
  v_add_f32 v88, v88, v89
  v_add_f32 v90, v90, v91
  s_nop 1
  v_permlane32_swap_b32 v88, v90
  v_add_f32 v88, v88, v90
  buffer_store_dword v88, v15, s[28:31], s56 offen sc1
  s_mul_i32 s96, s6, 8192
  s_add_u32 s96, s96, 98304
  v_add_u32 v13, s96, v4
  s_waitcnt vmcnt(33)
  v_accvgpr_read_b32 v14, a248
  v_lshlrev_b32 v64, 16, v14
  v_and_b32 v65, 0xffff0000, v14
  v_pk_add_f32 v[16:17], v[16:17], v[64:65]
  v_accvgpr_write_b32 a224, v16
  v_accvgpr_write_b32 a225, v17
  v_accvgpr_read_b32 v14, a249
  v_lshlrev_b32 v64, 16, v14
  v_and_b32 v65, 0xffff0000, v14
  v_pk_add_f32 v[18:19], v[18:19], v[64:65]
  v_accvgpr_write_b32 a226, v18
  v_accvgpr_write_b32 a227, v19
  ds_read_b64_tr_b16 a[184:185], v13 offset:0
  ds_read_b64_tr_b16 a[186:187], v13 offset:256
  ds_read_b64_tr_b16 a[188:189], v13 offset:512
  ds_read_b64_tr_b16 a[190:191], v13 offset:768
  ds_read_b64_tr_b16 a[192:193], v13 offset:2048
  ds_read_b64_tr_b16 a[194:195], v13 offset:2304
  ds_read_b64_tr_b16 a[196:197], v13 offset:2560
  ds_read_b64_tr_b16 a[198:199], v13 offset:2816
  ds_read_b64_tr_b16 a[200:201], v13 offset:4096
  ds_read_b64_tr_b16 a[202:203], v13 offset:4352
  ds_read_b64_tr_b16 a[204:205], v13 offset:4608
  ds_read_b64_tr_b16 a[206:207], v13 offset:4864
  ds_read_b64_tr_b16 a[208:209], v13 offset:6144
  ds_read_b64_tr_b16 a[210:211], v13 offset:6400
  ds_read_b64_tr_b16 a[212:213], v13 offset:6656
  ds_read_b64_tr_b16 a[214:215], v13 offset:6912
  s_mul_i32 s96, s6, 2048
  s_add_u32 s96, s96, 147648
  v_add_u32 v13, s96, v4
  v_accvgpr_read_b32 v14, a250
  v_lshlrev_b32 v64, 16, v14
  v_and_b32 v65, 0xffff0000, v14
  v_pk_add_f32 v[20:21], v[20:21], v[64:65]
  v_accvgpr_write_b32 a228, v20
  v_accvgpr_write_b32 a229, v21
  s_waitcnt vmcnt(27)
  ds_read_b64_tr_b16 a[216:217], v13 offset:0
  ds_read_b64_tr_b16 a[218:219], v13 offset:256
  ds_read_b64_tr_b16 a[220:221], v13 offset:512
  ds_read_b64_tr_b16 a[222:223], v13 offset:768
  s_lshl_b32 s54, s6, 14
  v_add_u32 v122, s54, v4
  s_lshl_b32 s54, s6, 13
  v_add_u32 v13, s54, v5
  v_accvgpr_read_b32 v14, a251
  v_lshlrev_b32 v64, 16, v14
  v_and_b32 v65, 0xffff0000, v14
  v_pk_add_f32 v[22:23], v[22:23], v[64:65]
  v_accvgpr_write_b32 a230, v22
  v_accvgpr_write_b32 a231, v23
  v_accvgpr_read_b32 v14, a252
  v_lshlrev_b32 v64, 16, v14
  v_and_b32 v65, 0xffff0000, v14
  v_pk_add_f32 v[24:25], v[24:25], v[64:65]
  v_accvgpr_write_b32 a232, v24
  v_accvgpr_write_b32 a233, v25
  v_accvgpr_read_b32 v14, a253
  v_lshlrev_b32 v64, 16, v14
  v_and_b32 v65, 0xffff0000, v14
  v_pk_add_f32 v[26:27], v[26:27], v[64:65]
  v_accvgpr_write_b32 a234, v26
  v_accvgpr_write_b32 a235, v27
  v_accvgpr_read_b32 v14, a254
  v_lshlrev_b32 v64, 16, v14
  v_and_b32 v65, 0xffff0000, v14
  v_pk_add_f32 v[28:29], v[28:29], v[64:65]
  v_accvgpr_write_b32 a236, v28
  v_accvgpr_write_b32 a237, v29
  s_waitcnt vmcnt(11)
  ds_read_b64_tr_b16 v[128:129], v122 offset:0
  ds_read_b64_tr_b16 v[130:131], v122 offset:256
  ds_read_b64_tr_b16 v[132:133], v122 offset:512
  ds_read_b64_tr_b16 v[134:135], v122 offset:768
  ds_read_b64_tr_b16 v[136:137], v122 offset:2048
  ds_read_b64_tr_b16 v[138:139], v122 offset:2304
  ds_read_b64_tr_b16 v[140:141], v122 offset:2560
  ds_read_b64_tr_b16 v[142:143], v122 offset:2816
  ds_read_b64_tr_b16 v[144:145], v122 offset:4096
  ds_read_b64_tr_b16 v[146:147], v122 offset:4352
  ds_read_b64_tr_b16 v[148:149], v122 offset:4608
  ds_read_b64_tr_b16 v[150:151], v122 offset:4864
  ds_read_b64_tr_b16 v[152:153], v122 offset:6144
  ds_read_b64_tr_b16 v[154:155], v122 offset:6400
  ds_read_b64_tr_b16 v[156:157], v122 offset:6656
  ds_read_b64_tr_b16 v[158:159], v122 offset:6912
  ds_read_b64_tr_b16 v[160:161], v122 offset:8192
  ds_read_b64_tr_b16 v[162:163], v122 offset:8448
  ds_read_b64_tr_b16 v[164:165], v122 offset:8704
  ds_read_b64_tr_b16 v[166:167], v122 offset:8960
  ds_read_b64_tr_b16 v[168:169], v122 offset:10240
  ds_read_b64_tr_b16 v[170:171], v122 offset:10496
  ds_read_b64_tr_b16 v[172:173], v122 offset:10752
  ds_read_b64_tr_b16 v[174:175], v122 offset:11008
  ds_read_b64_tr_b16 v[176:177], v122 offset:12288
  ds_read_b64_tr_b16 v[178:179], v122 offset:12544
  ds_read_b64_tr_b16 v[180:181], v122 offset:12800
  ds_read_b64_tr_b16 v[182:183], v122 offset:13056
  ds_read_b64_tr_b16 v[184:185], v122 offset:14336
  ds_read_b64_tr_b16 v[186:187], v122 offset:14592
  ds_read_b64_tr_b16 v[188:189], v122 offset:14848
  ds_read_b64_tr_b16 v[190:191], v122 offset:15104
  s_waitcnt vmcnt(3)
  ds_read_b64_tr_b16 v[192:193], v13 offset:0
  ds_read_b64_tr_b16 v[194:195], v13 offset:256
  ds_read_b64_tr_b16 v[196:197], v13 offset:512
  ds_read_b64_tr_b16 v[198:199], v13 offset:768
  ds_read_b64_tr_b16 v[200:201], v13 offset:2048
  ds_read_b64_tr_b16 v[202:203], v13 offset:2304
  ds_read_b64_tr_b16 v[204:205], v13 offset:2560
  ds_read_b64_tr_b16 v[206:207], v13 offset:2816
  ds_read_b64_tr_b16 v[208:209], v13 offset:4096
  ds_read_b64_tr_b16 v[210:211], v13 offset:4352
  ds_read_b64_tr_b16 v[212:213], v13 offset:4608
  ds_read_b64_tr_b16 v[214:215], v13 offset:4864
  ds_read_b64_tr_b16 v[216:217], v13 offset:6144
  ds_read_b64_tr_b16 v[218:219], v13 offset:6400
  ds_read_b64_tr_b16 v[220:221], v13 offset:6656
  ds_read_b64_tr_b16 v[222:223], v13 offset:6912
  v_lshrrev_b32 v60, 2, v0
  v_xor_b32 v60, v60, v0
  v_bfe_u32 v60, v60, 2, 1
  v_add_u32 v60, -1, v60
  v_and_b32 v60, 0x3f803f80, v60
  v_mov_b32 v61, v60
  v_mov_b64 v[62:63], v[60:61]
  v_accvgpr_read_b32 v14, a255
  v_lshlrev_b32 v64, 16, v14
  v_and_b32 v65, 0xffff0000, v14
  v_pk_add_f32 v[30:31], v[30:31], v[64:65]
  v_accvgpr_write_b32 a238, v30
  v_accvgpr_write_b32 a239, v31
  s_lshr_b32 s96, s6, 1
  s_lshl_b32 s96, s96, 9
  s_and_b32 s97, s6, 1
  s_lshl_b32 s97, s97, 3
  s_add_u32 s96, s96, s97
  s_add_u32 s96, s96, 156160
  v_and_b32 v123, 0x1f0, v1
  v_add_u32 v123, s96, v123
  v_and_b32 v14, 0x1c0, v1
  v_or_b32 v14, 16711680, v14
  s_cmp_eq_u32 s51, 0
  s_waitcnt vmcnt(0)
  buffer_store_byte_d16_hi v14, v14, s[28:31], s9 offen offset:3072
  v_mov_b32 v14, 3
  s_cbranch_scc1 L45
  buffer_store_dword v14, off, s[28:31], s52
L46:
  s_cmp_ge_u32 s5, 14
  s_cbranch_scc1 L47
  s_waitcnt lgkmcnt(15)
  v_mfma_f32_16x16x32_bf16 v[96:99], v[60:63], v[128:131], 0
  v_mfma_f32_16x16x32_bf16 v[100:103], v[60:63], v[132:135], 0
  v_mfma_f32_16x16x32_bf16 v[96:99], v[60:63], v[136:139], v[96:99]
  v_mfma_f32_16x16x32_bf16 v[100:103], v[60:63], v[140:143], v[100:103]
  v_mfma_f32_16x16x32_bf16 v[96:99], v[60:63], v[144:147], v[96:99]
  v_mfma_f32_16x16x32_bf16 v[100:103], v[60:63], v[148:151], v[100:103]
  v_mfma_f32_16x16x32_bf16 v[96:99], v[60:63], v[152:155], v[96:99]
  v_mfma_f32_16x16x32_bf16 v[100:103], v[60:63], v[156:159], v[100:103]
  v_mfma_f32_16x16x32_bf16 v[96:99], v[60:63], v[160:163], v[96:99]
  v_mfma_f32_16x16x32_bf16 v[100:103], v[60:63], v[164:167], v[100:103]
  v_mfma_f32_16x16x32_bf16 v[96:99], v[60:63], v[168:171], v[96:99]
  v_mfma_f32_16x16x32_bf16 v[100:103], v[60:63], v[172:175], v[100:103]
  v_mfma_f32_16x16x32_bf16 v[96:99], v[60:63], v[176:179], v[96:99]
  v_mfma_f32_16x16x32_bf16 v[100:103], v[60:63], v[180:183], v[100:103]
  v_mfma_f32_16x16x32_bf16 v[96:99], v[60:63], v[184:187], v[96:99]
  v_mfma_f32_16x16x32_bf16 v[100:103], v[60:63], v[188:191], v[100:103]
  s_waitcnt lgkmcnt(14)
  v_mfma_f32_16x16x32_bf16 v[52:55], v[60:63], v[192:195], 0
  s_waitcnt lgkmcnt(12)
  v_mfma_f32_16x16x32_bf16 v[56:59], v[60:63], v[196:199], 0
  s_waitcnt lgkmcnt(10)
  v_mfma_f32_16x16x32_bf16 v[52:55], v[60:63], v[200:203], v[52:55]
  s_waitcnt lgkmcnt(8)
  v_mfma_f32_16x16x32_bf16 v[56:59], v[60:63], v[204:207], v[56:59]
  s_waitcnt lgkmcnt(6)
  v_mfma_f32_16x16x32_bf16 v[52:55], v[60:63], v[208:211], v[52:55]
  s_waitcnt lgkmcnt(4)
  v_mfma_f32_16x16x32_bf16 v[56:59], v[60:63], v[212:215], v[56:59]
  s_waitcnt lgkmcnt(2)
  v_mfma_f32_16x16x32_bf16 v[52:55], v[60:63], v[216:219], v[52:55]
  s_waitcnt lgkmcnt(0)
  v_mfma_f32_16x16x32_bf16 v[56:59], v[60:63], v[220:223], v[56:59]
  v_cvt_pk_bf16_f32 v98, v96, v96
  v_lshlrev_b32 v97, 16, v98
  v_sub_f32 v97, v96, v97
  v_and_b32 v99, 0xffff, v98
  v_cvt_pk_bf16_f32 v98, v96, v97
  v_lshl_or_b32 v99, v48, 16, v99
  v_cvt_pk_bf16_f32 v102, v100, v100
  v_lshlrev_b32 v101, 16, v102
  v_sub_f32 v101, v100, v101
  v_and_b32 v103, 0xffff, v102
  v_cvt_pk_bf16_f32 v102, v100, v101
  v_lshl_or_b32 v103, v49, 16, v103
  ds_write_b64 v123, v[98:99] offset:3072
  ds_write_b64 v123, v[102:103] offset:4096
  s_waitcnt lgkmcnt(0)
  s_barrier
  v_add_u32 v15, 159232, v1
L50:
  ds_read_b64_tr_b16 v[64:65], v4 offset:0
  ds_read_b64_tr_b16 v[66:67], v4 offset:256
  ds_read_b64_tr_b16 v[68:69], v4 offset:512
  ds_read_b64_tr_b16 v[70:71], v4 offset:768
  ds_read_b64_tr_b16 v[72:73], v4 offset:2048
  ds_read_b64_tr_b16 v[74:75], v4 offset:2304
  ds_read_b64_tr_b16 v[76:77], v4 offset:2560
  ds_read_b64_tr_b16 v[78:79], v4 offset:2816
  ds_read_b64_tr_b16 v[80:81], v4 offset:4096
  ds_read_b64_tr_b16 v[82:83], v4 offset:4352
  ds_read_b64_tr_b16 v[84:85], v4 offset:4608
  ds_read_b64_tr_b16 v[86:87], v4 offset:4864
  s_lshl_b32 s57, s48, 17
  s_lshl_b32 s58, s5, 13
  s_add_u32 s57, s57, s58
  s_add_u32 s57, s57, 12582912
  s_cmp_ge_u32 s5, 14
  s_cselect_b32 s57, 1073741824, s57
  s_add_u32 s58, s57, 4096
  s_lshl_b32 s55, s48, 2
  s_add_u32 s55, s55, s0
  s_lshl_b32 s55, s55, 13
  s_add_u32 s55, s55, 0
  s_lshl_b32 s56, s48, 12
  s_add_u32 s56, s56, 11534336
  v_lshlrev_b32 v111, 2, v0
  s_cmp_ge_u32 s5, 14
  s_cselect_b32 s55, 1073741824, s55
  s_cselect_b32 s56, 1073741824, s56
  s_buffer_load_dwordx4 s[44:47], s[28:31], s38 offset:3072
  s_waitcnt lgkmcnt(0)
  s_nand_b64 s[44:45], s[44:45], s[46:47]
  s_cbranch_scc1 L51
L52:
  s_xor_b32 s54, s55, 0
  buffer_load_dwordx4 v[128:131], v1, s[32:35], s54 offen offset:0 sc1
  buffer_load_dwordx4 v[132:135], v1, s[32:35], s54 offen offset:1024 sc1
  buffer_load_dwordx4 v[136:139], v1, s[32:35], s54 offen offset:2048 sc1
  buffer_load_dwordx4 v[140:143], v1, s[32:35], s54 offen offset:3072 sc1
  s_xor_b32 s54, s55, 4096
  buffer_load_dwordx4 v[144:147], v1, s[32:35], s54 offen offset:0 sc1
  buffer_load_dwordx4 v[148:151], v1, s[32:35], s54 offen offset:1024 sc1
  buffer_load_dwordx4 v[152:155], v1, s[32:35], s54 offen offset:2048 sc1
  buffer_load_dwordx4 v[156:159], v1, s[32:35], s54 offen offset:3072 sc1
  s_xor_b32 s54, s55, 8192
  buffer_load_dwordx4 v[160:163], v1, s[32:35], s54 offen offset:0 sc1
  buffer_load_dwordx4 v[164:167], v1, s[32:35], s54 offen offset:1024 sc1
  buffer_load_dwordx4 v[168:171], v1, s[32:35], s54 offen offset:2048 sc1
  buffer_load_dwordx4 v[172:175], v1, s[32:35], s54 offen offset:3072 sc1
  s_xor_b32 s54, s55, 12288
  buffer_load_dwordx4 v[176:179], v1, s[32:35], s54 offen offset:0 sc1
  buffer_load_dwordx4 v[180:183], v1, s[32:35], s54 offen offset:1024 sc1
  ds_read_b64_tr_b16 v[88:89], v4 offset:6144
  ds_read_b64_tr_b16 v[90:91], v4 offset:6400
  ds_read_b64_tr_b16 v[92:93], v4 offset:6656
  ds_read_b64_tr_b16 v[94:95], v4 offset:6912
  s_waitcnt vmcnt(13)
  v_mfma_f32_32x32x16_bf16 v[16:31], v[64:67], v[128:131], 0
  v_mfma_f32_32x32x16_bf16 v[32:47], v[68:71], v[128:131], 0
  buffer_load_dwordx4 v[184:187], v1, s[32:35], s54 offen offset:2048 sc1
  ds_read_b64_tr_b16 v[64:65], v4 offset:8192
  ds_read_b64_tr_b16 v[66:67], v4 offset:8448
  ds_read_b64_tr_b16 v[68:69], v4 offset:8704
  ds_read_b64_tr_b16 v[70:71], v4 offset:8960
  s_waitcnt vmcnt(13)
  v_mfma_f32_32x32x16_bf16 v[16:31], v[72:75], v[132:135], v[16:31]
  v_mfma_f32_32x32x16_bf16 v[32:47], v[76:79], v[132:135], v[32:47]
  buffer_load_dwordx4 v[188:191], v1, s[32:35], s54 offen offset:3072 sc1
  ds_read_b64_tr_b16 v[72:73], v4 offset:10240
  ds_read_b64_tr_b16 v[74:75], v4 offset:10496
  ds_read_b64_tr_b16 v[76:77], v4 offset:10752
  ds_read_b64_tr_b16 v[78:79], v4 offset:11008
  s_waitcnt vmcnt(13)
  v_mfma_f32_32x32x16_bf16 v[16:31], v[80:83], v[136:139], v[16:31]
  v_mfma_f32_32x32x16_bf16 v[32:47], v[84:87], v[136:139], v[32:47]
  buffer_load_dword v96, v111, s[28:31], s56 offen offset:0 sc1
  buffer_load_dword v97, v111, s[28:31], s56 offen offset:256 sc1
  buffer_load_dword v98, v111, s[28:31], s56 offen offset:512 sc1
  buffer_load_dword v99, v111, s[28:31], s56 offen offset:768 sc1
  ds_read_b64_tr_b16 v[80:81], v4 offset:12288
  ds_read_b64_tr_b16 v[82:83], v4 offset:12544
  ds_read_b64_tr_b16 v[84:85], v4 offset:12800
  ds_read_b64_tr_b16 v[86:87], v4 offset:13056
  s_waitcnt vmcnt(16) lgkmcnt(14)
  v_mfma_f32_32x32x16_bf16 v[16:31], v[88:91], v[140:143], v[16:31]
  s_waitcnt lgkmcnt(12)
  v_mfma_f32_32x32x16_bf16 v[32:47], v[92:95], v[140:143], v[32:47]
  buffer_load_dword v100, v111, s[28:31], s56 offen offset:1024 sc1
  buffer_load_dword v101, v111, s[28:31], s56 offen offset:1280 sc1
  buffer_load_dword v102, v111, s[28:31], s56 offen offset:1536 sc1
  buffer_load_dword v103, v111, s[28:31], s56 offen offset:1792 sc1
  ds_read_b64_tr_b16 v[88:89], v4 offset:14336
  ds_read_b64_tr_b16 v[90:91], v4 offset:14592
  ds_read_b64_tr_b16 v[92:93], v4 offset:14848
  ds_read_b64_tr_b16 v[94:95], v4 offset:15104
  s_waitcnt vmcnt(19) lgkmcnt(14)
  v_mfma_f32_32x32x16_bf16 v[16:31], v[64:67], v[144:147], v[16:31]
  s_waitcnt lgkmcnt(12)
  v_mfma_f32_32x32x16_bf16 v[32:47], v[68:71], v[144:147], v[32:47]
  buffer_load_dword v104, v111, s[28:31], s56 offen offset:2048 sc1
  buffer_load_dword v105, v111, s[28:31], s56 offen offset:2304 sc1
  buffer_load_dword v106, v111, s[28:31], s56 offen offset:2560 sc1
  buffer_load_dword v107, v111, s[28:31], s56 offen offset:2816 sc1
  ds_read_b64_tr_b16 v[64:65], v4 offset:16384
  ds_read_b64_tr_b16 v[66:67], v4 offset:16640
  ds_read_b64_tr_b16 v[68:69], v4 offset:16896
  ds_read_b64_tr_b16 v[70:71], v4 offset:17152
  s_waitcnt vmcnt(22) lgkmcnt(14)
  v_mfma_f32_32x32x16_bf16 v[16:31], v[72:75], v[148:151], v[16:31]
  s_waitcnt lgkmcnt(12)
  v_mfma_f32_32x32x16_bf16 v[32:47], v[76:79], v[148:151], v[32:47]
  buffer_load_dword v108, v111, s[28:31], s56 offen offset:3072 sc1
  buffer_load_dword v109, v111, s[28:31], s56 offen offset:3328 sc1
  buffer_load_dword v110, v111, s[28:31], s56 offen offset:3584 sc1
  buffer_load_dword v111, v111, s[28:31], s56 offen offset:3840 sc1
  ds_read_b64_tr_b16 v[72:73], v4 offset:18432
  ds_read_b64_tr_b16 v[74:75], v4 offset:18688
  ds_read_b64_tr_b16 v[76:77], v4 offset:18944
  ds_read_b64_tr_b16 v[78:79], v4 offset:19200
  s_waitcnt vmcnt(25) lgkmcnt(14)
  v_mfma_f32_32x32x16_bf16 v[16:31], v[80:83], v[152:155], v[16:31]
  s_waitcnt lgkmcnt(12)
  v_mfma_f32_32x32x16_bf16 v[32:47], v[84:87], v[152:155], v[32:47]
  s_xor_b32 s54, s55, 16384
  buffer_load_dwordx4 v[192:195], v1, s[32:35], s54 offen offset:0 sc1
  ds_read_b64_tr_b16 v[80:81], v4 offset:20480
  ds_read_b64_tr_b16 v[82:83], v4 offset:20736
  ds_read_b64_tr_b16 v[84:85], v4 offset:20992
  ds_read_b64_tr_b16 v[86:87], v4 offset:21248
  s_waitcnt vmcnt(25) lgkmcnt(14)
  v_mfma_f32_32x32x16_bf16 v[16:31], v[88:91], v[156:159], v[16:31]
  s_waitcnt lgkmcnt(12)
  v_mfma_f32_32x32x16_bf16 v[32:47], v[92:95], v[156:159], v[32:47]
  buffer_load_dwordx4 v[196:199], v1, s[32:35], s54 offen offset:1024 sc1
  ds_read_b64_tr_b16 v[88:89], v4 offset:22528
  ds_read_b64_tr_b16 v[90:91], v4 offset:22784
  ds_read_b64_tr_b16 v[92:93], v4 offset:23040
  ds_read_b64_tr_b16 v[94:95], v4 offset:23296
  s_waitcnt vmcnt(25) lgkmcnt(14)
  v_mfma_f32_32x32x16_bf16 v[16:31], v[64:67], v[160:163], v[16:31]
  s_waitcnt lgkmcnt(12)
  v_mfma_f32_32x32x16_bf16 v[32:47], v[68:71], v[160:163], v[32:47]
  buffer_load_dwordx4 v[200:203], v1, s[32:35], s54 offen offset:2048 sc1
  ds_read_b64_tr_b16 v[64:65], v4 offset:24576
  ds_read_b64_tr_b16 v[66:67], v4 offset:24832
  ds_read_b64_tr_b16 v[68:69], v4 offset:25088
  ds_read_b64_tr_b16 v[70:71], v4 offset:25344
  s_waitcnt vmcnt(25) lgkmcnt(14)
  v_mfma_f32_32x32x16_bf16 v[16:31], v[72:75], v[164:167], v[16:31]
  s_waitcnt lgkmcnt(12)
  v_mfma_f32_32x32x16_bf16 v[32:47], v[76:79], v[164:167], v[32:47]
  buffer_load_dwordx4 v[204:207], v1, s[32:35], s54 offen offset:3072 sc1
  ds_read_b64_tr_b16 v[72:73], v4 offset:26624
  ds_read_b64_tr_b16 v[74:75], v4 offset:26880
  ds_read_b64_tr_b16 v[76:77], v4 offset:27136
  ds_read_b64_tr_b16 v[78:79], v4 offset:27392
  s_waitcnt vmcnt(25) lgkmcnt(14)
  v_mfma_f32_32x32x16_bf16 v[16:31], v[80:83], v[168:171], v[16:31]
  s_waitcnt lgkmcnt(12)
  v_mfma_f32_32x32x16_bf16 v[32:47], v[84:87], v[168:171], v[32:47]
  s_xor_b32 s54, s55, 20480
  buffer_load_dwordx4 v[208:211], v1, s[32:35], s54 offen offset:0 sc1
  ds_read_b64_tr_b16 v[80:81], v4 offset:28672
  ds_read_b64_tr_b16 v[82:83], v4 offset:28928
  ds_read_b64_tr_b16 v[84:85], v4 offset:29184
  ds_read_b64_tr_b16 v[86:87], v4 offset:29440
  s_waitcnt vmcnt(25) lgkmcnt(14)
  v_mfma_f32_32x32x16_bf16 v[16:31], v[88:91], v[172:175], v[16:31]
  s_waitcnt lgkmcnt(12)
  v_mfma_f32_32x32x16_bf16 v[32:47], v[92:95], v[172:175], v[32:47]
  buffer_load_dwordx4 v[212:215], v1, s[32:35], s54 offen offset:1024 sc1
  ds_read_b64_tr_b16 v[88:89], v4 offset:30720
  ds_read_b64_tr_b16 v[90:91], v4 offset:30976
  ds_read_b64_tr_b16 v[92:93], v4 offset:31232
  ds_read_b64_tr_b16 v[94:95], v4 offset:31488
  s_waitcnt vmcnt(25) lgkmcnt(14)
  v_mfma_f32_32x32x16_bf16 v[16:31], v[64:67], v[176:179], v[16:31]
  s_waitcnt lgkmcnt(12)
  v_mfma_f32_32x32x16_bf16 v[32:47], v[68:71], v[176:179], v[32:47]
  buffer_load_dwordx4 v[216:219], v1, s[32:35], s54 offen offset:2048 sc1
  ds_read_b64_tr_b16 v[64:65], v4 offset:32768
  ds_read_b64_tr_b16 v[66:67], v4 offset:33024
  ds_read_b64_tr_b16 v[68:69], v4 offset:33280
  ds_read_b64_tr_b16 v[70:71], v4 offset:33536
  s_waitcnt vmcnt(25) lgkmcnt(14)
  v_mfma_f32_32x32x16_bf16 v[16:31], v[72:75], v[180:183], v[16:31]
  s_waitcnt lgkmcnt(12)
  v_mfma_f32_32x32x16_bf16 v[32:47], v[76:79], v[180:183], v[32:47]
  buffer_load_dwordx4 v[220:223], v1, s[32:35], s54 offen offset:3072 sc1
  ds_read_b64_tr_b16 v[72:73], v4 offset:34816
  ds_read_b64_tr_b16 v[74:75], v4 offset:35072
  ds_read_b64_tr_b16 v[76:77], v4 offset:35328
  ds_read_b64_tr_b16 v[78:79], v4 offset:35584
  s_waitcnt vmcnt(25) lgkmcnt(14)
  v_mfma_f32_32x32x16_bf16 v[16:31], v[80:83], v[184:187], v[16:31]
  s_waitcnt lgkmcnt(12)
  v_mfma_f32_32x32x16_bf16 v[32:47], v[84:87], v[184:187], v[32:47]
  s_xor_b32 s54, s55, 24576
  buffer_load_dwordx4 v[224:227], v1, s[32:35], s54 offen offset:0 sc1
  ds_read_b64_tr_b16 v[80:81], v4 offset:36864
  ds_read_b64_tr_b16 v[82:83], v4 offset:37120
  ds_read_b64_tr_b16 v[84:85], v4 offset:37376
  ds_read_b64_tr_b16 v[86:87], v4 offset:37632
  s_waitcnt vmcnt(25) lgkmcnt(14)
  v_mfma_f32_32x32x16_bf16 v[16:31], v[88:91], v[188:191], v[16:31]
  s_waitcnt lgkmcnt(12)
  v_mfma_f32_32x32x16_bf16 v[32:47], v[92:95], v[188:191], v[32:47]
  buffer_load_dwordx4 v[228:231], v1, s[32:35], s54 offen offset:1024 sc1
  ds_read_b64_tr_b16 v[88:89], v4 offset:38912
  ds_read_b64_tr_b16 v[90:91], v4 offset:39168
  ds_read_b64_tr_b16 v[92:93], v4 offset:39424
  ds_read_b64_tr_b16 v[94:95], v4 offset:39680
  s_waitcnt vmcnt(9) lgkmcnt(14)
  v_mfma_f32_32x32x16_bf16 v[16:31], v[64:67], v[192:195], v[16:31]
  s_waitcnt lgkmcnt(12)
  v_mfma_f32_32x32x16_bf16 v[32:47], v[68:71], v[192:195], v[32:47]
  buffer_load_dwordx4 v[232:235], v1, s[32:35], s54 offen offset:2048 sc1
  ds_read_b64_tr_b16 v[64:65], v4 offset:40960
  ds_read_b64_tr_b16 v[66:67], v4 offset:41216
  ds_read_b64_tr_b16 v[68:69], v4 offset:41472
  ds_read_b64_tr_b16 v[70:71], v4 offset:41728
  s_waitcnt vmcnt(9) lgkmcnt(14)
  v_mfma_f32_32x32x16_bf16 v[16:31], v[72:75], v[196:199], v[16:31]
  s_waitcnt lgkmcnt(12)
  v_mfma_f32_32x32x16_bf16 v[32:47], v[76:79], v[196:199], v[32:47]
  buffer_load_dwordx4 v[236:239], v1, s[32:35], s54 offen offset:3072 sc1
  ds_read_b64_tr_b16 v[72:73], v4 offset:43008
  ds_read_b64_tr_b16 v[74:75], v4 offset:43264
  ds_read_b64_tr_b16 v[76:77], v4 offset:43520
  ds_read_b64_tr_b16 v[78:79], v4 offset:43776
  s_waitcnt vmcnt(9) lgkmcnt(14)
  v_mfma_f32_32x32x16_bf16 v[16:31], v[80:83], v[200:203], v[16:31]
  s_waitcnt lgkmcnt(12)
  v_mfma_f32_32x32x16_bf16 v[32:47], v[84:87], v[200:203], v[32:47]
  s_xor_b32 s54, s55, 28672
  buffer_load_dwordx4 v[240:243], v1, s[32:35], s54 offen offset:0 sc1
  ds_read_b64_tr_b16 v[80:81], v4 offset:45056
  ds_read_b64_tr_b16 v[82:83], v4 offset:45312
  ds_read_b64_tr_b16 v[84:85], v4 offset:45568
  ds_read_b64_tr_b16 v[86:87], v4 offset:45824
  v_add_f32 v96, v96, v104
  v_add_f32 v97, v97, v105
  v_add_f32 v98, v98, v106
  v_add_f32 v99, v99, v107
  v_add_f32 v100, v100, v108
  v_add_f32 v101, v101, v109
  v_add_f32 v102, v102, v110
  s_waitcnt vmcnt(9) lgkmcnt(14)
  v_mfma_f32_32x32x16_bf16 v[16:31], v[88:91], v[204:207], v[16:31]
  s_waitcnt lgkmcnt(12)
  v_mfma_f32_32x32x16_bf16 v[32:47], v[92:95], v[204:207], v[32:47]
  buffer_load_dwordx4 v[244:247], v1, s[32:35], s54 offen offset:1024 sc1
  ds_read_b64_tr_b16 v[88:89], v4 offset:47104
  ds_read_b64_tr_b16 v[90:91], v4 offset:47360
  ds_read_b64_tr_b16 v[92:93], v4 offset:47616
  ds_read_b64_tr_b16 v[94:95], v4 offset:47872
  v_add_f32 v103, v103, v111
  v_add_f32 v96, v96, v100
  v_add_f32 v97, v97, v101
  v_add_f32 v98, v98, v102
  v_add_f32 v99, v99, v103
  v_add_f32 v96, v96, v98
  s_waitcnt vmcnt(9) lgkmcnt(14)
  v_mfma_f32_32x32x16_bf16 v[16:31], v[64:67], v[208:211], v[16:31]
  s_waitcnt lgkmcnt(12)
  v_mfma_f32_32x32x16_bf16 v[32:47], v[68:71], v[208:211], v[32:47]
  buffer_load_dwordx4 v[248:251], v1, s[32:35], s54 offen offset:2048 sc1
  v_add_f32 v97, v97, v99
  v_add_f32 v96, v96, v97
  v_mov_b32 v97, v96
  s_nop 0
  s_nop 0
  v_permlane32_swap_b32 v96, v97
  s_waitcnt vmcnt(9) lgkmcnt(10)
  v_mfma_f32_32x32x16_bf16 v[16:31], v[72:75], v[212:215], v[16:31]
  s_waitcnt lgkmcnt(8)
  ds_read_b64_tr_b16 v[64:65], v4 offset:49152
  ds_read_b64_tr_b16 v[66:67], v4 offset:49408
  ds_read_b64_tr_b16 v[68:69], v4 offset:49664
  ds_read_b64_tr_b16 v[70:71], v4 offset:49920
  v_mfma_f32_32x32x16_bf16 v[32:47], v[76:79], v[212:215], v[32:47]
  buffer_load_dwordx4 v[252:255], v1, s[32:35], s54 offen offset:3072 sc1
  s_mov_b32 s99, 0x3b000000
  v_mul_f32 v96, 0xbb000000, v96
  v_mul_f32 v98, v96, v96
  v_fma_f32 v97, v97, s99, -v98
  v_cvt_pk_bf16_f32 v112, v96, v96
  v_max_f32 v97, 0, v97
  s_waitcnt vmcnt(9) lgkmcnt(10)
  v_mfma_f32_32x32x16_bf16 v[16:31], v[80:83], v[216:219], v[16:31]
  s_waitcnt lgkmcnt(8)
  ds_read_b64_tr_b16 v[72:73], v4 offset:51200
  ds_read_b64_tr_b16 v[74:75], v4 offset:51456
  ds_read_b64_tr_b16 v[76:77], v4 offset:51712
  ds_read_b64_tr_b16 v[78:79], v4 offset:51968
  v_mfma_f32_32x32x16_bf16 v[32:47], v[84:87], v[216:219], v[32:47]
  s_lshl_b32 s61, s0, 1
  s_xor_b32 s61, s61, s6
  s_xor_b32 s61, s61, 4
  s_mul_i32 s61, s61, 229376
  s_lshl_b32 s62, s5, 8
  s_add_u32 s61, s61, s62
  s_cmp_ge_u32 s5, 14
  s_cselect_b32 s61, 1073741824, s61
  s_lshl_b32 s62, s6, 13
  s_add_u32 m0, s62, 98304
  s_add_u32 s60, s61, 128
  buffer_load_dwordx4 v11, s[20:23], s60 offen offset:0 lds
  ds_read_b64_tr_b16 v[80:81], v4 offset:53248
  ds_read_b64_tr_b16 v[82:83], v4 offset:53504
  ds_read_b64_tr_b16 v[84:85], v4 offset:53760
  ds_read_b64_tr_b16 v[86:87], v4 offset:54016
  s_waitcnt vmcnt(9) lgkmcnt(14)
  v_mfma_f32_32x32x16_bf16 v[16:31], v[88:91], v[220:223], v[16:31]
  s_waitcnt lgkmcnt(12)
  v_mfma_f32_32x32x16_bf16 v[32:47], v[92:95], v[220:223], v[32:47]
  s_add_u32 s60, s61, 27776
  buffer_load_dwordx4 v11, s[20:23], s60 offen offset:1024 lds
  ds_read_b64_tr_b16 v[88:89], v4 offset:55296
  ds_read_b64_tr_b16 v[90:91], v4 offset:55552
  ds_read_b64_tr_b16 v[92:93], v4 offset:55808
  ds_read_b64_tr_b16 v[94:95], v4 offset:56064
  s_waitcnt vmcnt(9) lgkmcnt(14)
  v_mfma_f32_32x32x16_bf16 v[16:31], v[64:67], v[224:227], v[16:31]
  s_waitcnt lgkmcnt(12)
  v_mfma_f32_32x32x16_bf16 v[32:47], v[68:71], v[224:227], v[32:47]
  s_add_u32 s60, s61, 55424
  buffer_load_dwordx4 v11, s[20:23], s60 offen offset:2048 lds
  ds_read_b64_tr_b16 v[64:65], v4 offset:57344
  ds_read_b64_tr_b16 v[66:67], v4 offset:57600
  ds_read_b64_tr_b16 v[68:69], v4 offset:57856
  ds_read_b64_tr_b16 v[70:71], v4 offset:58112
  v_add_f32 v98, 0x3727c5ac, v97
  v_rsq_f32 v122, v98
  v_lshlrev_b32 v99, 16, v112
  v_sub_f32 v99, v96, v99
  s_waitcnt vmcnt(9) lgkmcnt(14)
  v_mfma_f32_32x32x16_bf16 v[16:31], v[72:75], v[228:231], v[16:31]
  s_waitcnt lgkmcnt(12)
  v_mfma_f32_32x32x16_bf16 v[32:47], v[76:79], v[228:231], v[32:47]
  s_add_u32 s60, s61, 83072
  buffer_load_dwordx4 v11, s[20:23], s60 offen offset:3072 lds
  ds_read_b64_tr_b16 v[72:73], v4 offset:59392
  ds_read_b64_tr_b16 v[74:75], v4 offset:59648
  ds_read_b64_tr_b16 v[76:77], v4 offset:59904
  ds_read_b64_tr_b16 v[78:79], v4 offset:60160
  v_mul_f32 v97, v97, v122
  v_mul_f32 v97, v97, v122
  v_add_f32 v97, 0x3727c5ac, v97
  v_rsq_f32 v97, v97
  s_waitcnt vmcnt(9) lgkmcnt(14)
  v_mfma_f32_32x32x16_bf16 v[16:31], v[80:83], v[232:235], v[16:31]
  s_waitcnt lgkmcnt(12)
  v_mfma_f32_32x32x16_bf16 v[32:47], v[84:87], v[232:235], v[32:47]
  s_add_u32 m0, s62, 102400
  s_add_u32 s60, s61, 114816
  buffer_load_dwordx4 v11, s[20:23], s60 offen offset:0 lds
  ds_read_b64_tr_b16 v[80:81], v4 offset:61440
  ds_read_b64_tr_b16 v[82:83], v4 offset:61696
  ds_read_b64_tr_b16 v[84:85], v4 offset:61952
  ds_read_b64_tr_b16 v[86:87], v4 offset:62208
  v_mov_b32 v114, v112
  v_mul_f32 v122, v97, v122
  v_rcp_f32 v120, v122
  s_waitcnt vmcnt(9) lgkmcnt(14)
  v_mfma_f32_32x32x16_bf16 v[16:31], v[88:91], v[236:239], v[16:31]
  s_waitcnt lgkmcnt(12)
  v_mfma_f32_32x32x16_bf16 v[32:47], v[92:95], v[236:239], v[32:47]
  s_add_u32 s60, s61, 142464
  buffer_load_dwordx4 v11, s[20:23], s60 offen offset:1024 lds
  ds_read_b64_tr_b16 v[88:89], v4 offset:63488
  ds_read_b64_tr_b16 v[90:91], v4 offset:63744
  ds_read_b64_tr_b16 v[92:93], v4 offset:64000
  ds_read_b64_tr_b16 v[94:95], v4 offset:64256
  v_cvt_pk_bf16_f32 v113, v99, v120
  v_and_b32 v96, 0xffff0000, v113
  v_sub_f32 v96, v120, v96
  v_cvt_pk_bf16_f32 v115, v99, v96
  v_mul_f32 v116, 0xc0135761, v122
  s_waitcnt vmcnt(9) lgkmcnt(14)
  v_mfma_f32_32x32x16_bf16 v[16:31], v[64:67], v[240:243], v[16:31]
  s_waitcnt lgkmcnt(12)
  v_mfma_f32_32x32x16_bf16 v[32:47], v[68:71], v[240:243], v[32:47]
  s_add_u32 s60, s61, 170112
  buffer_load_dwordx4 v11, s[20:23], s60 offen offset:2048 lds
  ds_read_b128 v[64:67], v15 offset:0
  ds_read_b128 v[68:71], v15 offset:1024
  v_mul_f32 v118, v122, v122
  v_mul_f32 v118, v118, v116
  v_mul_f32 v118, 0x3d372713, v118
  s_waitcnt vmcnt(9) lgkmcnt(12)
  v_mfma_f32_32x32x16_bf16 v[16:31], v[72:75], v[244:247], v[16:31]
  s_waitcnt lgkmcnt(10)
  v_mfma_f32_32x32x16_bf16 v[32:47], v[76:79], v[244:247], v[32:47]
  s_add_u32 s60, s61, 197760
  buffer_load_dwordx4 v11, s[20:23], s60 offen offset:3072 lds
  s_waitcnt vmcnt(9) lgkmcnt(8)
  v_mfma_f32_32x32x16_bf16 v[16:31], v[80:83], v[248:251], v[16:31]
  s_waitcnt lgkmcnt(6)
  v_mfma_f32_32x32x16_bf16 v[32:47], v[84:87], v[248:251], v[32:47]
  s_lshl_b32 s96, s4, 4
  s_add_u32 s96, s96, s5
  s_lshl_b32 s96, s96, 2
  s_add_u32 s96, s96, s6
  s_lshl_b32 s96, s96, 9
  s_add_u32 s96, s96, 20971520
  v_and_b32 v14, 0x180, v1
  s_waitcnt vmcnt(8) lgkmcnt(4)
  v_mfma_f32_32x32x16_bf16 v[16:31], v[88:91], v[252:255], v[16:31]
  s_waitcnt lgkmcnt(2)
  buffer_load_dword v14, v14, s[28:31], s96 offen sc1
  v_mfma_f32_32x32x16_bf16 v[32:47], v[92:95], v[252:255], v[32:47]
  s_waitcnt lgkmcnt(1)
  v_mfma_f32_32x32x16_bf16 v[16:31], v[64:67], v[112:115], v[16:31]
  s_waitcnt lgkmcnt(0)
  v_mfma_f32_32x32x16_bf16 v[32:47], v[68:71], v[112:115], v[32:47]
  s_nop 9
  v_pk_mul_f32 v[124:125], v[16:17], v[16:17]
  v_pk_mul_f32 v[126:127], v[18:19], v[18:19]
  v_pk_fma_f32 v[124:125], v[124:125], v[118:119], v[116:117] op_sel_hi:[1,0,0]
  v_pk_fma_f32 v[126:127], v[126:127], v[118:119], v[116:117] op_sel_hi:[1,0,0]
  v_pk_mul_f32 v[124:125], v[124:125], v[16:17]
  v_pk_mul_f32 v[126:127], v[126:127], v[18:19]
  v_exp_f32 v124, v124
  v_exp_f32 v125, v125
  v_exp_f32 v126, v126
  v_exp_f32 v127, v127
  v_pk_fma_f32 v[124:125], v[124:125], v[120:121], v[120:121] op_sel_hi:[1,0,0]
  v_pk_fma_f32 v[126:127], v[126:127], v[120:121], v[120:121] op_sel_hi:[1,0,0]
  v_rcp_f32 v124, v124
  v_rcp_f32 v125, v125
  v_rcp_f32 v126, v126
  v_rcp_f32 v127, v127
  v_pk_mul_f32 v[16:17], v[16:17], v[124:125]
  v_pk_mul_f32 v[18:19], v[18:19], v[126:127]
  v_cvt_pk_bf16_f32 v16, v16, v17
  v_cvt_pk_bf16_f32 v17, v18, v19
  v_pk_mul_f32 v[124:125], v[20:21], v[20:21]
  v_pk_mul_f32 v[126:127], v[22:23], v[22:23]
  v_pk_fma_f32 v[124:125], v[124:125], v[118:119], v[116:117] op_sel_hi:[1,0,0]
  v_pk_fma_f32 v[126:127], v[126:127], v[118:119], v[116:117] op_sel_hi:[1,0,0]
  v_pk_mul_f32 v[124:125], v[124:125], v[20:21]
  v_pk_mul_f32 v[126:127], v[126:127], v[22:23]
  v_exp_f32 v124, v124
  v_exp_f32 v125, v125
  v_exp_f32 v126, v126
  v_exp_f32 v127, v127
  v_pk_fma_f32 v[124:125], v[124:125], v[120:121], v[120:121] op_sel_hi:[1,0,0]
  v_pk_fma_f32 v[126:127], v[126:127], v[120:121], v[120:121] op_sel_hi:[1,0,0]
  v_rcp_f32 v124, v124
  v_rcp_f32 v125, v125
  v_rcp_f32 v126, v126
  v_rcp_f32 v127, v127
  v_pk_mul_f32 v[20:21], v[20:21], v[124:125]
  v_pk_mul_f32 v[22:23], v[22:23], v[126:127]
  v_cvt_pk_bf16_f32 v18, v20, v21
  v_cvt_pk_bf16_f32 v19, v22, v23
  v_pk_mul_f32 v[124:125], v[24:25], v[24:25]
  v_pk_mul_f32 v[126:127], v[26:27], v[26:27]
  v_pk_fma_f32 v[124:125], v[124:125], v[118:119], v[116:117] op_sel_hi:[1,0,0]
  v_pk_fma_f32 v[126:127], v[126:127], v[118:119], v[116:117] op_sel_hi:[1,0,0]
  v_pk_mul_f32 v[124:125], v[124:125], v[24:25]
  v_pk_mul_f32 v[126:127], v[126:127], v[26:27]
  v_exp_f32 v124, v124
  v_exp_f32 v125, v125
  v_exp_f32 v126, v126
  v_exp_f32 v127, v127
  v_pk_fma_f32 v[124:125], v[124:125], v[120:121], v[120:121] op_sel_hi:[1,0,0]
  v_pk_fma_f32 v[126:127], v[126:127], v[120:121], v[120:121] op_sel_hi:[1,0,0]
  v_rcp_f32 v124, v124
  v_rcp_f32 v125, v125
  v_rcp_f32 v126, v126
  v_rcp_f32 v127, v127
  v_pk_mul_f32 v[24:25], v[24:25], v[124:125]
  v_pk_mul_f32 v[26:27], v[26:27], v[126:127]
  v_cvt_pk_bf16_f32 v20, v24, v25
  v_cvt_pk_bf16_f32 v21, v26, v27
  v_pk_mul_f32 v[124:125], v[28:29], v[28:29]
  v_pk_mul_f32 v[126:127], v[30:31], v[30:31]
  v_pk_fma_f32 v[124:125], v[124:125], v[118:119], v[116:117] op_sel_hi:[1,0,0]
  v_pk_fma_f32 v[126:127], v[126:127], v[118:119], v[116:117] op_sel_hi:[1,0,0]
  v_pk_mul_f32 v[124:125], v[124:125], v[28:29]
  v_pk_mul_f32 v[126:127], v[126:127], v[30:31]
  v_exp_f32 v124, v124
  v_exp_f32 v125, v125
  v_exp_f32 v126, v126
  v_exp_f32 v127, v127
  v_pk_fma_f32 v[124:125], v[124:125], v[120:121], v[120:121] op_sel_hi:[1,0,0]
  v_pk_fma_f32 v[126:127], v[126:127], v[120:121], v[120:121] op_sel_hi:[1,0,0]
  v_rcp_f32 v124, v124
  v_rcp_f32 v125, v125
  v_rcp_f32 v126, v126
  v_rcp_f32 v127, v127
  v_pk_mul_f32 v[28:29], v[28:29], v[124:125]
  v_pk_mul_f32 v[30:31], v[30:31], v[126:127]
  v_cvt_pk_bf16_f32 v22, v28, v29
  v_cvt_pk_bf16_f32 v23, v30, v31
  buffer_store_dwordx4 v[16:19], v1, s[28:31], s57 offen offset:0 sc1
  ds_read_b64_tr_b16 v[64:65], v5 offset:0
  ds_read_b64_tr_b16 v[66:67], v5 offset:256
  ds_read_b64_tr_b16 v[68:69], v5 offset:2048
  ds_read_b64_tr_b16 v[70:71], v5 offset:2304
  ds_read_b64_tr_b16 v[72:73], v5 offset:4096
  ds_read_b64_tr_b16 v[74:75], v5 offset:4352
  ds_read_b64_tr_b16 v[76:77], v5 offset:6144
  ds_read_b64_tr_b16 v[78:79], v5 offset:6400
  ds_read_b64_tr_b16 v[80:81], v5 offset:8192
  ds_read_b64_tr_b16 v[82:83], v5 offset:8448
  ds_read_b64_tr_b16 v[84:85], v5 offset:10240
  ds_read_b64_tr_b16 v[86:87], v5 offset:10496
  buffer_store_dwordx4 v[20:23], v1, s[28:31], s57 offen offset:1024 sc1
  ds_read_b64_tr_b16 v[88:89], v5 offset:12288
  ds_read_b64_tr_b16 v[90:91], v5 offset:12544
  s_waitcnt lgkmcnt(10)
  v_mfma_f32_32x32x16_bf16 v[96:111], v[64:67], v[128:131], 0
  ds_read_b64_tr_b16 v[92:93], v5 offset:14336
  ds_read_b64_tr_b16 v[94:95], v5 offset:14592
  v_mfma_f32_32x32x16_bf16 v[96:111], v[68:71], v[132:135], v[96:111]
  s_waitcnt lgkmcnt(8)
  ds_read_b64_tr_b16 v[64:65], v5 offset:16384
  ds_read_b64_tr_b16 v[66:67], v5 offset:16640
  v_mul_f32 v124, v32, v32
  v_mfma_f32_32x32x16_bf16 v[96:111], v[72:75], v[136:139], v[96:111]
  ds_read_b64_tr_b16 v[68:69], v5 offset:18432
  ds_read_b64_tr_b16 v[70:71], v5 offset:18688
  v_mul_f32 v125, v33, v33
  v_mul_f32 v126, v34, v34
  v_mul_f32 v127, v35, v35
  v_mfma_f32_32x32x16_bf16 v[96:111], v[76:79], v[140:143], v[96:111]
  s_waitcnt lgkmcnt(8)
  ds_read_b64_tr_b16 v[72:73], v5 offset:20480
  ds_read_b64_tr_b16 v[74:75], v5 offset:20736
  v_fma_f32 v124, v124, v118, v116
  v_fma_f32 v125, v125, v118, v116
  v_mfma_f32_32x32x16_bf16 v[96:111], v[80:83], v[144:147], v[96:111]
  ds_read_b64_tr_b16 v[76:77], v5 offset:22528
  ds_read_b64_tr_b16 v[78:79], v5 offset:22784
  v_fma_f32 v126, v126, v118, v116
  v_fma_f32 v127, v127, v118, v116
  v_mul_f32 v124, v124, v32
  v_mfma_f32_32x32x16_bf16 v[96:111], v[84:87], v[148:151], v[96:111]
  s_waitcnt vmcnt(3)
  ds_read_b64_tr_b16 v[16:17], v13 offset:32768
  ds_read_b64_tr_b16 v[18:19], v13 offset:33024
  v_mul_f32 v125, v125, v33
  v_mul_f32 v126, v126, v34
  v_mul_f32 v127, v127, v35
  s_barrier
  ds_read_b64_tr_b16 v[80:81], v5 offset:24576
  ds_read_b64_tr_b16 v[82:83], v5 offset:24832
  s_waitcnt lgkmcnt(12)
  v_mfma_f32_32x32x16_bf16 v[96:111], v[88:91], v[152:155], v[96:111]
  ds_read_b64_tr_b16 v[20:21], v13 offset:33280
  ds_read_b64_tr_b16 v[22:23], v13 offset:33536
  ds_read_b64_tr_b16 v[84:85], v5 offset:26624
  ds_read_b64_tr_b16 v[86:87], v5 offset:26880
  v_exp_f32 v124, v124
  v_exp_f32 v125, v125
  v_exp_f32 v126, v126
  v_exp_f32 v127, v127
  v_fma_f32 v124, v124, v120, v120
  v_mfma_f32_32x32x16_bf16 v[96:111], v[92:95], v[156:159], v[96:111]
  s_waitcnt lgkmcnt(11)
  ds_read_b64_tr_b16 v[24:25], v13 offset:34816
  ds_read_b64_tr_b16 v[26:27], v13 offset:35072
  ds_read_b64_tr_b16 v[88:89], v5 offset:28672
  ds_read_b64_tr_b16 v[90:91], v5 offset:28928
  v_fma_f32 v125, v125, v120, v120
  v_fma_f32 v126, v126, v120, v120
  v_fma_f32 v127, v127, v120, v120
  v_rcp_f32 v124, v124
  v_mfma_f32_32x32x16_bf16 v[96:111], v[64:67], v[160:163], v[96:111]
  ds_read_b64_tr_b16 v[28:29], v13 offset:35328
  ds_read_b64_tr_b16 v[30:31], v13 offset:35584
  s_mul_i32 s61, s6, 98304
  s_lshl_b32 s62, s5, 6
  s_add_u32 s61, s61, s62
  s_lshl_b32 s62, s6, 11
  s_add_u32 s61, s61, 1024
  s_xor_b32 s60, s0, 0
  s_mul_i32 s60, s60, 393216
  s_add_u32 m0, s62, 0
  s_add_u32 s60, s60, s61
  buffer_load_dwordx4 v10, s[12:15], s60 offen offset:0 lds
  v_rcp_f32 v125, v125
  v_rcp_f32 v126, v126
  v_rcp_f32 v127, v127
  v_mul_f32 v32, v32, v124
  v_mul_f32 v33, v33, v125
  v_mul_f32 v34, v34, v126
  v_mul_f32 v35, v35, v127
  v_cvt_pk_bf16_f32 v32, v32, v33
  v_cvt_pk_bf16_f32 v33, v34, v35
  v_mul_f32 v124, v36, v36
  s_waitcnt lgkmcnt(12)
  v_mfma_f32_16x16x32_bf16 v[52:55], v[60:63], v[16:19], v[52:55]
  ds_read_b64_tr_b16 v[92:93], v5 offset:30720
  ds_read_b64_tr_b16 v[94:95], v5 offset:30976
  v_mfma_f32_32x32x16_bf16 v[96:111], v[68:71], v[164:167], v[96:111]
  s_waitcnt lgkmcnt(10)
  ds_read_b64_tr_b16 v[16:17], v13 offset:36864
  ds_read_b64_tr_b16 v[18:19], v13 offset:37120
  v_mul_f32 v125, v37, v37
  v_mul_f32 v126, v38, v38
  v_mul_f32 v127, v39, v39
  v_fma_f32 v124, v124, v118, v116
  v_fma_f32 v125, v125, v118, v116
  v_mfma_f32_16x16x32_bf16 v[56:59], v[60:63], v[20:23], v[56:59]
  ds_read_b64_tr_b16 v[64:65], v5 offset:32768
  ds_read_b64_tr_b16 v[66:67], v5 offset:33024
  v_mfma_f32_32x32x16_bf16 v[96:111], v[72:75], v[168:171], v[96:111]
  s_waitcnt lgkmcnt(10)
  ds_read_b64_tr_b16 v[20:21], v13 offset:37376
  ds_read_b64_tr_b16 v[22:23], v13 offset:37632
  v_fma_f32 v126, v126, v118, v116
  v_fma_f32 v127, v127, v118, v116
  v_mul_f32 v124, v124, v36
  v_mul_f32 v125, v125, v37
  v_mul_f32 v126, v126, v38
  v_mfma_f32_16x16x32_bf16 v[52:55], v[60:63], v[24:27], v[52:55]
  ds_read_b64_tr_b16 v[68:69], v5 offset:34816
  ds_read_b64_tr_b16 v[70:71], v5 offset:35072
  v_mfma_f32_32x32x16_bf16 v[96:111], v[76:79], v[172:175], v[96:111]
  s_waitcnt lgkmcnt(10)
  ds_read_b64_tr_b16 v[24:25], v13 offset:38912
  ds_read_b64_tr_b16 v[26:27], v13 offset:39168
  s_add_u32 s60, s60, 48128
  buffer_load_dwordx4 v10, s[12:15], s60 offen offset:1024 lds
  v_mul_f32 v127, v127, v39
  v_exp_f32 v124, v124
  v_exp_f32 v125, v125
  v_exp_f32 v126, v126
  v_exp_f32 v127, v127
  v_fma_f32 v124, v124, v120, v120
  v_mfma_f32_16x16x32_bf16 v[56:59], v[60:63], v[28:31], v[56:59]
  ds_read_b64_tr_b16 v[72:73], v5 offset:36864
  ds_read_b64_tr_b16 v[74:75], v5 offset:37120
  v_mfma_f32_32x32x16_bf16 v[96:111], v[80:83], v[176:179], v[96:111]
  s_waitcnt lgkmcnt(10)
  ds_read_b64_tr_b16 v[28:29], v13 offset:39424
  ds_read_b64_tr_b16 v[30:31], v13 offset:39680
  v_fma_f32 v125, v125, v120, v120
  v_fma_f32 v126, v126, v120, v120
  v_fma_f32 v127, v127, v120, v120
  v_rcp_f32 v124, v124
  v_rcp_f32 v125, v125
  v_mfma_f32_16x16x32_bf16 v[52:55], v[60:63], v[16:19], v[52:55]
  ds_read_b64_tr_b16 v[76:77], v5 offset:38912
  ds_read_b64_tr_b16 v[78:79], v5 offset:39168
  v_mfma_f32_32x32x16_bf16 v[96:111], v[84:87], v[180:183], v[96:111]
  s_waitcnt lgkmcnt(10)
  v_rcp_f32 v126, v126
  v_rcp_f32 v127, v127
  v_mul_f32 v36, v36, v124
  v_mul_f32 v37, v37, v125
  v_mfma_f32_16x16x32_bf16 v[56:59], v[60:63], v[20:23], v[56:59]
  ds_read_b64_tr_b16 v[80:81], v5 offset:40960
  ds_read_b64_tr_b16 v[82:83], v5 offset:41216
  v_mfma_f32_32x32x16_bf16 v[96:111], v[88:91], v[184:187], v[96:111]
  s_waitcnt vmcnt(4)
  v_and_b32 v14, 0x1c0, v1
  v_or_b32 v14, 16711680, v14
  s_cmp_eq_u32 s51, 0
  s_waitcnt vmcnt(2)
  buffer_store_byte_d16_hi v14, v14, s[28:31], s10 offen offset:1024
  v_mov_b32 v14, 4
  s_cbranch_scc1 L56
  buffer_store_dword v14, off, s[28:31], s52
L57:
  s_xor_b32 s60, s0, 0
  s_mul_i32 s60, s60, 393216
  s_add_u32 m0, s62, 31744
  s_add_u32 s60, s60, s61
  buffer_load_dwordx4 v10, s[12:15], s60 offen offset:1024 lds
  v_mul_f32 v38, v38, v126
  v_mul_f32 v39, v39, v127
  v_cvt_pk_bf16_f32 v34, v36, v37
  v_cvt_pk_bf16_f32 v35, v38, v39
  v_mul_f32 v124, v40, v40
  v_mul_f32 v125, v41, v41
  v_mul_f32 v126, v42, v42
  v_mul_f32 v127, v43, v43
  v_fma_f32 v124, v124, v118, v116
  s_waitcnt lgkmcnt(8)
  v_mfma_f32_16x16x32_bf16 v[52:55], v[60:63], v[24:27], v[52:55]
  buffer_store_dwordx4 v[32:35], v1, s[28:31], s57 offen offset:2048 sc1
  ds_read_b64_tr_b16 v[84:85], v5 offset:43008
  ds_read_b64_tr_b16 v[86:87], v5 offset:43264
  v_mfma_f32_32x32x16_bf16 v[96:111], v[92:95], v[188:191], v[96:111]
  s_waitcnt lgkmcnt(6)
  v_fma_f32 v125, v125, v118, v116
  v_fma_f32 v126, v126, v118, v116
  v_fma_f32 v127, v127, v118, v116
  v_mul_f32 v124, v124, v40
  v_mfma_f32_16x16x32_bf16 v[56:59], v[60:63], v[28:31], v[56:59]
  ds_read_b64_tr_b16 v[88:89], v5 offset:45056
  ds_read_b64_tr_b16 v[90:91], v5 offset:45312
  v_mfma_f32_32x32x16_bf16 v[96:111], v[64:67], v[192:195], v[96:111]
  s_lshr_b32 s96, s6, 1
  v_mul_f32 v125, v125, v41
  v_mul_f32 v126, v126, v42
  v_mul_f32 v127, v127, v43
  v_exp_f32 v124, v124
  v_mfma_f32_32x32x16_bf16 v[96:111], v[68:71], v[196:199], v[96:111]
  s_waitcnt lgkmcnt(6)
  ds_read_b64_tr_b16 v[92:93], v5 offset:47104
  ds_read_b64_tr_b16 v[94:95], v5 offset:47360
  v_cvt_pk_bf16_f32 v54, v52, v52
  v_lshlrev_b32 v53, 16, v54
  v_sub_f32 v53, v52, v53
  s_mul_i32 s96, s96, 57344
  s_add_u32 s60, s60, 48128
  buffer_load_dwordx4 v10, s[12:15], s60 offen offset:2048 lds
  ds_read_b64_tr_b16 v[64:65], v5 offset:49152
  ds_read_b64_tr_b16 v[66:67], v5 offset:49408
  v_exp_f32 v125, v125
  v_exp_f32 v126, v126
  v_exp_f32 v127, v127
  v_fma_f32 v124, v124, v120, v120
  v_fma_f32 v125, v125, v120, v120
  v_mfma_f32_32x32x16_bf16 v[96:111], v[72:75], v[200:203], v[96:111]
  v_and_b32 v55, 0xffff, v54
  v_cvt_pk_bf16_f32 v54, v52, v53
  v_lshl_or_b32 v55, v50, 16, v55
  s_and_b32 s97, s6, 1
  v_fma_f32 v126, v126, v120, v120
  v_fma_f32 v127, v127, v120, v120
  v_rcp_f32 v124, v124
  v_rcp_f32 v125, v125
  v_rcp_f32 v126, v126
  v_mfma_f32_32x32x16_bf16 v[96:111], v[76:79], v[204:207], v[96:111]
  s_waitcnt lgkmcnt(8)
  ds_read_b64_tr_b16 v[68:69], v5 offset:51200
  ds_read_b64_tr_b16 v[70:71], v5 offset:51456
  ds_write_b64 v123, v[54:55] offset:5120
  v_cvt_pk_bf16_f32 v58, v56, v56
  v_lshlrev_b32 v57, 16, v58
  s_lshl_b32 s97, s97, 10
  v_rcp_f32 v127, v127
  v_mul_f32 v40, v40, v124
  v_mul_f32 v41, v41, v125
  v_mul_f32 v42, v42, v126
  v_mul_f32 v43, v43, v127
  v_mfma_f32_32x32x16_bf16 v[96:111], v[80:83], v[208:211], v[96:111]
  s_waitcnt lgkmcnt(9)
  ds_read_b64_tr_b16 v[72:73], v5 offset:53248
  ds_read_b64_tr_b16 v[74:75], v5 offset:53504
  v_sub_f32 v57, v56, v57
  v_and_b32 v59, 0xffff, v58
  v_cvt_pk_bf16_f32 v58, v56, v57
  s_add_u32 s96, s96, s97
  s_xor_b32 s60, s0, 1
  s_mul_i32 s60, s60, 393216
  s_add_u32 m0, s62, 8192
  s_add_u32 s60, s60, s61
  buffer_load_dwordx4 v10, s[12:15], s60 offen offset:0 lds
  ds_read_b64_tr_b16 v[76:77], v5 offset:55296
  ds_read_b64_tr_b16 v[78:79], v5 offset:55552
  v_cvt_pk_bf16_f32 v36, v40, v41
  v_cvt_pk_bf16_f32 v37, v42, v43
  v_mul_f32 v124, v44, v44
  v_mul_f32 v125, v45, v45
  v_mul_f32 v126, v46, v46
  v_mul_f32 v127, v47, v47
  v_fma_f32 v124, v124, v118, v116
  v_mfma_f32_32x32x16_bf16 v[96:111], v[84:87], v[212:215], v[96:111]
  s_waitcnt lgkmcnt(11)
  v_lshl_or_b32 v59, v51, 16, v59
  v_fma_f32 v125, v125, v118, v116
  v_fma_f32 v126, v126, v118, v116
  v_fma_f32 v127, v127, v118, v116
  v_mul_f32 v124, v124, v44
  v_mfma_f32_32x32x16_bf16 v[96:111], v[88:91], v[216:219], v[96:111]
  s_waitcnt lgkmcnt(9)
  ds_write_b64 v123, v[58:59] offset:6144
  s_add_u32 s96, s96, 12582912
  ds_read_b64_tr_b16 v[80:81], v5 offset:57344
  ds_read_b64_tr_b16 v[82:83], v5 offset:57600
  s_lshl_b32 s59, s49, 17
  v_mul_f32 v125, v125, v45
  v_mul_f32 v126, v126, v46
  v_mul_f32 v127, v127, v47
  v_mfma_f32_32x32x16_bf16 v[96:111], v[92:95], v[220:223], v[96:111]
  s_waitcnt lgkmcnt(8)
  ds_read_b64_tr_b16 v[84:85], v5 offset:59392
  ds_read_b64_tr_b16 v[86:87], v5 offset:59648
  s_xor_b32 s63, s59, 0x20000
  s_add_u32 s60, s60, 48128
  buffer_load_dwordx4 v10, s[12:15], s60 offen offset:1024 lds
  ds_read_b64_tr_b16 v[88:89], v5 offset:61440
  ds_read_b64_tr_b16 v[90:91], v5 offset:61696
  v_exp_f32 v124, v124
  v_exp_f32 v125, v125
  v_exp_f32 v126, v126
  v_exp_f32 v127, v127
  v_mfma_f32_32x32x16_bf16 v[96:111], v[64:67], v[224:227], v[96:111]
  s_add_u32 s59, s59, s96
  v_fma_f32 v124, v124, v120, v120
  v_fma_f32 v125, v125, v120, v120
  v_fma_f32 v126, v126, v120, v120
  v_mfma_f32_32x32x16_bf16 v[96:111], v[68:71], v[228:231], v[96:111]
  s_waitcnt lgkmcnt(6)
  ds_read_b64_tr_b16 v[92:93], v5 offset:63488
  ds_read_b64_tr_b16 v[94:95], v5 offset:63744
  s_barrier
  s_add_u32 s63, s63, s96
  v_fma_f32 v127, v127, v120, v120
  v_rcp_f32 v124, v124
  v_rcp_f32 v125, v125
  v_rcp_f32 v126, v126
  v_mfma_f32_32x32x16_bf16 v[96:111], v[72:75], v[232:235], v[96:111]
  ds_read_b128 v[64:67], v15 offset:2048
  s_xor_b32 s60, s0, 1
  s_mul_i32 s60, s60, 393216
  s_add_u32 m0, s62, 39936
  s_add_u32 s60, s60, s61
  buffer_load_dwordx4 v10, s[12:15], s60 offen offset:1024 lds
  ds_read_b64_tr_b16 v[68:69], v5 offset:512
  ds_read_b64_tr_b16 v[70:71], v5 offset:768
  v_rcp_f32 v127, v127
  v_mul_f32 v44, v44, v124
  v_mul_f32 v45, v45, v125
  v_mul_f32 v46, v46, v126
  v_mul_f32 v47, v47, v127
  v_mfma_f32_32x32x16_bf16 v[96:111], v[76:79], v[236:239], v[96:111]
  s_waitcnt lgkmcnt(7)
  ds_read_b64_tr_b16 v[72:73], v5 offset:2560
  ds_read_b64_tr_b16 v[74:75], v5 offset:2816
  v_cvt_pk_bf16_f32 v38, v44, v45
  v_cvt_pk_bf16_f32 v39, v46, v47
  v_mfma_f32_32x32x16_bf16 v[96:111], v[80:83], v[240:243], v[96:111]
  buffer_store_dwordx4 v[36:39], v1, s[28:31], s57 offen offset:3072 sc1
  ds_read_b64_tr_b16 v[76:77], v5 offset:4608
  ds_read_b64_tr_b16 v[78:79], v5 offset:4864
  v_mfma_f32_32x32x16_bf16 v[96:111], v[84:87], v[244:247], v[96:111]
  s_add_u32 s60, s60, 48128
  buffer_load_dwordx4 v10, s[12:15], s60 offen offset:2048 lds
  ds_read_b64_tr_b16 v[80:81], v5 offset:6656
  ds_read_b64_tr_b16 v[82:83], v5 offset:6912
  s_waitcnt lgkmcnt(9)
  v_mfma_f32_32x32x16_bf16 v[96:111], v[88:91], v[248:251], v[96:111]
  ds_read_b64_tr_b16 v[84:85], v5 offset:8704
  ds_read_b64_tr_b16 v[86:87], v5 offset:8960
  v_mfma_f32_32x32x16_bf16 v[96:111], v[92:95], v[252:255], v[96:111]
  s_waitcnt lgkmcnt(10)
  ds_read_b64_tr_b16 v[88:89], v5 offset:10752
  ds_read_b64_tr_b16 v[90:91], v5 offset:11008
  v_mfma_f32_32x32x16_bf16 v[96:111], v[64:67], v[112:115], v[96:111]
  s_xor_b32 s60, s0, 2
  s_mul_i32 s60, s60, 393216
  s_add_u32 m0, s62, 16384
  s_add_u32 s60, s60, s61
  buffer_load_dwordx4 v10, s[12:15], s60 offen offset:0 lds
  ds_read_b64_tr_b16 v[92:93], v5 offset:12800
  ds_read_b64_tr_b16 v[94:95], v5 offset:13056
  s_waitcnt lgkmcnt(10)
  v_mfma_f32_32x32x16_bf16 v[16:31], v[68:71], v[128:131], 0
  s_buffer_load_dwordx4 s[44:47], s[28:31], s37 offset:1024
  s_nop 1
  v_mul_f32 v124, v96, v96
  v_mfma_f32_32x32x16_bf16 v[16:31], v[72:75], v[132:135], v[16:31]
  s_waitcnt lgkmcnt(6)
  ds_read_b64_tr_b16 v[64:65], v5 offset:14848
  ds_read_b64_tr_b16 v[66:67], v5 offset:15104
  ds_read_b64_tr_b16 v[68:69], v5 offset:16896
  ds_read_b64_tr_b16 v[70:71], v5 offset:17152
  v_mul_f32 v125, v97, v97
  v_mul_f32 v126, v98, v98
  v_mfma_f32_32x32x16_bf16 v[16:31], v[76:79], v[136:139], v[16:31]
  s_add_u32 s60, s60, 48128
  buffer_load_dwordx4 v10, s[12:15], s60 offen offset:1024 lds
  ds_read_b64_tr_b16 v[72:73], v5 offset:18944
  ds_read_b64_tr_b16 v[74:75], v5 offset:19200
  v_mul_f32 v127, v99, v99
  v_fma_f32 v124, v124, v118, v116
  v_fma_f32 v125, v125, v118, v116
  v_fma_f32 v126, v126, v118, v116
  v_fma_f32 v127, v127, v118, v116
  v_mfma_f32_32x32x16_bf16 v[16:31], v[80:83], v[140:143], v[16:31]
  s_waitcnt lgkmcnt(8)
  ds_read_b64_tr_b16 v[76:77], v5 offset:20992
  ds_read_b64_tr_b16 v[78:79], v5 offset:21248
  v_mul_f32 v124, v124, v96
  v_mul_f32 v125, v125, v97
  v_mul_f32 v126, v126, v98
  v_mfma_f32_32x32x16_bf16 v[16:31], v[84:87], v[144:147], v[16:31]
  ds_read_b64_tr_b16 v[80:81], v5 offset:23040
  ds_read_b64_tr_b16 v[82:83], v5 offset:23296
  v_mul_f32 v127, v127, v99
  v_exp_f32 v124, v124
  v_exp_f32 v125, v125
  v_exp_f32 v126, v126
  v_mfma_f32_32x32x16_bf16 v[16:31], v[88:91], v[148:151], v[16:31]
  s_xor_b32 s60, s0, 2
  s_mul_i32 s60, s60, 393216
  s_add_u32 m0, s62, 48128
  s_add_u32 s60, s60, s61
  buffer_load_dwordx4 v10, s[12:15], s60 offen offset:1024 lds
  ds_read_b64_tr_b16 v[84:85], v5 offset:25088
  ds_read_b64_tr_b16 v[86:87], v5 offset:25344
  s_waitcnt lgkmcnt(10)
  v_exp_f32 v127, v127
  v_fma_f32 v124, v124, v120, v120
  v_fma_f32 v125, v125, v120, v120
  v_fma_f32 v126, v126, v120, v120
  v_fma_f32 v127, v127, v120, v120
  v_rcp_f32 v124, v124
  v_mfma_f32_32x32x16_bf16 v[16:31], v[92:95], v[152:155], v[16:31]
  ds_read_b64_tr_b16 v[88:89], v5 offset:27136
  ds_read_b64_tr_b16 v[90:91], v5 offset:27392
  v_rcp_f32 v125, v125
  v_rcp_f32 v126, v126
  v_rcp_f32 v127, v127
  v_mfma_f32_32x32x16_bf16 v[16:31], v[64:67], v[156:159], v[16:31]
  s_waitcnt lgkmcnt(8)
  ds_read_b64_tr_b16 v[92:93], v5 offset:29184
  ds_read_b64_tr_b16 v[94:95], v5 offset:29440
  v_mul_f32 v96, v96, v124
  v_mul_f32 v97, v97, v125
  v_mul_f32 v98, v98, v126
  v_mfma_f32_32x32x16_bf16 v[16:31], v[68:71], v[160:163], v[16:31]
  s_waitcnt lgkmcnt(0)
  s_or_b32 s47, s47, 0xffff0000
  s_nand_b64 s[44:45], s[44:45], s[46:47]
  s_cbranch_scc1 L58
L59:
  s_add_u32 s60, s60, 48128
  buffer_load_dwordx4 v10, s[12:15], s60 offen offset:2048 lds
  ds_read_b64_tr_b16 v[64:65], v5 offset:31232
  ds_read_b64_tr_b16 v[66:67], v5 offset:31488
  v_mul_f32 v99, v99, v127
  v_cvt_pk_bf16_f32 v96, v96, v97
  v_cvt_pk_bf16_f32 v97, v98, v99
  v_mul_f32 v124, v100, v100
  v_mul_f32 v125, v101, v101
  v_mul_f32 v126, v102, v102
  v_mul_f32 v127, v103, v103
  v_mfma_f32_32x32x16_bf16 v[16:31], v[72:75], v[164:167], v[16:31]
  s_add_u32 s96, s59, 0
  buffer_load_dwordx4 v[128:131], v1, s[28:31], s96 offen sc1
  ds_read_b64_tr_b16 v[68:69], v5 offset:33280
  ds_read_b64_tr_b16 v[70:71], v5 offset:33536
  v_fma_f32 v124, v124, v118, v116
  v_fma_f32 v125, v125, v118, v116
  v_fma_f32 v126, v126, v118, v116
  v_fma_f32 v127, v127, v118, v116
  v_mul_f32 v124, v124, v100
  v_mfma_f32_32x32x16_bf16 v[16:31], v[76:79], v[168:171], v[16:31]
  s_add_u32 s96, s63, 0
  buffer_load_dwordx4 v[132:135], v1, s[28:31], s96 offen sc1
  ds_read_b64_tr_b16 v[72:73], v5 offset:35328
  ds_read_b64_tr_b16 v[74:75], v5 offset:35584
  v_mul_f32 v125, v125, v101
  v_mul_f32 v126, v126, v102
  v_mul_f32 v127, v127, v103
  v_exp_f32 v124, v124
  v_exp_f32 v125, v125
  v_mfma_f32_32x32x16_bf16 v[16:31], v[80:83], v[172:175], v[16:31]
  s_add_u32 s96, s59, 8192
  buffer_load_dwordx4 v[136:139], v1, s[28:31], s96 offen sc1
  s_xor_b32 s60, s0, 3
  s_mul_i32 s60, s60, 393216
  s_add_u32 m0, s62, 24576
  s_add_u32 s60, s60, s61
  buffer_load_dwordx4 v10, s[12:15], s60 offen offset:0 lds
  ds_read_b64_tr_b16 v[76:77], v5 offset:37376
  ds_read_b64_tr_b16 v[78:79], v5 offset:37632
  v_exp_f32 v126, v126
  v_exp_f32 v127, v127
  v_fma_f32 v124, v124, v120, v120
  v_fma_f32 v125, v125, v120, v120
  v_fma_f32 v126, v126, v120, v120
  v_fma_f32 v127, v127, v120, v120
  v_rcp_f32 v124, v124
  v_mfma_f32_32x32x16_bf16 v[16:31], v[84:87], v[176:179], v[16:31]
  s_add_u32 s96, s63, 8192
  buffer_load_dwordx4 v[140:143], v1, s[28:31], s96 offen sc1
  ds_read_b64_tr_b16 v[80:81], v5 offset:39424
  ds_read_b64_tr_b16 v[82:83], v5 offset:39680
  v_rcp_f32 v125, v125
  v_rcp_f32 v126, v126
  v_rcp_f32 v127, v127
  v_mul_f32 v100, v100, v124
  v_mul_f32 v101, v101, v125
  v_mfma_f32_32x32x16_bf16 v[16:31], v[88:91], v[180:183], v[16:31]
  s_add_u32 s96, s59, 16384
  buffer_load_dwordx4 v[144:147], v1, s[28:31], s96 offen sc1
  ds_read_b64_tr_b16 v[84:85], v5 offset:41472
  ds_read_b64_tr_b16 v[86:87], v5 offset:41728
  s_waitcnt lgkmcnt(10)
  v_mul_f32 v102, v102, v126
  v_mul_f32 v103, v103, v127
  v_cvt_pk_bf16_f32 v98, v100, v101
  v_cvt_pk_bf16_f32 v99, v102, v103
  v_mfma_f32_32x32x16_bf16 v[16:31], v[92:95], v[184:187], v[16:31]
  s_add_u32 s96, s63, 16384
  buffer_load_dwordx4 v[148:151], v1, s[28:31], s96 offen sc1
  v_and_b32 v14, 0x1c0, v1
  v_or_b32 v14, 16711680, v14
  s_cmp_eq_u32 s51, 0
  s_waitcnt vmcnt(12)
  buffer_store_byte_d16_hi v14, v14, s[28:31], s10 offen offset:1536
  v_mov_b32 v14, 5
  s_cbranch_scc1 L63
  buffer_store_dword v14, off, s[28:31], s52
L64:
  s_add_u32 s60, s60, 48128
  buffer_load_dwordx4 v10, s[12:15], s60 offen offset:1024 lds
  buffer_store_dwordx4 v[96:99], v1, s[28:31], s58 offen offset:0 sc1
  ds_read_b64_tr_b16 v[88:89], v5 offset:43520
  ds_read_b64_tr_b16 v[90:91], v5 offset:43776
  v_mul_f32 v124, v104, v104
  v_mul_f32 v125, v105, v105
  v_mul_f32 v126, v106, v106
  v_mul_f32 v127, v107, v107
  v_fma_f32 v124, v124, v118, v116
  v_fma_f32 v125, v125, v118, v116
  v_fma_f32 v126, v126, v118, v116
  v_fma_f32 v127, v127, v118, v116
  v_mul_f32 v124, v124, v104
  v_mul_f32 v125, v125, v105
  v_mul_f32 v126, v126, v106
  v_mfma_f32_32x32x16_bf16 v[16:31], v[64:67], v[188:191], v[16:31]
  s_add_u32 s96, s59, 24576
  buffer_load_dwordx4 v[152:155], v1, s[28:31], s96 offen sc1
  ds_read_b64_tr_b16 v[92:93], v5 offset:45568
  ds_read_b64_tr_b16 v[94:95], v5 offset:45824
  s_waitcnt lgkmcnt(10)
  v_mul_f32 v127, v127, v107
  v_exp_f32 v124, v124
  v_exp_f32 v125, v125
  v_exp_f32 v126, v126
  v_exp_f32 v127, v127
  v_mfma_f32_32x32x16_bf16 v[16:31], v[68:71], v[192:195], v[16:31]
  ds_read_b64_tr_b16 v[64:65], v5 offset:47616
  ds_read_b64_tr_b16 v[66:67], v5 offset:47872
  v_fma_f32 v124, v124, v120, v120
  v_fma_f32 v125, v125, v120, v120
  v_fma_f32 v126, v126, v120, v120
  v_mfma_f32_32x32x16_bf16 v[16:31], v[72:75], v[196:199], v[16:31]
  s_add_u32 s96, s63, 24576
  buffer_load_dwordx4 v[156:159], v1, s[28:31], s96 offen sc1
  s_xor_b32 s60, s0, 3
  s_mul_i32 s60, s60, 393216
  s_add_u32 m0, s62, 56320
  s_add_u32 s60, s60, s61
  buffer_load_dwordx4 v10, s[12:15], s60 offen offset:1024 lds
  ds_read_b64_tr_b16 v[68:69], v5 offset:49664
  ds_read_b64_tr_b16 v[70:71], v5 offset:49920
  s_waitcnt lgkmcnt(10)
  v_fma_f32 v127, v127, v120, v120
  v_rcp_f32 v124, v124
  v_rcp_f32 v125, v125
  v_rcp_f32 v126, v126
  v_rcp_f32 v127, v127
  v_mul_f32 v104, v104, v124
  v_mul_f32 v105, v105, v125
  v_mul_f32 v106, v106, v126
  v_mfma_f32_32x32x16_bf16 v[16:31], v[76:79], v[200:203], v[16:31]
  ds_read_b64_tr_b16 v[72:73], v5 offset:51712
  ds_read_b64_tr_b16 v[74:75], v5 offset:51968
  v_mul_f32 v107, v107, v127
  v_cvt_pk_bf16_f32 v100, v104, v105
  v_cvt_pk_bf16_f32 v101, v106, v107
  v_mfma_f32_32x32x16_bf16 v[16:31], v[80:83], v[204:207], v[16:31]
  s_add_u32 s96, s59, 32768
  buffer_load_dwordx4 v[160:163], v1, s[28:31], s96 offen sc1
  ds_read_b64_tr_b16 v[76:77], v5 offset:53760
  ds_read_b64_tr_b16 v[78:79], v5 offset:54016
  s_waitcnt lgkmcnt(10)
  v_mul_f32 v124, v108, v108
  v_mul_f32 v125, v109, v109
  v_mul_f32 v126, v110, v110
  v_mul_f32 v127, v111, v111
  v_fma_f32 v124, v124, v118, v116
  v_mfma_f32_32x32x16_bf16 v[16:31], v[84:87], v[208:211], v[16:31]
  s_add_u32 s60, s60, 48128
  buffer_load_dwordx4 v10, s[12:15], s60 offen offset:2048 lds
  ds_read_b64_tr_b16 v[80:81], v5 offset:55808
  ds_read_b64_tr_b16 v[82:83], v5 offset:56064
  v_fma_f32 v125, v125, v118, v116
  v_fma_f32 v126, v126, v118, v116
  v_fma_f32 v127, v127, v118, v116
  v_mul_f32 v124, v124, v108
  v_mul_f32 v125, v125, v109
  v_mfma_f32_32x32x16_bf16 v[16:31], v[88:91], v[212:215], v[16:31]
  s_add_u32 s96, s63, 32768
  buffer_load_dwordx4 v[164:167], v1, s[28:31], s96 offen sc1
  ds_read_b64_tr_b16 v[84:85], v5 offset:57856
  ds_read_b64_tr_b16 v[86:87], v5 offset:58112
  s_waitcnt lgkmcnt(10)
  v_mul_f32 v126, v126, v110
  v_mul_f32 v127, v127, v111
  v_exp_f32 v124, v124
  v_exp_f32 v125, v125
  v_mfma_f32_32x32x16_bf16 v[16:31], v[92:95], v[216:219], v[16:31]
  ds_read_b64_tr_b16 v[88:89], v5 offset:59904
  ds_read_b64_tr_b16 v[90:91], v5 offset:60160
  v_exp_f32 v126, v126
  v_exp_f32 v127, v127
  v_fma_f32 v124, v124, v120, v120
  v_mfma_f32_32x32x16_bf16 v[16:31], v[64:67], v[220:223], v[16:31]
  s_add_u32 s96, s59, 40960
  buffer_load_dwordx4 v[168:171], v1, s[28:31], s96 offen sc1
  ds_read_b64_tr_b16 v[92:93], v5 offset:61952
  ds_read_b64_tr_b16 v[94:95], v5 offset:62208
  s_waitcnt lgkmcnt(10)
  v_fma_f32 v125, v125, v120, v120
  v_fma_f32 v126, v126, v120, v120
  v_fma_f32 v127, v127, v120, v120
  v_rcp_f32 v124, v124
  v_rcp_f32 v125, v125
  v_mfma_f32_32x32x16_bf16 v[16:31], v[68:71], v[224:227], v[16:31]
  ds_read_b64_tr_b16 v[64:65], v5 offset:64000
  ds_read_b64_tr_b16 v[66:67], v5 offset:64256
  v_rcp_f32 v126, v126
  v_rcp_f32 v127, v127
  v_mul_f32 v108, v108, v124
  v_mfma_f32_32x32x16_bf16 v[16:31], v[72:75], v[228:231], v[16:31]
  s_add_u32 s96, s63, 40960
  buffer_load_dwordx4 v[172:175], v1, s[28:31], s96 offen sc1
  s_buffer_load_dwordx4 s[44:47], s[28:31], s37 offset:1536
  v_mul_f32 v109, v109, v125
  v_mul_f32 v110, v110, v126
  v_mul_f32 v111, v111, v127
  v_cvt_pk_bf16_f32 v102, v108, v109
  v_cvt_pk_bf16_f32 v103, v110, v111
  s_waitcnt lgkmcnt(10)
  v_mfma_f32_32x32x16_bf16 v[16:31], v[76:79], v[232:235], v[16:31]
  s_waitcnt lgkmcnt(8)
  ds_read_b128 v[68:71], v15 offset:3072
  buffer_store_dwordx4 v[100:103], v1, s[28:31], s58 offen offset:1024 sc1
  v_mfma_f32_32x32x16_bf16 v[16:31], v[80:83], v[236:239], v[16:31]
  s_add_u32 s96, s59, 49152
  buffer_load_dwordx4 v[176:179], v1, s[28:31], s96 offen sc1
  s_waitcnt lgkmcnt(5)
  v_mfma_f32_32x32x16_bf16 v[16:31], v[84:87], v[240:243], v[16:31]
  v_mfma_f32_32x32x16_bf16 v[16:31], v[88:91], v[244:247], v[16:31]
  s_add_u32 s96, s63, 49152
  buffer_load_dwordx4 v[180:183], v1, s[28:31], s96 offen sc1
  s_waitcnt lgkmcnt(1)
  v_mfma_f32_32x32x16_bf16 v[16:31], v[92:95], v[248:251], v[16:31]
  v_mfma_f32_32x32x16_bf16 v[16:31], v[64:67], v[252:255], v[16:31]
  s_waitcnt lgkmcnt(0)
  v_mfma_f32_32x32x16_bf16 v[16:31], v[68:71], v[112:115], v[16:31]
L48:
  s_waitcnt vmcnt(21)
  v_mfma_f32_32x32x16_bf16 a[224:239], a[0:3], v[128:131], a[224:239]
  s_waitcnt lgkmcnt(0)
  s_or_b32 s47, s47, 0xffff0000
  s_nand_b64 s[44:45], s[44:45], s[46:47]
  s_cbranch_scc1 L65
L66:
  v_mfma_f32_32x32x16_bf16 v[32:47], a[4:7], v[128:131], 0
  s_add_u32 s96, s59, 2048
  buffer_load_dwordx4 v[184:187], v1, s[28:31], s96 offen sc1
  s_nop 2
  v_mul_f32 v124, v16, v16
  v_mul_f32 v125, v17, v17
  v_mul_f32 v126, v18, v18
  v_mul_f32 v127, v19, v19
  v_fma_f32 v124, v124, v118, v116
  v_fma_f32 v125, v125, v118, v116
  s_waitcnt vmcnt(21)
  v_mfma_f32_32x32x16_bf16 v[48:63], a[0:3], v[132:135], 0
  s_add_u32 s96, s63, 2048
  buffer_load_dwordx4 v[188:191], v1, s[28:31], s96 offen sc1
  v_fma_f32 v126, v126, v118, v116
  v_fma_f32 v127, v127, v118, v116
  v_mul_f32 v124, v124, v16
  v_mul_f32 v125, v125, v17
  v_mfma_f32_32x32x16_bf16 v[240:255], a[4:7], v[132:135], 0
  s_add_u32 s96, s59, 10240
  buffer_load_dwordx4 v[192:195], v1, s[28:31], s96 offen sc1
  v_mul_f32 v126, v126, v18
  v_mul_f32 v127, v127, v19
  v_exp_f32 v124, v124
  s_waitcnt vmcnt(22)
  v_mfma_f32_32x32x16_bf16 a[224:239], a[8:11], v[136:139], a[224:239]
  s_add_u32 s96, s63, 10240
  buffer_load_dwordx4 v[196:199], v1, s[28:31], s96 offen sc1
  v_exp_f32 v125, v125
  v_exp_f32 v126, v126
  v_mfma_f32_32x32x16_bf16 v[32:47], a[12:15], v[136:139], v[32:47]
  s_add_u32 s96, s59, 18432
  buffer_load_dwordx4 v[200:203], v1, s[28:31], s96 offen sc1
  v_exp_f32 v127, v127
  v_fma_f32 v124, v124, v120, v120
  v_fma_f32 v125, v125, v120, v120
  s_waitcnt vmcnt(22)
  v_mfma_f32_32x32x16_bf16 v[48:63], a[8:11], v[140:143], v[48:63]
  s_add_u32 s96, s63, 18432
  buffer_load_dwordx4 v[204:207], v1, s[28:31], s96 offen sc1
  v_fma_f32 v126, v126, v120, v120
  v_fma_f32 v127, v127, v120, v120
  v_rcp_f32 v124, v124
  v_mfma_f32_32x32x16_bf16 v[240:255], a[12:15], v[140:143], v[240:255]
  s_add_u32 s96, s59, 26624
  buffer_load_dwordx4 v[208:211], v1, s[28:31], s96 offen sc1
  v_rcp_f32 v125, v125
  v_rcp_f32 v126, v126
  s_waitcnt vmcnt(23)
  v_mfma_f32_32x32x16_bf16 a[224:239], a[16:19], v[144:147], a[224:239]
  v_rcp_f32 v127, v127
  v_mul_f32 v16, v16, v124
  v_mul_f32 v17, v17, v125
  v_mul_f32 v18, v18, v126
  v_mul_f32 v19, v19, v127
  v_mfma_f32_32x32x16_bf16 v[32:47], a[20:23], v[144:147], v[32:47]
  s_add_u32 s96, s63, 26624
  buffer_load_dwordx4 v[212:215], v1, s[28:31], s96 offen sc1
  v_cvt_pk_bf16_f32 v16, v16, v17
  v_cvt_pk_bf16_f32 v17, v18, v19
  v_mul_f32 v124, v20, v20
  v_mul_f32 v125, v21, v21
  s_waitcnt vmcnt(23)
  v_mfma_f32_32x32x16_bf16 v[48:63], a[16:19], v[148:151], v[48:63]
  v_mul_f32 v126, v22, v22
  v_mul_f32 v127, v23, v23
  v_fma_f32 v124, v124, v118, v116
  v_fma_f32 v125, v125, v118, v116
  v_fma_f32 v126, v126, v118, v116
  v_fma_f32 v127, v127, v118, v116
  v_mfma_f32_32x32x16_bf16 v[240:255], a[20:23], v[148:151], v[240:255]
  s_add_u32 s96, s59, 34816
  buffer_load_dwordx4 v[216:219], v1, s[28:31], s96 offen sc1
  v_mul_f32 v124, v124, v20
  v_mul_f32 v125, v125, v21
  v_mul_f32 v126, v126, v22
  v_mul_f32 v127, v127, v23
  s_waitcnt vmcnt(19)
  v_mfma_f32_32x32x16_bf16 a[224:239], a[24:27], v[152:155], a[224:239]
  v_and_b32 v14, 0x1c0, v1
  v_or_b32 v14, 16711680, v14
  s_cmp_eq_u32 s51, 0
  s_waitcnt vmcnt(11)
  buffer_store_byte_d16_hi v14, v14, s[28:31], s10 offen offset:2048
  v_mov_b32 v14, 6
  s_cbranch_scc1 L70
  buffer_store_dword v14, off, s[28:31], s52
L71:
  v_mfma_f32_32x32x16_bf16 v[32:47], a[28:31], v[152:155], v[32:47]
  s_add_u32 s96, s63, 34816
  buffer_load_dwordx4 v[220:223], v1, s[28:31], s96 offen sc1
  v_exp_f32 v124, v124
  s_waitcnt vmcnt(34)
  v_mfma_f32_32x32x16_bf16 v[48:63], a[24:27], v[156:159], v[48:63]
  v_exp_f32 v125, v125
  v_exp_f32 v126, v126
  v_exp_f32 v127, v127
  v_mfma_f32_32x32x16_bf16 v[240:255], a[28:31], v[156:159], v[240:255]
  s_add_u32 s96, s59, 43008
  buffer_load_dwordx4 v[224:227], v1, s[28:31], s96 offen sc1
  v_fma_f32 v124, v124, v120, v120
  v_fma_f32 v125, v125, v120, v120
  v_fma_f32 v126, v126, v120, v120
  v_fma_f32 v127, v127, v120, v120
  s_waitcnt vmcnt(34)
  v_mfma_f32_32x32x16_bf16 a[224:239], a[32:35], v[160:163], a[224:239]
  v_rcp_f32 v124, v124
  v_rcp_f32 v125, v125
  v_rcp_f32 v126, v126
  v_mfma_f32_32x32x16_bf16 v[32:47], a[36:39], v[160:163], v[32:47]
  s_add_u32 s96, s63, 43008
  buffer_load_dwordx4 v[228:231], v1, s[28:31], s96 offen sc1
  v_rcp_f32 v127, v127
  v_mul_f32 v20, v20, v124
  v_mul_f32 v21, v21, v125
  s_waitcnt vmcnt(34)
  v_mfma_f32_32x32x16_bf16 v[48:63], a[32:35], v[164:167], v[48:63]
  v_mul_f32 v22, v22, v126
  v_mul_f32 v23, v23, v127
  v_cvt_pk_bf16_f32 v18, v20, v21
  v_cvt_pk_bf16_f32 v19, v22, v23
  v_mul_f32 v124, v24, v24
  v_mfma_f32_32x32x16_bf16 v[240:255], a[36:39], v[164:167], v[240:255]
  buffer_store_dwordx4 v[16:19], v1, s[28:31], s58 offen offset:2048 sc1
  s_add_u32 s96, s59, 51200
  buffer_load_dwordx4 v[232:235], v1, s[28:31], s96 offen sc1
  v_mul_f32 v125, v25, v25
  v_mul_f32 v126, v26, v26
  v_mul_f32 v127, v27, v27
  v_fma_f32 v124, v124, v118, v116
  s_waitcnt vmcnt(35)
  v_mfma_f32_32x32x16_bf16 a[224:239], a[40:43], v[168:171], a[224:239]
  v_fma_f32 v125, v125, v118, v116
  v_fma_f32 v126, v126, v118, v116
  v_fma_f32 v127, v127, v118, v116
  v_mul_f32 v124, v124, v24
  v_mul_f32 v125, v125, v25
  v_mul_f32 v126, v126, v26
  v_mfma_f32_32x32x16_bf16 v[32:47], a[44:47], v[168:171], v[32:47]
  s_add_u32 s96, s63, 51200
  buffer_load_dwordx4 v[236:239], v1, s[28:31], s96 offen sc1
  v_mul_f32 v127, v127, v27
  v_exp_f32 v124, v124
  v_exp_f32 v125, v125
  s_waitcnt vmcnt(35)
  v_mfma_f32_32x32x16_bf16 v[48:63], a[40:43], v[172:175], v[48:63]
  s_buffer_load_dwordx4 s[44:47], s[28:31], s37 offset:2048
  v_exp_f32 v126, v126
  v_exp_f32 v127, v127
  v_mfma_f32_32x32x16_bf16 v[240:255], a[44:47], v[172:175], v[240:255]
  v_fma_f32 v124, v124, v120, v120
  v_fma_f32 v125, v125, v120, v120
  v_fma_f32 v126, v126, v120, v120
  v_fma_f32 v127, v127, v120, v120
  v_rcp_f32 v124, v124
  s_waitcnt vmcnt(18)
  v_mfma_f32_32x32x16_bf16 a[224:239], a[48:51], v[176:179], a[224:239]
  v_rcp_f32 v125, v125
  v_rcp_f32 v126, v126
  v_rcp_f32 v127, v127
  v_mfma_f32_32x32x16_bf16 v[32:47], a[52:55], v[176:179], v[32:47]
  v_mul_f32 v24, v24, v124
  v_mul_f32 v25, v25, v125
  v_mul_f32 v26, v26, v126
  v_mul_f32 v27, v27, v127
  v_cvt_pk_bf16_f32 v20, v24, v25
  v_cvt_pk_bf16_f32 v21, v26, v27
  s_waitcnt vmcnt(17)
  v_mfma_f32_32x32x16_bf16 v[48:63], a[48:51], v[180:183], v[48:63]
  v_mul_f32 v124, v28, v28
  v_mul_f32 v125, v29, v29
  v_mul_f32 v126, v30, v30
  v_mul_f32 v127, v31, v31
  v_fma_f32 v124, v124, v118, v116
  v_fma_f32 v125, v125, v118, v116
  v_mfma_f32_32x32x16_bf16 v[240:255], a[52:55], v[180:183], v[240:255]
  v_fma_f32 v126, v126, v118, v116
  v_fma_f32 v127, v127, v118, v116
  v_mul_f32 v124, v124, v28
  v_mul_f32 v125, v125, v29
  v_mul_f32 v126, v126, v30
  v_mul_f32 v127, v127, v31
  v_exp_f32 v124, v124
  v_exp_f32 v125, v125
  v_exp_f32 v126, v126
  v_exp_f32 v127, v127
  v_fma_f32 v124, v124, v120, v120
  v_fma_f32 v125, v125, v120, v120
  v_fma_f32 v126, v126, v120, v120
  v_fma_f32 v127, v127, v120, v120
  v_rcp_f32 v124, v124
  v_rcp_f32 v125, v125
  v_rcp_f32 v126, v126
  v_rcp_f32 v127, v127
  v_mul_f32 v28, v28, v124
  v_mul_f32 v29, v29, v125
  v_mul_f32 v30, v30, v126
  v_mul_f32 v31, v31, v127
  v_cvt_pk_bf16_f32 v22, v28, v29
  v_cvt_pk_bf16_f32 v23, v30, v31
  s_waitcnt vmcnt(16)
  v_mfma_f32_32x32x16_bf16 a[224:239], a[56:59], v[184:187], a[224:239]
  buffer_store_dwordx4 v[20:23], v1, s[28:31], s58 offen offset:3072 sc1
  v_mfma_f32_32x32x16_bf16 v[32:47], a[60:63], v[184:187], v[32:47]
  s_waitcnt vmcnt(16)
  v_mfma_f32_32x32x16_bf16 v[48:63], a[56:59], v[188:191], v[48:63]
  s_waitcnt lgkmcnt(0)
  s_or_b32 s47, s47, 0xffff0000
  s_nand_b64 s[44:45], s[44:45], s[46:47]
  s_cbranch_scc1 L72
L73:
  v_mfma_f32_32x32x16_bf16 v[240:255], a[60:63], v[188:191], v[240:255]
  s_add_u32 s96, s59, 4096
  buffer_load_dwordx4 v[128:131], v1, s[28:31], s96 offen sc1
  s_waitcnt vmcnt(16)
  v_mfma_f32_32x32x16_bf16 a[224:239], a[64:67], v[192:195], a[224:239]
  s_add_u32 s96, s63, 4096
  buffer_load_dwordx4 v[132:135], v1, s[28:31], s96 offen sc1
  v_mfma_f32_32x32x16_bf16 v[32:47], a[68:71], v[192:195], v[32:47]
  s_add_u32 s96, s59, 12288
  buffer_load_dwordx4 v[136:139], v1, s[28:31], s96 offen sc1
  s_waitcnt vmcnt(17)
  v_mfma_f32_32x32x16_bf16 v[48:63], a[64:67], v[196:199], v[48:63]
  s_add_u32 s96, s63, 12288
  buffer_load_dwordx4 v[140:143], v1, s[28:31], s96 offen sc1
  v_mfma_f32_32x32x16_bf16 v[240:255], a[68:71], v[196:199], v[240:255]
  s_add_u32 s96, s59, 20480
  buffer_load_dwordx4 v[144:147], v1, s[28:31], s96 offen sc1
  s_waitcnt vmcnt(18)
  v_mfma_f32_32x32x16_bf16 a[224:239], a[72:75], v[200:203], a[224:239]
  s_add_u32 s96, s63, 20480
  buffer_load_dwordx4 v[148:151], v1, s[28:31], s96 offen sc1
  v_mfma_f32_32x32x16_bf16 v[32:47], a[76:79], v[200:203], v[32:47]
  s_add_u32 s96, s59, 28672
  buffer_load_dwordx4 v[152:155], v1, s[28:31], s96 offen sc1
  s_waitcnt vmcnt(19)
  v_mfma_f32_32x32x16_bf16 v[48:63], a[72:75], v[204:207], v[48:63]
  v_mfma_f32_32x32x16_bf16 v[240:255], a[76:79], v[204:207], v[240:255]
  s_add_u32 s96, s63, 28672
  buffer_load_dwordx4 v[156:159], v1, s[28:31], s96 offen sc1
  s_waitcnt vmcnt(19)
  v_mfma_f32_32x32x16_bf16 a[224:239], a[80:83], v[208:211], a[224:239]
  v_mfma_f32_32x32x16_bf16 v[32:47], a[84:87], v[208:211], v[32:47]
  s_add_u32 s96, s59, 36864
  buffer_load_dwordx4 v[160:163], v1, s[28:31], s96 offen sc1
  s_waitcnt vmcnt(19)
  v_mfma_f32_32x32x16_bf16 v[48:63], a[80:83], v[212:215], v[48:63]
  v_and_b32 v14, 0x1c0, v1
  v_or_b32 v14, 16711680, v14
  s_cmp_eq_u32 s51, 0
  s_waitcnt vmcnt(9)
  buffer_store_byte_d16_hi v14, v14, s[28:31], s10 offen offset:2560
  v_mov_b32 v14, 7
  s_cbranch_scc1 L77
  buffer_store_dword v14, off, s[28:31], s52
L78:
  v_mfma_f32_32x32x16_bf16 v[240:255], a[84:87], v[212:215], v[240:255]
  s_add_u32 s96, s63, 36864
  buffer_load_dwordx4 v[164:167], v1, s[28:31], s96 offen sc1
  v_mfma_f32_32x32x16_bf16 a[224:239], a[88:91], v[216:219], a[224:239]
  s_barrier
  v_mfma_f32_32x32x16_bf16 v[32:47], a[92:95], v[216:219], v[32:47]
  s_add_u32 s96, s59, 45056
  buffer_load_dwordx4 v[168:171], v1, s[28:31], s96 offen sc1
  v_mfma_f32_32x32x16_bf16 v[48:63], a[88:91], v[220:223], v[48:63]
  v_mfma_f32_32x32x16_bf16 v[240:255], a[92:95], v[220:223], v[240:255]
  s_add_u32 s96, s63, 45056
  buffer_load_dwordx4 v[172:175], v1, s[28:31], s96 offen sc1
  v_mfma_f32_32x32x16_bf16 a[224:239], a[96:99], v[224:227], a[224:239]
  v_mfma_f32_32x32x16_bf16 v[32:47], a[100:103], v[224:227], v[32:47]
  s_add_u32 s96, s59, 53248
  buffer_load_dwordx4 v[176:179], v1, s[28:31], s96 offen sc1
  v_mfma_f32_32x32x16_bf16 v[48:63], a[96:99], v[228:231], v[48:63]
  s_buffer_load_dwordx4 s[44:47], s[28:31], s37 offset:2560
  v_mfma_f32_32x32x16_bf16 v[240:255], a[100:103], v[228:231], v[240:255]
  s_add_u32 s96, s63, 53248
  buffer_load_dwordx4 v[180:183], v1, s[28:31], s96 offen sc1
  v_mfma_f32_32x32x16_bf16 a[224:239], a[104:107], v[232:235], a[224:239]
  v_mfma_f32_32x32x16_bf16 v[32:47], a[108:111], v[232:235], v[32:47]
  v_mfma_f32_32x32x16_bf16 v[48:63], a[104:107], v[236:239], v[48:63]
  v_mfma_f32_32x32x16_bf16 v[240:255], a[108:111], v[236:239], v[240:255]
  s_waitcnt vmcnt(15)
  v_mfma_f32_32x32x16_bf16 a[224:239], a[112:115], v[128:131], a[224:239]
  v_mfma_f32_32x32x16_bf16 v[32:47], a[116:119], v[128:131], v[32:47]
  s_waitcnt vmcnt(14)
  v_mfma_f32_32x32x16_bf16 v[48:63], a[112:115], v[132:135], v[48:63]
  s_waitcnt lgkmcnt(0)
  s_or_b32 s47, s47, 0xffff0000
  s_nand_b64 s[44:45], s[44:45], s[46:47]
  s_cbranch_scc1 L79
L80:
  v_mfma_f32_32x32x16_bf16 v[240:255], a[116:119], v[132:135], v[240:255]
  s_add_u32 s96, s59, 6144
  buffer_load_dwordx4 v[184:187], v1, s[28:31], s96 offen sc1
  s_waitcnt vmcnt(14)
  v_mfma_f32_32x32x16_bf16 a[224:239], a[120:123], v[136:139], a[224:239]
  s_add_u32 s96, s63, 6144
  buffer_load_dwordx4 v[188:191], v1, s[28:31], s96 offen sc1
  v_mfma_f32_32x32x16_bf16 v[32:47], a[124:127], v[136:139], v[32:47]
  s_add_u32 s96, s59, 14336
  buffer_load_dwordx4 v[192:195], v1, s[28:31], s96 offen sc1
  s_waitcnt vmcnt(15)
  v_mfma_f32_32x32x16_bf16 v[48:63], a[120:123], v[140:143], v[48:63]
  s_add_u32 s96, s63, 14336
  buffer_load_dwordx4 v[196:199], v1, s[28:31], s96 offen sc1
  v_mfma_f32_32x32x16_bf16 v[240:255], a[124:127], v[140:143], v[240:255]
  s_add_u32 s96, s59, 22528
  buffer_load_dwordx4 v[200:203], v1, s[28:31], s96 offen sc1
  s_waitcnt vmcnt(16)
  v_mfma_f32_32x32x16_bf16 a[224:239], a[128:131], v[144:147], a[224:239]
  s_add_u32 s96, s63, 22528
  buffer_load_dwordx4 v[204:207], v1, s[28:31], s96 offen sc1
  v_mfma_f32_32x32x16_bf16 v[32:47], a[132:135], v[144:147], v[32:47]
  s_add_u32 s96, s59, 30720
  buffer_load_dwordx4 v[208:211], v1, s[28:31], s96 offen sc1
  s_waitcnt vmcnt(17)
  v_mfma_f32_32x32x16_bf16 v[48:63], a[128:131], v[148:151], v[48:63]
  v_mfma_f32_32x32x16_bf16 v[240:255], a[132:135], v[148:151], v[240:255]
  s_add_u32 s96, s63, 30720
  buffer_load_dwordx4 v[212:215], v1, s[28:31], s96 offen sc1
  s_waitcnt vmcnt(17)
  v_mfma_f32_32x32x16_bf16 a[224:239], a[136:139], v[152:155], a[224:239]
  v_mfma_f32_32x32x16_bf16 v[32:47], a[140:143], v[152:155], v[32:47]
  s_add_u32 s96, s59, 38912
  buffer_load_dwordx4 v[216:219], v1, s[28:31], s96 offen sc1
  s_waitcnt vmcnt(17)
  v_mfma_f32_32x32x16_bf16 v[48:63], a[136:139], v[156:159], v[48:63]
  v_mfma_f32_32x32x16_bf16 v[240:255], a[140:143], v[156:159], v[240:255]
  s_add_u32 s96, s63, 38912
  buffer_load_dwordx4 v[220:223], v1, s[28:31], s96 offen sc1
  s_waitcnt vmcnt(17)
  v_mfma_f32_32x32x16_bf16 a[224:239], a[144:147], v[160:163], a[224:239]
  v_mfma_f32_32x32x16_bf16 v[32:47], a[148:151], v[160:163], v[32:47]
  s_add_u32 s96, s59, 47104
  buffer_load_dwordx4 v[224:227], v1, s[28:31], s96 offen sc1
  s_waitcnt vmcnt(15)
  v_mfma_f32_32x32x16_bf16 v[48:63], a[144:147], v[164:167], v[48:63]
  v_mfma_f32_32x32x16_bf16 v[240:255], a[148:151], v[164:167], v[240:255]
  s_add_u32 s96, s63, 47104
  buffer_load_dwordx4 v[228:231], v1, s[28:31], s96 offen sc1
  s_waitcnt vmcnt(15)
  v_mfma_f32_32x32x16_bf16 a[224:239], a[152:155], v[168:171], a[224:239]
  v_mfma_f32_32x32x16_bf16 v[32:47], a[156:159], v[168:171], v[32:47]
  s_add_u32 s96, s59, 55296
  buffer_load_dwordx4 v[232:235], v1, s[28:31], s96 offen sc1
  s_waitcnt vmcnt(15)
  v_mfma_f32_32x32x16_bf16 v[48:63], a[152:155], v[172:175], v[48:63]
  v_mfma_f32_32x32x16_bf16 v[240:255], a[156:159], v[172:175], v[240:255]
  s_add_u32 s96, s63, 55296
  buffer_load_dwordx4 v[236:239], v1, s[28:31], s96 offen sc1
  s_waitcnt vmcnt(15)
  v_mfma_f32_32x32x16_bf16 a[224:239], a[160:163], v[176:179], a[224:239]
  v_mfma_f32_32x32x16_bf16 v[32:47], a[164:167], v[176:179], v[32:47]
  s_waitcnt vmcnt(14)
  v_mfma_f32_32x32x16_bf16 v[48:63], a[160:163], v[180:183], v[48:63]
  v_mfma_f32_32x32x16_bf16 v[240:255], a[164:167], v[180:183], v[240:255]
  s_xor_b32 s96, s6, 0
  s_mul_i32 s96, s96, 12288
  s_add_u32 s96, s96, 98304
  v_add_u32 v16, s96, v1
  s_xor_b32 s96, s6, 1
  s_mul_i32 s96, s96, 12288
  s_add_u32 s96, s96, 98304
  v_add_u32 v17, s96, v1
  s_xor_b32 s96, s6, 2
  s_mul_i32 s96, s96, 12288
  s_add_u32 s96, s96, 102400
  v_add_u32 v18, s96, v1
  s_xor_b32 s96, s6, 3
  s_mul_i32 s96, s96, 12288
  s_add_u32 s96, s96, 106496
  v_add_u32 v19, s96, v1
  s_lshl_b32 s56, s49, 4
  s_add_u32 s56, s56, s50
  s_lshl_b32 s55, s56, 11
  s_add_u32 s55, s55, 0
  s_lshl_b32 s56, s56, 8
  s_add_u32 s56, s56, 11534336
  v_lshlrev_b32 v15, 2, v0
  s_waitcnt vmcnt(13)
  v_mfma_f32_32x32x16_bf16 a[224:239], a[168:171], v[184:187], a[224:239]
  v_mfma_f32_32x32x16_bf16 v[32:47], a[172:175], v[184:187], v[32:47]
  s_waitcnt vmcnt(12)
  v_mfma_f32_32x32x16_bf16 v[48:63], a[168:171], v[188:191], v[48:63]
  v_mfma_f32_32x32x16_bf16 v[240:255], a[172:175], v[188:191], v[240:255]
  s_waitcnt vmcnt(11)
  v_mfma_f32_32x32x16_bf16 a[224:239], a[176:179], v[192:195], a[224:239]
  v_mfma_f32_32x32x16_bf16 v[32:47], a[180:183], v[192:195], v[32:47]
  s_waitcnt vmcnt(10)
  v_mfma_f32_32x32x16_bf16 v[48:63], a[176:179], v[196:199], v[48:63]
  v_mfma_f32_32x32x16_bf16 v[240:255], a[180:183], v[196:199], v[240:255]
  s_waitcnt vmcnt(9)
  v_mfma_f32_32x32x16_bf16 a[224:239], a[184:187], v[200:203], a[224:239]
  v_mfma_f32_32x32x16_bf16 v[32:47], a[188:191], v[200:203], v[32:47]
  s_waitcnt vmcnt(8)
  v_mfma_f32_32x32x16_bf16 v[48:63], a[184:187], v[204:207], v[48:63]
  v_mfma_f32_32x32x16_bf16 v[240:255], a[188:191], v[204:207], v[240:255]
  s_waitcnt vmcnt(7)
  v_mfma_f32_32x32x16_bf16 a[224:239], a[192:195], v[208:211], a[224:239]
  v_mfma_f32_32x32x16_bf16 v[32:47], a[196:199], v[208:211], v[32:47]
  s_waitcnt vmcnt(6)
  v_mfma_f32_32x32x16_bf16 v[48:63], a[192:195], v[212:215], v[48:63]
  v_mfma_f32_32x32x16_bf16 v[240:255], a[196:199], v[212:215], v[240:255]
  s_waitcnt vmcnt(5)
  v_mfma_f32_32x32x16_bf16 a[224:239], a[200:203], v[216:219], a[224:239]
  v_mfma_f32_32x32x16_bf16 v[32:47], a[204:207], v[216:219], v[32:47]
  s_waitcnt vmcnt(4)
  v_mfma_f32_32x32x16_bf16 v[48:63], a[200:203], v[220:223], v[48:63]
  v_mfma_f32_32x32x16_bf16 v[240:255], a[204:207], v[220:223], v[240:255]
  s_waitcnt vmcnt(2)
  v_mfma_f32_32x32x16_bf16 v[240:255], a[212:215], v[228:231], v[240:255]
  s_waitcnt vmcnt(0)
  v_mfma_f32_32x32x16_bf16 v[240:255], a[220:223], v[236:239], v[240:255]
  v_mfma_f32_32x32x16_bf16 v[48:63], a[208:211], v[228:231], v[48:63]
  v_mfma_f32_32x32x16_bf16 v[48:63], a[216:219], v[236:239], v[48:63]
  s_nop 9
  ds_write_b128 v19, v[240:243] offset:0
  ds_write_b128 v19, v[244:247] offset:1024
  ds_write_b128 v19, v[248:251] offset:2048
  ds_write_b128 v19, v[252:255] offset:3072
  v_mfma_f32_32x32x16_bf16 v[32:47], a[212:215], v[224:227], v[32:47]
  v_mfma_f32_32x32x16_bf16 v[32:47], a[220:223], v[232:235], v[32:47]
  ds_write_b128 v18, v[48:51] offset:0
  ds_write_b128 v18, v[52:55] offset:1024
  ds_write_b128 v18, v[56:59] offset:2048
  ds_write_b128 v18, v[60:63] offset:3072
  v_mfma_f32_32x32x16_bf16 a[224:239], a[208:211], v[224:227], a[224:239]
  v_mfma_f32_32x32x16_bf16 a[224:239], a[216:219], v[232:235], a[224:239]
  s_nop 5
  ds_write_b128 v17, v[32:35] offset:0
  ds_write_b128 v17, v[36:39] offset:1024
  ds_write_b128 v17, v[40:43] offset:2048
  ds_write_b128 v17, v[44:47] offset:3072
  s_nop 1
  v_accvgpr_read_b32 v64, a224
  v_accvgpr_read_b32 v65, a225
  v_accvgpr_read_b32 v66, a226
  v_accvgpr_read_b32 v67, a227
  v_accvgpr_read_b32 v68, a228
  v_accvgpr_read_b32 v69, a229
  v_accvgpr_read_b32 v70, a230
  v_accvgpr_read_b32 v71, a231
  v_accvgpr_read_b32 v72, a232
  v_accvgpr_read_b32 v73, a233
  v_accvgpr_read_b32 v74, a234
  v_accvgpr_read_b32 v75, a235
  v_accvgpr_read_b32 v76, a236
  v_accvgpr_read_b32 v77, a237
  v_accvgpr_read_b32 v78, a238
  v_accvgpr_read_b32 v79, a239
  s_waitcnt lgkmcnt(0)
  s_barrier
  ds_read_b128 v[80:83], v16 offset:0
  ds_read_b128 v[84:87], v16 offset:1024
  ds_read_b128 v[88:91], v16 offset:2048
  ds_read_b128 v[92:95], v16 offset:3072
  ds_read_b128 v[96:99], v16 offset:4096
  ds_read_b128 v[100:103], v16 offset:5120
  ds_read_b128 v[104:107], v16 offset:6144
  ds_read_b128 v[108:111], v16 offset:7168
  ds_read_b128 v[112:115], v16 offset:8192
  ds_read_b128 v[116:119], v16 offset:9216
  ds_read_b128 v[120:123], v16 offset:10240
  ds_read_b128 v[124:127], v16 offset:11264
  s_waitcnt lgkmcnt(11)
  v_pk_add_f32 v[64:65], v[64:65], v[80:81]
  v_pk_add_f32 v[66:67], v[66:67], v[82:83]
  s_waitcnt lgkmcnt(10)
  v_pk_add_f32 v[68:69], v[68:69], v[84:85]
  v_pk_add_f32 v[70:71], v[70:71], v[86:87]
  s_waitcnt lgkmcnt(9)
  v_pk_add_f32 v[72:73], v[72:73], v[88:89]
  v_pk_add_f32 v[74:75], v[74:75], v[90:91]
  s_waitcnt lgkmcnt(8)
  v_pk_add_f32 v[76:77], v[76:77], v[92:93]
  v_pk_add_f32 v[78:79], v[78:79], v[94:95]
  s_waitcnt lgkmcnt(7)
  v_pk_add_f32 v[64:65], v[64:65], v[96:97]
  v_pk_add_f32 v[66:67], v[66:67], v[98:99]
  s_waitcnt lgkmcnt(6)
  v_pk_add_f32 v[68:69], v[68:69], v[100:101]
  v_pk_add_f32 v[70:71], v[70:71], v[102:103]
  s_waitcnt lgkmcnt(5)
  v_pk_add_f32 v[72:73], v[72:73], v[104:105]
  v_pk_add_f32 v[74:75], v[74:75], v[106:107]
  s_waitcnt lgkmcnt(4)
  v_pk_add_f32 v[76:77], v[76:77], v[108:109]
  v_pk_add_f32 v[78:79], v[78:79], v[110:111]
  s_waitcnt lgkmcnt(3)
  v_pk_add_f32 v[64:65], v[64:65], v[112:113]
  v_pk_add_f32 v[66:67], v[66:67], v[114:115]
  s_waitcnt lgkmcnt(2)
  v_pk_add_f32 v[68:69], v[68:69], v[116:117]
  v_pk_add_f32 v[70:71], v[70:71], v[118:119]
  s_waitcnt lgkmcnt(1)
  v_pk_add_f32 v[72:73], v[72:73], v[120:121]
  v_pk_add_f32 v[74:75], v[74:75], v[122:123]
  s_waitcnt lgkmcnt(0)
  v_pk_add_f32 v[76:77], v[76:77], v[124:125]
  v_pk_add_f32 v[78:79], v[78:79], v[126:127]
  v_cvt_pk_bf16_f32 v16, v64, v65
  v_cvt_pk_bf16_f32 v17, v66, v67
  v_cvt_pk_bf16_f32 v18, v68, v69
  v_cvt_pk_bf16_f32 v19, v70, v71
  v_cvt_pk_bf16_f32 v20, v72, v73
  v_cvt_pk_bf16_f32 v21, v74, v75
  v_cvt_pk_bf16_f32 v22, v76, v77
  v_cvt_pk_bf16_f32 v23, v78, v79
  s_cmp_eq_u32 s51, 0
  s_cbranch_scc1 L89
  buffer_store_dwordx4 v[16:19], v1, s[32:35], s55 offen
L90:
  s_cmp_eq_u32 s51, 0
  s_cbranch_scc1 L91
  buffer_store_dwordx4 v[20:23], v1, s[32:35], s55 offen offset:1024
L92:
  v_pk_add_f32 v[24:25], v[64:65], v[66:67]
  v_pk_mul_f32 v[26:27], v[64:65], v[64:65]
  v_pk_fma_f32 v[26:27], v[66:67], v[66:67], v[26:27]
  v_pk_add_f32 v[24:25], v[24:25], v[68:69]
  v_pk_fma_f32 v[26:27], v[68:69], v[68:69], v[26:27]
  v_pk_add_f32 v[24:25], v[24:25], v[70:71]
  v_pk_fma_f32 v[26:27], v[70:71], v[70:71], v[26:27]
  v_pk_add_f32 v[24:25], v[24:25], v[72:73]
  v_pk_fma_f32 v[26:27], v[72:73], v[72:73], v[26:27]
  v_pk_add_f32 v[24:25], v[24:25], v[74:75]
  v_pk_fma_f32 v[26:27], v[74:75], v[74:75], v[26:27]
  v_pk_add_f32 v[24:25], v[24:25], v[76:77]
  v_pk_fma_f32 v[26:27], v[76:77], v[76:77], v[26:27]
  v_pk_add_f32 v[24:25], v[24:25], v[78:79]
  v_pk_fma_f32 v[26:27], v[78:79], v[78:79], v[26:27]
  v_add_f32 v24, v24, v25
  v_add_f32 v26, v26, v27
  s_nop 1
  v_permlane32_swap_b32 v24, v26
  v_add_f32 v24, v24, v26
  s_cmp_eq_u32 s51, 0
  s_cbranch_scc1 L93
  buffer_store_dword v24, v15, s[28:31], s56 offen
L94:
  v_accvgpr_write_b32 a224, v64
  v_accvgpr_write_b32 a225, v65
  v_accvgpr_write_b32 a226, v66
  v_accvgpr_write_b32 a227, v67
  v_accvgpr_write_b32 a228, v68
  v_accvgpr_write_b32 a229, v69
  v_accvgpr_write_b32 a230, v70
  v_accvgpr_write_b32 a231, v71
  v_accvgpr_write_b32 a232, v72
  v_accvgpr_write_b32 a233, v73
  v_accvgpr_write_b32 a234, v74
  v_accvgpr_write_b32 a235, v75
  v_accvgpr_write_b32 a236, v76
  v_accvgpr_write_b32 a237, v77
  v_accvgpr_write_b32 a238, v78
  v_accvgpr_write_b32 a239, v79
  v_and_b32 v14, 0x1c0, v1
  v_or_b32 v14, 16711680, v14
  s_cmp_eq_u32 s51, 0
  s_waitcnt vmcnt(0)
  buffer_store_byte_d16_hi v14, v14, s[28:31], s9 offen offset:3584
  v_mov_b32 v14, 8
  s_cbranch_scc1 L95
  buffer_store_dword v14, off, s[28:31], s52
L96:
  s_add_u32 s9, s9, 4096
  s_add_u32 s10, s10, 4096
L_p1_1:
  s_mul_i32 s61, s6, 98304
  s_lshl_b32 s62, s5, 6
  s_add_u32 s61, s61, s62
  s_lshl_b32 s62, s6, 11
  s_xor_b32 s60, s0, 0
  s_mul_i32 s60, s60, 393216
  s_add_u32 m0, s62, 65536
  s_add_u32 s60, s60, s61
  buffer_load_dwordx4 v10, s[12:15], s60 offen offset:0 lds
  s_add_u32 s60, s60, 48128
  buffer_load_dwordx4 v10, s[12:15], s60 offen offset:1024 lds
  s_xor_b32 s60, s0, 1
  s_mul_i32 s60, s60, 393216
  s_add_u32 m0, s62, 73728
  s_add_u32 s60, s60, s61
  buffer_load_dwordx4 v10, s[12:15], s60 offen offset:0 lds
  s_add_u32 s60, s60, 48128
  buffer_load_dwordx4 v10, s[12:15], s60 offen offset:1024 lds
  v_add_u32 v15, 156160, v1
  ds_read_b128 v[116:119], v15 offset:0
  ds_read_b128 v[120:123], v15 offset:1024
  ds_read_b128 v[124:127], v15 offset:2048
L97:
  ds_read_b64_tr_b16 v[64:65], v2 offset:0
  ds_read_b64_tr_b16 v[66:67], v2 offset:256
  ds_read_b64_tr_b16 v[68:69], v2 offset:32768
  ds_read_b64_tr_b16 v[70:71], v2 offset:33024
  ds_read_b64_tr_b16 v[72:73], v2 offset:1024
  ds_read_b64_tr_b16 v[74:75], v2 offset:1280
  ds_read_b64_tr_b16 v[76:77], v2 offset:33792
  ds_read_b64_tr_b16 v[78:79], v2 offset:34048
  ds_read_b64_tr_b16 v[80:81], v2 offset:2048
  ds_read_b64_tr_b16 v[82:83], v2 offset:2304
  ds_read_b64_tr_b16 v[84:85], v2 offset:34816
  ds_read_b64_tr_b16 v[86:87], v2 offset:35072
  s_lshl_b32 s55, s48, 2
  s_add_u32 s55, s55, s0
  s_lshl_b32 s55, s55, 13
  s_add_u32 s55, s55, 0
  s_lshl_b32 s56, s48, 12
  s_add_u32 s56, s56, 11534336
  v_lshlrev_b32 v111, 2, v0
  s_buffer_load_dwordx4 s[44:47], s[28:31], s38 offset:3584
  s_waitcnt lgkmcnt(0)
  s_nand_b64 s[44:45], s[44:45], s[46:47]
  s_cbranch_scc1 L98
L99:
  s_xor_b32 s54, s55, 0
  buffer_load_dwordx4 v[128:131], v1, s[32:35], s54 offen offset:0 sc1
  buffer_load_dwordx4 v[132:135], v1, s[32:35], s54 offen offset:1024 sc1
  buffer_load_dwordx4 v[136:139], v1, s[32:35], s54 offen offset:2048 sc1
  buffer_load_dwordx4 v[140:143], v1, s[32:35], s54 offen offset:3072 sc1
  s_xor_b32 s54, s55, 4096
  buffer_load_dwordx4 v[144:147], v1, s[32:35], s54 offen offset:0 sc1
  buffer_load_dwordx4 v[148:151], v1, s[32:35], s54 offen offset:1024 sc1
  buffer_load_dwordx4 v[152:155], v1, s[32:35], s54 offen offset:2048 sc1
  buffer_load_dwordx4 v[156:159], v1, s[32:35], s54 offen offset:3072 sc1
  s_xor_b32 s54, s55, 8192
  buffer_load_dwordx4 v[160:163], v1, s[32:35], s54 offen offset:0 sc1
  buffer_load_dwordx4 v[164:167], v1, s[32:35], s54 offen offset:1024 sc1
  buffer_load_dwordx4 v[168:171], v1, s[32:35], s54 offen offset:2048 sc1
  buffer_load_dwordx4 v[172:175], v1, s[32:35], s54 offen offset:3072 sc1
  s_xor_b32 s54, s55, 12288
  buffer_load_dwordx4 v[176:179], v1, s[32:35], s54 offen offset:0 sc1
  buffer_load_dwordx4 v[180:183], v1, s[32:35], s54 offen offset:1024 sc1
  ds_read_b64_tr_b16 v[88:89], v2 offset:3072
  ds_read_b64_tr_b16 v[90:91], v2 offset:3328
  ds_read_b64_tr_b16 v[92:93], v2 offset:35840
  ds_read_b64_tr_b16 v[94:95], v2 offset:36096
  s_waitcnt vmcnt(13)
  v_mfma_f32_32x32x16_bf16 v[16:31], v[64:67], v[128:131], 0
  v_mfma_f32_32x32x16_bf16 v[32:47], v[128:131], v[68:71], 0
  buffer_load_dwordx4 v[184:187], v1, s[32:35], s54 offen offset:2048 sc1
  ds_read_b64_tr_b16 v[64:65], v2 offset:4096
  ds_read_b64_tr_b16 v[66:67], v2 offset:4352
  ds_read_b64_tr_b16 v[68:69], v2 offset:36864
  ds_read_b64_tr_b16 v[70:71], v2 offset:37120
  s_waitcnt vmcnt(13)
  v_mfma_f32_32x32x16_bf16 v[16:31], v[72:75], v[132:135], v[16:31]
  v_mfma_f32_32x32x16_bf16 v[32:47], v[132:135], v[76:79], v[32:47]
  buffer_load_dwordx4 v[188:191], v1, s[32:35], s54 offen offset:3072 sc1
  ds_read_b64_tr_b16 v[72:73], v2 offset:5120
  ds_read_b64_tr_b16 v[74:75], v2 offset:5376
  ds_read_b64_tr_b16 v[76:77], v2 offset:37888
  ds_read_b64_tr_b16 v[78:79], v2 offset:38144
  s_waitcnt vmcnt(13)
  v_mfma_f32_32x32x16_bf16 v[16:31], v[80:83], v[136:139], v[16:31]
  v_mfma_f32_32x32x16_bf16 v[32:47], v[136:139], v[84:87], v[32:47]
  buffer_load_dword v96, v111, s[28:31], s56 offen offset:0 sc1
  buffer_load_dword v97, v111, s[28:31], s56 offen offset:256 sc1
  buffer_load_dword v98, v111, s[28:31], s56 offen offset:512 sc1
  buffer_load_dword v99, v111, s[28:31], s56 offen offset:768 sc1
  ds_read_b64_tr_b16 v[80:81], v2 offset:6144
  ds_read_b64_tr_b16 v[82:83], v2 offset:6400
  ds_read_b64_tr_b16 v[84:85], v2 offset:38912
  ds_read_b64_tr_b16 v[86:87], v2 offset:39168
  s_waitcnt vmcnt(16) lgkmcnt(14)
  v_mfma_f32_32x32x16_bf16 v[16:31], v[88:91], v[140:143], v[16:31]
  s_waitcnt lgkmcnt(12)
  v_mfma_f32_32x32x16_bf16 v[32:47], v[140:143], v[92:95], v[32:47]
  buffer_load_dword v100, v111, s[28:31], s56 offen offset:1024 sc1
  buffer_load_dword v101, v111, s[28:31], s56 offen offset:1280 sc1
  buffer_load_dword v102, v111, s[28:31], s56 offen offset:1536 sc1
  buffer_load_dword v103, v111, s[28:31], s56 offen offset:1792 sc1
  ds_read_b64_tr_b16 v[88:89], v2 offset:7168
  ds_read_b64_tr_b16 v[90:91], v2 offset:7424
  ds_read_b64_tr_b16 v[92:93], v2 offset:39936
  ds_read_b64_tr_b16 v[94:95], v2 offset:40192
  s_waitcnt vmcnt(19) lgkmcnt(14)
  v_mfma_f32_32x32x16_bf16 v[16:31], v[64:67], v[144:147], v[16:31]
  s_waitcnt lgkmcnt(12)
  v_mfma_f32_32x32x16_bf16 v[32:47], v[144:147], v[68:71], v[32:47]
  buffer_load_dword v104, v111, s[28:31], s56 offen offset:2048 sc1
  buffer_load_dword v105, v111, s[28:31], s56 offen offset:2304 sc1
  buffer_load_dword v106, v111, s[28:31], s56 offen offset:2560 sc1
  buffer_load_dword v107, v111, s[28:31], s56 offen offset:2816 sc1
  ds_read_b64_tr_b16 v[64:65], v2 offset:8192
  ds_read_b64_tr_b16 v[66:67], v2 offset:8448
  ds_read_b64_tr_b16 v[68:69], v2 offset:40960
  ds_read_b64_tr_b16 v[70:71], v2 offset:41216
  s_waitcnt vmcnt(22) lgkmcnt(14)
  v_mfma_f32_32x32x16_bf16 v[16:31], v[72:75], v[148:151], v[16:31]
  s_waitcnt lgkmcnt(12)
  v_mfma_f32_32x32x16_bf16 v[32:47], v[148:151], v[76:79], v[32:47]
  buffer_load_dword v108, v111, s[28:31], s56 offen offset:3072 sc1
  buffer_load_dword v109, v111, s[28:31], s56 offen offset:3328 sc1
  buffer_load_dword v110, v111, s[28:31], s56 offen offset:3584 sc1
  buffer_load_dword v111, v111, s[28:31], s56 offen offset:3840 sc1
  ds_read_b64_tr_b16 v[72:73], v2 offset:9216
  ds_read_b64_tr_b16 v[74:75], v2 offset:9472
  ds_read_b64_tr_b16 v[76:77], v2 offset:41984
  ds_read_b64_tr_b16 v[78:79], v2 offset:42240
  s_waitcnt vmcnt(25) lgkmcnt(14)
  v_mfma_f32_32x32x16_bf16 v[16:31], v[80:83], v[152:155], v[16:31]
  s_waitcnt lgkmcnt(12)
  v_mfma_f32_32x32x16_bf16 v[32:47], v[152:155], v[84:87], v[32:47]
  s_xor_b32 s54, s55, 16384
  buffer_load_dwordx4 v[192:195], v1, s[32:35], s54 offen offset:0 sc1
  ds_read_b64_tr_b16 v[80:81], v2 offset:10240
  ds_read_b64_tr_b16 v[82:83], v2 offset:10496
  ds_read_b64_tr_b16 v[84:85], v2 offset:43008
  ds_read_b64_tr_b16 v[86:87], v2 offset:43264
  s_waitcnt vmcnt(25) lgkmcnt(14)
  v_mfma_f32_32x32x16_bf16 v[16:31], v[88:91], v[156:159], v[16:31]
  s_waitcnt lgkmcnt(12)
  v_mfma_f32_32x32x16_bf16 v[32:47], v[156:159], v[92:95], v[32:47]
  buffer_load_dwordx4 v[196:199], v1, s[32:35], s54 offen offset:1024 sc1
  ds_read_b64_tr_b16 v[88:89], v2 offset:11264
  ds_read_b64_tr_b16 v[90:91], v2 offset:11520
  ds_read_b64_tr_b16 v[92:93], v2 offset:44032
  ds_read_b64_tr_b16 v[94:95], v2 offset:44288
  s_waitcnt vmcnt(25) lgkmcnt(14)
  v_mfma_f32_32x32x16_bf16 v[16:31], v[64:67], v[160:163], v[16:31]
  s_waitcnt lgkmcnt(12)
  v_mfma_f32_32x32x16_bf16 v[32:47], v[160:163], v[68:71], v[32:47]
  buffer_load_dwordx4 v[200:203], v1, s[32:35], s54 offen offset:2048 sc1
  ds_read_b64_tr_b16 v[64:65], v2 offset:12288
  ds_read_b64_tr_b16 v[66:67], v2 offset:12544
  ds_read_b64_tr_b16 v[68:69], v2 offset:45056
  ds_read_b64_tr_b16 v[70:71], v2 offset:45312
  s_waitcnt vmcnt(25) lgkmcnt(14)
  v_mfma_f32_32x32x16_bf16 v[16:31], v[72:75], v[164:167], v[16:31]
  s_waitcnt lgkmcnt(12)
  v_mfma_f32_32x32x16_bf16 v[32:47], v[164:167], v[76:79], v[32:47]
  buffer_load_dwordx4 v[204:207], v1, s[32:35], s54 offen offset:3072 sc1
  ds_read_b64_tr_b16 v[72:73], v2 offset:13312
  ds_read_b64_tr_b16 v[74:75], v2 offset:13568
  ds_read_b64_tr_b16 v[76:77], v2 offset:46080
  ds_read_b64_tr_b16 v[78:79], v2 offset:46336
  s_waitcnt vmcnt(25) lgkmcnt(14)
  v_mfma_f32_32x32x16_bf16 v[16:31], v[80:83], v[168:171], v[16:31]
  s_waitcnt lgkmcnt(12)
  v_mfma_f32_32x32x16_bf16 v[32:47], v[168:171], v[84:87], v[32:47]
  s_xor_b32 s54, s55, 20480
  buffer_load_dwordx4 v[208:211], v1, s[32:35], s54 offen offset:0 sc1
  ds_read_b64_tr_b16 v[80:81], v2 offset:14336
  ds_read_b64_tr_b16 v[82:83], v2 offset:14592
  ds_read_b64_tr_b16 v[84:85], v2 offset:47104
  ds_read_b64_tr_b16 v[86:87], v2 offset:47360
  s_waitcnt vmcnt(25) lgkmcnt(14)
  v_mfma_f32_32x32x16_bf16 v[16:31], v[88:91], v[172:175], v[16:31]
  s_waitcnt lgkmcnt(12)
  v_mfma_f32_32x32x16_bf16 v[32:47], v[172:175], v[92:95], v[32:47]
  buffer_load_dwordx4 v[212:215], v1, s[32:35], s54 offen offset:1024 sc1
  ds_read_b64_tr_b16 v[88:89], v2 offset:15360
  ds_read_b64_tr_b16 v[90:91], v2 offset:15616
  ds_read_b64_tr_b16 v[92:93], v2 offset:48128
  ds_read_b64_tr_b16 v[94:95], v2 offset:48384
  s_waitcnt vmcnt(25) lgkmcnt(14)
  v_mfma_f32_32x32x16_bf16 v[16:31], v[64:67], v[176:179], v[16:31]
  s_waitcnt lgkmcnt(12)
  v_mfma_f32_32x32x16_bf16 v[32:47], v[176:179], v[68:71], v[32:47]
  buffer_load_dwordx4 v[216:219], v1, s[32:35], s54 offen offset:2048 sc1
  ds_read_b64_tr_b16 v[64:65], v2 offset:16384
  ds_read_b64_tr_b16 v[66:67], v2 offset:16640
  ds_read_b64_tr_b16 v[68:69], v2 offset:49152
  ds_read_b64_tr_b16 v[70:71], v2 offset:49408
  s_waitcnt vmcnt(25) lgkmcnt(14)
  v_mfma_f32_32x32x16_bf16 v[16:31], v[72:75], v[180:183], v[16:31]
  s_waitcnt lgkmcnt(12)
  v_mfma_f32_32x32x16_bf16 v[32:47], v[180:183], v[76:79], v[32:47]
  buffer_load_dwordx4 v[220:223], v1, s[32:35], s54 offen offset:3072 sc1
  ds_read_b64_tr_b16 v[72:73], v2 offset:17408
  ds_read_b64_tr_b16 v[74:75], v2 offset:17664
  ds_read_b64_tr_b16 v[76:77], v2 offset:50176
  ds_read_b64_tr_b16 v[78:79], v2 offset:50432
  s_waitcnt vmcnt(25) lgkmcnt(14)
  v_mfma_f32_32x32x16_bf16 v[16:31], v[80:83], v[184:187], v[16:31]
  s_waitcnt lgkmcnt(12)
  v_mfma_f32_32x32x16_bf16 v[32:47], v[184:187], v[84:87], v[32:47]
  s_xor_b32 s54, s55, 24576
  buffer_load_dwordx4 v[224:227], v1, s[32:35], s54 offen offset:0 sc1
  ds_read_b64_tr_b16 v[80:81], v2 offset:18432
  ds_read_b64_tr_b16 v[82:83], v2 offset:18688
  ds_read_b64_tr_b16 v[84:85], v2 offset:51200
  ds_read_b64_tr_b16 v[86:87], v2 offset:51456
  s_waitcnt vmcnt(25) lgkmcnt(14)
  v_mfma_f32_32x32x16_bf16 v[16:31], v[88:91], v[188:191], v[16:31]
  s_waitcnt lgkmcnt(12)
  v_mfma_f32_32x32x16_bf16 v[32:47], v[188:191], v[92:95], v[32:47]
  buffer_load_dwordx4 v[228:231], v1, s[32:35], s54 offen offset:1024 sc1
  ds_read_b64_tr_b16 v[88:89], v2 offset:19456
  ds_read_b64_tr_b16 v[90:91], v2 offset:19712
  ds_read_b64_tr_b16 v[92:93], v2 offset:52224
  ds_read_b64_tr_b16 v[94:95], v2 offset:52480
  s_waitcnt vmcnt(9) lgkmcnt(14)
  v_mfma_f32_32x32x16_bf16 v[16:31], v[64:67], v[192:195], v[16:31]
  s_waitcnt lgkmcnt(12)
  v_mfma_f32_32x32x16_bf16 v[32:47], v[192:195], v[68:71], v[32:47]
  buffer_load_dwordx4 v[232:235], v1, s[32:35], s54 offen offset:2048 sc1
  ds_read_b64_tr_b16 v[64:65], v2 offset:20480
  ds_read_b64_tr_b16 v[66:67], v2 offset:20736
  ds_read_b64_tr_b16 v[68:69], v2 offset:53248
  ds_read_b64_tr_b16 v[70:71], v2 offset:53504
  s_waitcnt vmcnt(9) lgkmcnt(14)
  v_mfma_f32_32x32x16_bf16 v[16:31], v[72:75], v[196:199], v[16:31]
  s_waitcnt lgkmcnt(12)
  v_mfma_f32_32x32x16_bf16 v[32:47], v[196:199], v[76:79], v[32:47]
  buffer_load_dwordx4 v[236:239], v1, s[32:35], s54 offen offset:3072 sc1
  ds_read_b64_tr_b16 v[72:73], v2 offset:21504
  ds_read_b64_tr_b16 v[74:75], v2 offset:21760
  ds_read_b64_tr_b16 v[76:77], v2 offset:54272
  ds_read_b64_tr_b16 v[78:79], v2 offset:54528
  s_waitcnt vmcnt(9) lgkmcnt(14)
  v_mfma_f32_32x32x16_bf16 v[16:31], v[80:83], v[200:203], v[16:31]
  s_waitcnt lgkmcnt(12)
  v_mfma_f32_32x32x16_bf16 v[32:47], v[200:203], v[84:87], v[32:47]
  s_xor_b32 s54, s55, 28672
  buffer_load_dwordx4 v[240:243], v1, s[32:35], s54 offen offset:0 sc1
  ds_read_b64_tr_b16 v[80:81], v2 offset:22528
  ds_read_b64_tr_b16 v[82:83], v2 offset:22784
  ds_read_b64_tr_b16 v[84:85], v2 offset:55296
  ds_read_b64_tr_b16 v[86:87], v2 offset:55552
  v_add_f32 v96, v96, v104
  v_add_f32 v97, v97, v105
  v_add_f32 v98, v98, v106
  v_add_f32 v99, v99, v107
  v_add_f32 v100, v100, v108
  v_add_f32 v101, v101, v109
  v_add_f32 v102, v102, v110
  s_waitcnt vmcnt(9) lgkmcnt(14)
  v_mfma_f32_32x32x16_bf16 v[16:31], v[88:91], v[204:207], v[16:31]
  s_waitcnt lgkmcnt(12)
  v_mfma_f32_32x32x16_bf16 v[32:47], v[204:207], v[92:95], v[32:47]
  buffer_load_dwordx4 v[244:247], v1, s[32:35], s54 offen offset:1024 sc1
  ds_read_b64_tr_b16 v[88:89], v2 offset:23552
  ds_read_b64_tr_b16 v[90:91], v2 offset:23808
  ds_read_b64_tr_b16 v[92:93], v2 offset:56320
  ds_read_b64_tr_b16 v[94:95], v2 offset:56576
  v_add_f32 v103, v103, v111
  v_add_f32 v96, v96, v100
  v_add_f32 v97, v97, v101
  v_add_f32 v98, v98, v102
  v_add_f32 v99, v99, v103
  v_add_f32 v96, v96, v98
  s_waitcnt vmcnt(9) lgkmcnt(14)
  v_mfma_f32_32x32x16_bf16 v[16:31], v[64:67], v[208:211], v[16:31]
  s_waitcnt lgkmcnt(12)
  v_mfma_f32_32x32x16_bf16 v[32:47], v[208:211], v[68:71], v[32:47]
  buffer_load_dwordx4 v[248:251], v1, s[32:35], s54 offen offset:2048 sc1
  v_add_f32 v97, v97, v99
  v_add_f32 v96, v96, v97
  v_mov_b32 v97, v96
  s_nop 0
  s_nop 0
  v_permlane32_swap_b32 v96, v97
  s_waitcnt vmcnt(9) lgkmcnt(10)
  v_mfma_f32_32x32x16_bf16 v[16:31], v[72:75], v[212:215], v[16:31]
  s_waitcnt lgkmcnt(8)
  ds_read_b64_tr_b16 v[64:65], v2 offset:24576
  ds_read_b64_tr_b16 v[66:67], v2 offset:24832
  ds_read_b64_tr_b16 v[68:69], v2 offset:57344
  ds_read_b64_tr_b16 v[70:71], v2 offset:57600
  v_mfma_f32_32x32x16_bf16 v[32:47], v[212:215], v[76:79], v[32:47]
  buffer_load_dwordx4 v[252:255], v1, s[32:35], s54 offen offset:3072 sc1
  s_mov_b32 s99, 0x3b000000
  v_mul_f32 v96, 0xbb000000, v96
  v_mul_f32 v98, v96, v96
  v_fma_f32 v97, v97, s99, -v98
  v_cvt_pk_bf16_f32 v112, v96, v96
  v_max_f32 v97, 0, v97
  s_waitcnt vmcnt(9) lgkmcnt(10)
  v_mfma_f32_32x32x16_bf16 v[16:31], v[80:83], v[216:219], v[16:31]
  s_waitcnt lgkmcnt(8)
  ds_read_b64_tr_b16 v[72:73], v2 offset:25600
  ds_read_b64_tr_b16 v[74:75], v2 offset:25856
  ds_read_b64_tr_b16 v[76:77], v2 offset:58368
  ds_read_b64_tr_b16 v[78:79], v2 offset:58624
  v_mfma_f32_32x32x16_bf16 v[32:47], v[216:219], v[84:87], v[32:47]
  s_xor_b32 s60, s0, 2
  s_mul_i32 s60, s60, 393216
  s_add_u32 m0, s62, 81920
  s_add_u32 s60, s60, s61
  buffer_load_dwordx4 v10, s[12:15], s60 offen offset:0 lds
  ds_read_b64_tr_b16 v[80:81], v2 offset:26624
  ds_read_b64_tr_b16 v[82:83], v2 offset:26880
  ds_read_b64_tr_b16 v[84:85], v2 offset:59392
  ds_read_b64_tr_b16 v[86:87], v2 offset:59648
  v_add_f32 v98, 0x3727c5ac, v97
  v_rsq_f32 v13, v98
  s_waitcnt vmcnt(9) lgkmcnt(14)
  v_mfma_f32_32x32x16_bf16 v[16:31], v[88:91], v[220:223], v[16:31]
  s_waitcnt lgkmcnt(12)
  v_mfma_f32_32x32x16_bf16 v[32:47], v[220:223], v[92:95], v[32:47]
  s_add_u32 s60, s60, 48128
  buffer_load_dwordx4 v10, s[12:15], s60 offen offset:1024 lds
  ds_read_b64_tr_b16 v[88:89], v2 offset:27648
  ds_read_b64_tr_b16 v[90:91], v2 offset:27904
  ds_read_b64_tr_b16 v[92:93], v2 offset:60416
  ds_read_b64_tr_b16 v[94:95], v2 offset:60672
  v_lshlrev_b32 v99, 16, v112
  v_sub_f32 v99, v96, v99
  v_mov_b32 v114, v112
  v_cvt_pk_bf16_f32 v113, v99, v99
  s_waitcnt vmcnt(9) lgkmcnt(14)
  v_mfma_f32_32x32x16_bf16 v[16:31], v[64:67], v[224:227], v[16:31]
  s_waitcnt lgkmcnt(12)
  v_mfma_f32_32x32x16_bf16 v[32:47], v[224:227], v[68:71], v[32:47]
  s_xor_b32 s60, s0, 3
  s_mul_i32 s60, s60, 393216
  s_add_u32 m0, s62, 90112
  s_add_u32 s60, s60, s61
  buffer_load_dwordx4 v10, s[12:15], s60 offen offset:0 lds
  v_mov_b32 v115, v113
  s_lshl_b32 s96, s6, 7
  s_add_u32 s96, s96, 163328
  ds_read_b64_tr_b16 v[64:65], v2 offset:28672
  ds_read_b64_tr_b16 v[66:67], v2 offset:28928
  ds_read_b64_tr_b16 v[68:69], v2 offset:61440
  ds_read_b64_tr_b16 v[70:71], v2 offset:61696
  s_waitcnt vmcnt(9) lgkmcnt(14)
  v_mfma_f32_32x32x16_bf16 v[16:31], v[72:75], v[228:231], v[16:31]
  s_waitcnt lgkmcnt(12)
  v_mfma_f32_32x32x16_bf16 v[32:47], v[228:231], v[76:79], v[32:47]
  s_add_u32 s60, s60, 48128
  buffer_load_dwordx4 v10, s[12:15], s60 offen offset:1024 lds
  v_and_b32 v14, 31, v0
  v_lshl_add_u32 v14, v14, 2, s96
  v_lshrrev_b32 v15, 5, v0
  s_waitcnt vmcnt(9) lgkmcnt(10)
  v_mfma_f32_32x32x16_bf16 v[16:31], v[80:83], v[232:235], v[16:31]
  s_waitcnt lgkmcnt(8)
  ds_write_b32 v14, v13
  ds_read_b64_tr_b16 v[72:73], v2 offset:29696
  ds_read_b64_tr_b16 v[74:75], v2 offset:29952
  ds_read_b64_tr_b16 v[76:77], v2 offset:62464
  ds_read_b64_tr_b16 v[78:79], v2 offset:62720
  v_mfma_f32_32x32x16_bf16 v[32:47], v[232:235], v[84:87], v[32:47]
  v_lshl_add_u32 v14, v15, 4, s96
  ds_read_b128 v[96:99], v14 offset:0
  ds_read_b128 v[100:103], v14 offset:32
  ds_read_b128 v[104:107], v14 offset:64
  ds_read_b128 v[108:111], v14 offset:96
  ds_read_b64_tr_b16 v[80:81], v2 offset:30720
  ds_read_b64_tr_b16 v[82:83], v2 offset:30976
  ds_read_b64_tr_b16 v[84:85], v2 offset:63488
  ds_read_b64_tr_b16 v[86:87], v2 offset:63744
  v_lshlrev_b32 v15, 8, v15
  v_and_b32 v14, 0xf0, v1
  s_waitcnt vmcnt(8) lgkmcnt(15)
  v_mfma_f32_32x32x16_bf16 v[16:31], v[88:91], v[236:239], v[16:31]
  v_mfma_f32_32x32x16_bf16 v[32:47], v[236:239], v[92:95], v[32:47]
  ds_read_b64_tr_b16 v[88:89], v2 offset:31744
  ds_read_b64_tr_b16 v[90:91], v2 offset:32000
  ds_read_b64_tr_b16 v[92:93], v2 offset:64512
  ds_read_b64_tr_b16 v[94:95], v2 offset:64768
  v_add_u32 v15, v15, v14
  v_bfe_u32 v14, v0, 4, 1
  v_lshl_add_u32 v15, v14, 11, v15
  s_waitcnt vmcnt(7)
  v_mfma_f32_32x32x16_bf16 v[16:31], v[64:67], v[240:243], v[16:31]
  s_waitcnt lgkmcnt(15)
  v_mfma_f32_32x32x16_bf16 v[32:47], v[240:243], v[68:71], v[32:47]
  s_waitcnt vmcnt(6) lgkmcnt(14)
  v_mfma_f32_32x32x16_bf16 v[16:31], v[72:75], v[244:247], v[16:31]
  s_waitcnt lgkmcnt(12)
  v_mfma_f32_32x32x16_bf16 v[32:47], v[244:247], v[76:79], v[32:47]
  s_waitcnt vmcnt(5) lgkmcnt(6)
  v_mfma_f32_32x32x16_bf16 v[16:31], v[80:83], v[248:251], v[16:31]
  s_waitcnt lgkmcnt(4)
  v_mfma_f32_32x32x16_bf16 v[32:47], v[248:251], v[84:87], v[32:47]
  s_waitcnt vmcnt(4) lgkmcnt(2)
  v_mfma_f32_32x32x16_bf16 v[16:31], v[88:91], v[252:255], v[16:31]
  s_waitcnt lgkmcnt(0)
  v_mfma_f32_32x32x16_bf16 v[32:47], v[252:255], v[92:95], v[32:47]
  v_mfma_f32_32x32x16_bf16 v[16:31], v[116:119], v[112:115], v[16:31]
  v_mfma_f32_32x32x16_bf16 v[32:47], v[112:115], v[120:123], v[32:47]
  s_nop 10
  v_pk_mul_f32 v[16:17], v[16:17], v[12:13] op_sel:[0,1]
  v_pk_mul_f32 v[18:19], v[18:19], v[12:13] op_sel:[0,1]
  v_pk_mul_f32 v[20:21], v[20:21], v[12:13] op_sel:[0,1]
  v_pk_mul_f32 v[22:23], v[22:23], v[12:13] op_sel:[0,1]
  v_pk_mul_f32 v[24:25], v[24:25], v[12:13] op_sel:[0,1]
  v_pk_mul_f32 v[26:27], v[26:27], v[12:13] op_sel:[0,1]
  v_pk_mul_f32 v[28:29], v[28:29], v[12:13] op_sel:[0,1]
  v_pk_mul_f32 v[30:31], v[30:31], v[12:13] op_sel:[0,1]
  v_cvt_pk_bf16_f32 v16, v16, v17
  v_cvt_pk_bf16_f32 v17, v18, v19
  v_cvt_pk_bf16_f32 v18, v20, v21
  v_cvt_pk_bf16_f32 v19, v22, v23
  v_cvt_pk_bf16_f32 v20, v24, v25
  v_cvt_pk_bf16_f32 v21, v26, v27
  v_cvt_pk_bf16_f32 v22, v28, v29
  v_cvt_pk_bf16_f32 v23, v30, v31
  s_lshl_b32 s96, s48, 4
  s_add_u32 s96, s96, s5
  s_lshl_b32 s96, s96, 12
  s_add_u32 s96, s96, 22020096
  buffer_store_dwordx4 v[16:19], v1, s[28:31], s96 offen sc1
  buffer_store_dwordx4 v[20:23], v1, s[28:31], s96 offen offset:2048 sc1
  v_pk_mul_f32 v[32:33], v[32:33], v[96:97]
  v_pk_mul_f32 v[34:35], v[34:35], v[98:99]
  v_pk_mul_f32 v[36:37], v[36:37], v[100:101]
  v_pk_mul_f32 v[38:39], v[38:39], v[102:103]
  v_pk_mul_f32 v[40:41], v[40:41], v[104:105]
  v_pk_mul_f32 v[42:43], v[42:43], v[106:107]
  v_pk_mul_f32 v[44:45], v[44:45], v[108:109]
  v_pk_mul_f32 v[46:47], v[46:47], v[110:111]
  v_cvt_pk_bf16_f32 v32, v32, v33
  v_cvt_pk_bf16_f32 v33, v34, v35
  v_cvt_pk_bf16_f32 v34, v36, v37
  v_cvt_pk_bf16_f32 v35, v38, v39
  v_cvt_pk_bf16_f32 v36, v40, v41
  v_cvt_pk_bf16_f32 v37, v42, v43
  v_cvt_pk_bf16_f32 v38, v44, v45
  v_cvt_pk_bf16_f32 v39, v46, v47
  buffer_store_dwordx4 v[32:35], v15, s[28:31], s96 offen offset:1024 sc1
  buffer_store_dwordx4 v[36:39], v15, s[28:31], s96 offen offset:1536 sc1
  s_waitcnt vmcnt(4)
  s_barrier
  ds_read_b64_tr_b16 v[64:65], v3 offset:0
  ds_read_b64_tr_b16 v[66:67], v3 offset:256
  ds_read_b64_tr_b16 v[68:69], v3 offset:1024
  ds_read_b64_tr_b16 v[70:71], v3 offset:1280
  ds_read_b64_tr_b16 v[72:73], v3 offset:2048
  ds_read_b64_tr_b16 v[74:75], v3 offset:2304
  ds_read_b64_tr_b16 v[76:77], v3 offset:3072
  ds_read_b64_tr_b16 v[78:79], v3 offset:3328
  ds_read_b64_tr_b16 v[80:81], v3 offset:4096
  ds_read_b64_tr_b16 v[82:83], v3 offset:4352
  ds_read_b64_tr_b16 v[84:85], v3 offset:5120
  ds_read_b64_tr_b16 v[86:87], v3 offset:5376
  ds_read_b64_tr_b16 v[88:89], v3 offset:6144
  ds_read_b64_tr_b16 v[90:91], v3 offset:6400
  s_waitcnt lgkmcnt(12)
  v_mfma_f32_32x32x16_bf16 v[48:63], v[64:67], v[128:131], 0
  v_mfma_f32_32x32x16_bf16 v[48:63], v[124:127], v[112:115], v[48:63]
  s_waitcnt lgkmcnt(10)
  ds_read_b64_tr_b16 v[92:93], v3 offset:7168
  ds_read_b64_tr_b16 v[94:95], v3 offset:7424
  v_mfma_f32_32x32x16_bf16 v[48:63], v[68:71], v[132:135], v[48:63]
  s_mul_i32 s97, s6, 4112
  s_add_u32 s97, s97, 131200
  v_add_u32 v14, s97, v1
  v_add_u32 v15, s97, v15
  s_waitcnt lgkmcnt(10)
  v_mfma_f32_32x32x16_bf16 v[48:63], v[72:75], v[136:139], v[48:63]
  s_waitcnt lgkmcnt(7)
  ds_write_b128 v14, v[16:19]
  ds_read_b64_tr_b16 v[64:65], v3 offset:8192
  ds_read_b64_tr_b16 v[66:67], v3 offset:8448
  ds_write_b128 v14, v[20:23] offset:2048
  ds_write_b128 v15, v[32:35] offset:1024
  ds_write_b128 v15, v[36:39] offset:1536
  ds_read_b64_tr_b16 v[68:69], v3 offset:9216
  ds_read_b64_tr_b16 v[70:71], v3 offset:9472
  v_mfma_f32_32x32x16_bf16 v[48:63], v[76:79], v[140:143], v[48:63]
  v_mul_f32 v13, 0x3eb8aa3b, v13
  s_sub_u32 s96, s48, 8
  s_cselect_b32 s96, 0, s96
  s_cselect_b32 s97, 0x200, -1
  s_cselect_b32 s98, 1073741824, 0
  s_lshl_b32 s96, s96, 4
  s_add_u32 s96, s96, s5
  s_lshl_b32 s96, s96, 12
  s_add_u32 s61, s96, 22020096
  s_add_u32 s62, s61, s98
  v_and_b32 v96, s97, v1
  s_sub_u32 s96, s48, 4
  s_cselect_b32 s96, 0, s96
  s_cselect_b32 s97, 0x200, -1
  s_cselect_b32 s98, 1073741824, 0
  s_lshl_b32 s96, s96, 4
  s_add_u32 s96, s96, s5
  s_lshl_b32 s96, s96, 12
  s_add_u32 s63, s96, 22020096
  s_add_u32 s59, s63, s98
  v_and_b32 v97, s97, v1
  s_waitcnt lgkmcnt(14)
  v_mfma_f32_32x32x16_bf16 v[48:63], v[80:83], v[144:147], v[48:63]
  s_waitcnt lgkmcnt(11)
  ds_read_b64_tr_b16 v[72:73], v3 offset:10240
  ds_read_b64_tr_b16 v[74:75], v3 offset:10496
  ds_read_b64_tr_b16 v[76:77], v3 offset:11264
  ds_read_b64_tr_b16 v[78:79], v3 offset:11520
  v_mfma_f32_32x32x16_bf16 v[48:63], v[84:87], v[148:151], v[48:63]
  s_waitcnt lgkmcnt(13)
  ds_read_b64_tr_b16 v[80:81], v3 offset:12288
  ds_read_b64_tr_b16 v[82:83], v3 offset:12544
  v_mfma_f32_32x32x16_bf16 v[48:63], v[88:91], v[152:155], v[48:63]
  s_waitcnt lgkmcnt(13)
  ds_read_b64_tr_b16 v[84:85], v3 offset:13312
  ds_read_b64_tr_b16 v[86:87], v3 offset:13568
  v_mfma_f32_32x32x16_bf16 v[48:63], v[92:95], v[156:159], v[48:63]
  s_waitcnt lgkmcnt(13)
  ds_read_b64_tr_b16 v[88:89], v3 offset:14336
  ds_read_b64_tr_b16 v[90:91], v3 offset:14592
  v_mfma_f32_32x32x16_bf16 v[48:63], v[64:67], v[160:163], v[48:63]
  s_waitcnt lgkmcnt(10)
  ds_read_b64_tr_b16 v[92:93], v3 offset:15360
  ds_read_b64_tr_b16 v[94:95], v3 offset:15616
  v_mfma_f32_32x32x16_bf16 v[48:63], v[68:71], v[164:167], v[48:63]
  s_waitcnt lgkmcnt(10)
  ds_read_b64_tr_b16 v[64:65], v3 offset:16384
  ds_read_b64_tr_b16 v[66:67], v3 offset:16640
  v_mfma_f32_32x32x16_bf16 v[48:63], v[72:75], v[168:171], v[48:63]
  s_waitcnt lgkmcnt(10)
  ds_read_b64_tr_b16 v[68:69], v3 offset:17408
  ds_read_b64_tr_b16 v[70:71], v3 offset:17664
  v_mfma_f32_32x32x16_bf16 v[48:63], v[76:79], v[172:175], v[48:63]
  s_waitcnt lgkmcnt(10)
  ds_read_b64_tr_b16 v[72:73], v3 offset:18432
  ds_read_b64_tr_b16 v[74:75], v3 offset:18688
  v_mfma_f32_32x32x16_bf16 v[48:63], v[80:83], v[176:179], v[48:63]
  s_waitcnt lgkmcnt(10)
  buffer_load_dwordx4 v[128:131], v96, s[28:31], s61 offen offset:0 sc1
  buffer_load_dwordx4 v[132:135], v1, s[28:31], s62 offen offset:1024 sc1
  buffer_load_dwordx4 v[136:139], v96, s[28:31], s61 offen offset:2048 sc1
  buffer_load_dwordx4 v[140:143], v1, s[28:31], s62 offen offset:3072 sc1
  buffer_load_dwordx4 v[144:147], v97, s[28:31], s63 offen offset:0 sc1
  ds_read_b64_tr_b16 v[76:77], v3 offset:19456
  ds_read_b64_tr_b16 v[78:79], v3 offset:19712
  v_mfma_f32_32x32x16_bf16 v[48:63], v[84:87], v[180:183], v[48:63]
  s_waitcnt lgkmcnt(10)
  buffer_load_dwordx4 v[148:151], v1, s[28:31], s59 offen offset:1024 sc1
  buffer_load_dwordx4 v[152:155], v97, s[28:31], s63 offen offset:2048 sc1
  buffer_load_dwordx4 v[156:159], v1, s[28:31], s59 offen offset:3072 sc1
  ds_read_b64_tr_b16 v[80:81], v3 offset:20480
  ds_read_b64_tr_b16 v[82:83], v3 offset:20736
  v_mfma_f32_32x32x16_bf16 v[48:63], v[88:91], v[184:187], v[48:63]
  s_mul_i32 s96, s6, 4112
  s_add_u32 s96, s96, 98304
  v_add_u32 v24, s96, v1
  v_and_b32 v30, 0xf0, v1
  v_lshrrev_b32 v31, 5, v0
  v_lshl_add_u32 v30, v31, 8, v30
  v_add_u32 v30, s96, v30
  v_bfe_i32 v31, v0, 4, 1
  s_waitcnt lgkmcnt(10)
  v_mfma_f32_32x32x16_bf16 v[48:63], v[92:95], v[188:191], v[48:63]
  s_waitcnt lgkmcnt(8)
  ds_read_b64_tr_b16 v[84:85], v3 offset:21504
  ds_read_b64_tr_b16 v[86:87], v3 offset:21760
  ds_read_b64_tr_b16 v[88:89], v3 offset:22528
  ds_read_b64_tr_b16 v[90:91], v3 offset:22784
  v_mfma_f32_32x32x16_bf16 v[48:63], v[64:67], v[192:195], v[48:63]
  s_mul_i32 s96, s6, 4112
  s_add_u32 s96, s96, 98304
  s_add_u32 s97, s96, 3072
  v_bfi_b32 v25, v31, s97, v30
  s_add_u32 s97, s96, 2560
  v_bfi_b32 v26, v31, s97, v30
  s_add_u32 s97, s96, 1024
  v_bfi_b32 v27, v31, s97, v30
  s_add_u32 s97, s96, 512
  v_bfi_b32 v28, v31, s97, v30
  s_waitcnt lgkmcnt(10)
  v_mfma_f32_32x32x16_bf16 v[48:63], v[68:71], v[196:199], v[48:63]
  s_waitcnt lgkmcnt(8)
  ds_read_b64_tr_b16 v[92:93], v3 offset:23552
  ds_read_b64_tr_b16 v[94:95], v3 offset:23808
  ds_read_b64_tr_b16 v[64:65], v3 offset:24576
  ds_read_b64_tr_b16 v[66:67], v3 offset:24832
  v_mfma_f32_32x32x16_bf16 v[48:63], v[72:75], v[200:203], v[48:63]
  s_waitcnt lgkmcnt(10)
  ds_read_b64_tr_b16 v[68:69], v3 offset:25600
  ds_read_b64_tr_b16 v[70:71], v3 offset:25856
  v_mfma_f32_32x32x16_bf16 v[48:63], v[76:79], v[204:207], v[48:63]
  s_waitcnt lgkmcnt(10)
  ds_read_b64_tr_b16 v[72:73], v3 offset:26624
  ds_read_b64_tr_b16 v[74:75], v3 offset:26880
  v_mfma_f32_32x32x16_bf16 v[48:63], v[80:83], v[208:211], v[48:63]
  s_mul_i32 s96, s6, 4112
  s_add_u32 s96, s96, 98304
  v_lshrrev_b32 v30, 2, v0
  v_min_u32 v30, 2, v30
  v_lshlrev_b32 v31, 2, v30
  v_add_u32 v31, s48, v31
  v_cmp_le_u32 vcc, 8, v31
  v_mul_u32_u24 v30, 16448, v30
  v_and_b32 v31, 3, v0
  v_lshl_add_u32 v30, v31, 2, v30
  v_add_u32 v30, s96, v30
  v_mov_b32 v31, 0x3f803f80
  v_cndmask_b32 v31, 0, v31, vcc
  s_waitcnt lgkmcnt(10)
  v_mfma_f32_32x32x16_bf16 v[48:63], v[84:87], v[212:215], v[48:63]
  s_waitcnt lgkmcnt(8)
  ds_write_b32 v30, v31 offset:4096
  ds_read_b64_tr_b16 v[76:77], v3 offset:27648
  ds_read_b64_tr_b16 v[78:79], v3 offset:27904
  ds_read_b64_tr_b16 v[80:81], v3 offset:28672
  ds_read_b64_tr_b16 v[82:83], v3 offset:28928
  v_mfma_f32_32x32x16_bf16 v[48:63], v[88:91], v[216:219], v[48:63]
  s_waitcnt lgkmcnt(11)
  ds_read_b64_tr_b16 v[84:85], v3 offset:29696
  ds_read_b64_tr_b16 v[86:87], v3 offset:29952
  v_mfma_f32_32x32x16_bf16 v[48:63], v[92:95], v[220:223], v[48:63]
  s_waitcnt lgkmcnt(11)
  ds_read_b64_tr_b16 v[88:89], v3 offset:30720
  ds_read_b64_tr_b16 v[90:91], v3 offset:30976
  v_mfma_f32_32x32x16_bf16 v[48:63], v[64:67], v[224:227], v[48:63]
  s_waitcnt lgkmcnt(11)
  ds_read_b64_tr_b16 v[92:93], v3 offset:31744
  ds_read_b64_tr_b16 v[94:95], v3 offset:32000
  v_accvgpr_read_b32 v32, a240
  v_mfma_f32_32x32x16_bf16 v[48:63], v[68:71], v[228:231], v[48:63]
  s_waitcnt lgkmcnt(11)
  v_accvgpr_read_b32 v33, a241
  v_accvgpr_read_b32 v34, a242
  v_accvgpr_read_b32 v35, a243
  v_mfma_f32_32x32x16_bf16 v[48:63], v[72:75], v[232:235], v[48:63]
  s_waitcnt lgkmcnt(8)
  ds_read_b128 v[192:195], v24 offset:32896
  v_accvgpr_read_b32 v36, a244
  v_accvgpr_read_b32 v37, a245
  v_accvgpr_read_b32 v38, a246
  v_accvgpr_read_b32 v39, a247
  v_mfma_f32_32x32x16_bf16 v[48:63], v[76:79], v[236:239], v[48:63]
  s_waitcnt lgkmcnt(7)
  ds_read_b128 v[196:199], v24 offset:34944
  ds_read_b128 v[112:115], v25 offset:33920
  ds_read_b128 v[116:119], v26 offset:34432
  ds_read_b128 v[200:203], v27 offset:35968
  ds_read_b128 v[204:207], v28 offset:36480
  v_mfma_f32_32x32x16_bf16 v[48:63], v[80:83], v[240:243], v[48:63]
  s_waitcnt lgkmcnt(10)
  v_mfma_f32_32x32x16_bf16 v[48:63], v[84:87], v[244:247], v[48:63]
  s_waitcnt lgkmcnt(8)
  v_mfma_f32_32x32x16_bf16 v[48:63], v[88:91], v[248:251], v[48:63]
  s_waitcnt lgkmcnt(6)
  v_mfma_f32_32x32x16_bf16 v[48:63], v[92:95], v[252:255], v[48:63]
  s_waitcnt lgkmcnt(5)
  s_nop 10
  v_pk_mul_f32 v[48:49], v[48:49], v[12:13] op_sel:[0,1]
  v_pk_mul_f32 v[50:51], v[50:51], v[12:13] op_sel:[0,1]
  v_pk_mul_f32 v[52:53], v[52:53], v[12:13] op_sel:[0,1]
  v_pk_mul_f32 v[54:55], v[54:55], v[12:13] op_sel:[0,1]
  v_cvt_pk_bf16_f32 v16, v48, v49
  v_cvt_pk_bf16_f32 v17, v50, v51
  v_cvt_pk_bf16_f32 v18, v52, v53
  v_cvt_pk_bf16_f32 v19, v54, v55
  s_nop 1
  v_mfma_f32_32x32x16_bf16 v[160:175], v[192:195], v[16:19], 0
  s_waitcnt lgkmcnt(4)
  v_pk_mul_f32 v[56:57], v[56:57], v[12:13] op_sel:[0,1]
  v_pk_mul_f32 v[58:59], v[58:59], v[12:13] op_sel:[0,1]
  v_pk_mul_f32 v[60:61], v[60:61], v[12:13] op_sel:[0,1]
  v_pk_mul_f32 v[62:63], v[62:63], v[12:13] op_sel:[0,1]
  v_cvt_pk_bf16_f32 v20, v56, v57
  v_cvt_pk_bf16_f32 v21, v58, v59
  v_cvt_pk_bf16_f32 v22, v60, v61
  v_cvt_pk_bf16_f32 v23, v62, v63
  s_nop 1
  v_mfma_f32_32x32x16_bf16 v[176:191], v[196:199], v[20:23], 0
  s_lshl_b32 s54, s48, 4
  s_add_u32 s54, s54, s5
  s_lshl_b32 s54, s54, 11
  s_add_u32 s54, s54, 26214400
  s_mov_b32 s7, 20000
L103:
  s_waitcnt vmcnt(7)
  v_mfma_f32_32x32x16_bf16 v[64:79], v[128:131], v[16:19], 0
  ds_write_b128 v24, v[128:131] offset:0
  s_waitcnt vmcnt(6)
  ds_write_b128 v24, v[132:135] offset:1024
  v_max3_u32 v14, v128, v129, v130
  v_max_u32 v14, v14, v131
  v_max3_u32 v14, v14, v132, v133
  v_max3_u32 v14, v14, v134, v135
  s_waitcnt vmcnt(5)
  v_mfma_f32_32x32x16_bf16 v[80:95], v[136:139], v[20:23], 0
  ds_write_b128 v24, v[136:139] offset:2048
  s_waitcnt vmcnt(4)
  ds_write_b128 v24, v[140:143] offset:3072
  ds_read_b128 v[120:123], v25 offset:1024
  ds_read_b128 v[124:127], v26 offset:1536
  ds_read_b128 v[208:211], v27 offset:3072
  ds_read_b128 v[212:215], v28 offset:3584
  s_waitcnt vmcnt(3)
  ds_write_b128 v24, v[144:147] offset:16448
  s_waitcnt vmcnt(2)
  ds_write_b128 v24, v[148:151] offset:17472
  s_waitcnt vmcnt(1)
  ds_write_b128 v24, v[152:155] offset:18496
  s_waitcnt vmcnt(0)
  ds_write_b128 v24, v[156:159] offset:19520
  v_max3_u32 v14, v14, v136, v137
  v_max3_u32 v14, v14, v138, v139
  v_max3_u32 v14, v14, v140, v141
  v_max3_u32 v14, v14, v142, v143
  v_max3_u32 v14, v14, v144, v145
  v_max3_u32 v14, v14, v146, v147
  v_max3_u32 v14, v14, v148, v149
  v_max3_u32 v14, v14, v150, v151
  v_max3_u32 v14, v14, v152, v153
  v_max3_u32 v14, v14, v154, v155
  v_max3_u32 v14, v14, v156, v157
  v_max3_u32 v14, v14, v158, v159
  v_cmp_eq_u32 vcc, -1, v14
  s_cbranch_vccnz L105
L104:
  v_mfma_f32_32x32x16_bf16 v[96:111], v[144:147], v[16:19], 0
  v_cndmask_b32_e64 v64, v64, v160, s[64:65]
  v_cndmask_b32_e64 v65, v65, v161, s[66:67]
  v_cndmask_b32_e64 v66, v66, v162, s[68:69]
  v_cndmask_b32_e64 v67, v67, v163, s[70:71]
  v_cndmask_b32_e64 v68, v68, v164, s[72:73]
  v_cndmask_b32_e64 v69, v69, v165, s[74:75]
  v_cndmask_b32_e64 v70, v70, v166, s[76:77]
  v_cndmask_b32_e64 v71, v71, v167, s[78:79]
  v_cndmask_b32_e64 v72, v72, v168, s[80:81]
  v_cndmask_b32_e64 v73, v73, v169, s[82:83]
  v_cndmask_b32_e64 v74, v74, v170, s[84:85]
  v_cndmask_b32_e64 v75, v75, v171, s[86:87]
  v_cndmask_b32_e64 v76, v76, v172, s[88:89]
  v_cndmask_b32_e64 v77, v77, v173, s[90:91]
  v_cndmask_b32_e64 v78, v78, v174, s[92:93]
  v_cndmask_b32_e64 v79, v79, v175, s[94:95]
  v_exp_f32 v64, v64
  v_exp_f32 v65, v65
  v_exp_f32 v66, v66
  v_exp_f32 v67, v67
  v_exp_f32 v68, v68
  v_exp_f32 v69, v69
  v_exp_f32 v70, v70
  v_exp_f32 v71, v71
  v_exp_f32 v72, v72
  v_exp_f32 v73, v73
  v_exp_f32 v74, v74
  v_exp_f32 v75, v75
  v_exp_f32 v76, v76
  v_exp_f32 v77, v77
  v_exp_f32 v78, v78
  v_exp_f32 v79, v79
  v_cvt_pk_bf16_f32 v64, v64, v65
  v_cvt_pk_bf16_f32 v65, v66, v67
  v_cvt_pk_bf16_f32 v66, v68, v69
  v_cvt_pk_bf16_f32 v67, v70, v71
  v_cvt_pk_bf16_f32 v68, v72, v73
  v_cvt_pk_bf16_f32 v69, v74, v75
  v_cvt_pk_bf16_f32 v70, v76, v77
  v_cvt_pk_bf16_f32 v71, v78, v79
  v_and_b32 v72, v64, v32
  v_xor_b32 v64, v64, v72
  v_and_b32 v73, v65, v33
  v_xor_b32 v65, v65, v73
  v_and_b32 v74, v66, v34
  v_xor_b32 v66, v66, v74
  v_and_b32 v75, v67, v35
  v_xor_b32 v67, v67, v75
  v_and_b32 v76, v68, v36
  v_xor_b32 v68, v68, v76
  v_and_b32 v77, v69, v37
  v_xor_b32 v69, v69, v77
  v_and_b32 v78, v70, v38
  v_xor_b32 v70, v70, v78
  v_and_b32 v79, v71, v39
  v_xor_b32 v71, v71, v79
  s_waitcnt lgkmcnt(0)
  s_barrier
  v_mfma_f32_32x32x16_bf16 v[224:239], v[112:115], v[72:75], 0
  s_and_b32 s61, s6, 1
  s_lshl_b32 s61, s61, 18
  s_lshr_b32 s62, s6, 1
  s_xor_b32 s62, s62, s0
  s_and_b32 s62, s62, 1
  s_lshl_b32 s62, s62, 17
  s_add_u32 s61, s61, s62
  s_and_b32 s62, s50, 14
  s_lshl_b32 s62, s62, 6
  s_add_u32 s61, s61, s62
  s_lshl_b32 s62, s6, 14
  s_add_u32 m0, s62, 0
  s_add_u32 s60, s61, 0
  buffer_load_dwordx4 v12, s[16:19], s60 offen offset:0 lds
  v_cndmask_b32_e64 v80, v80, v176, s[64:65]
  v_cndmask_b32_e64 v81, v81, v177, s[66:67]
  v_cndmask_b32_e64 v82, v82, v178, s[68:69]
  v_cndmask_b32_e64 v83, v83, v179, s[70:71]
  v_cndmask_b32_e64 v84, v84, v180, s[72:73]
  v_cndmask_b32_e64 v85, v85, v181, s[74:75]
  v_cndmask_b32_e64 v86, v86, v182, s[76:77]
  v_mfma_f32_32x32x16_bf16 v[224:239], v[116:119], v[76:79], v[224:239]
  v_cndmask_b32_e64 v87, v87, v183, s[78:79]
  v_cndmask_b32_e64 v88, v88, v184, s[80:81]
  v_cndmask_b32_e64 v89, v89, v185, s[82:83]
  v_cndmask_b32_e64 v90, v90, v186, s[84:85]
  v_cndmask_b32_e64 v91, v91, v187, s[86:87]
  v_cndmask_b32_e64 v92, v92, v188, s[88:89]
  v_cndmask_b32_e64 v93, v93, v189, s[90:91]
  v_mfma_f32_32x32x16_bf16 v[224:239], v[120:123], v[64:67], v[224:239]
  ds_read_b128 v[216:219], v25 offset:17472
  s_add_u32 s60, s61, 7168
  buffer_load_dwordx4 v12, s[16:19], s60 offen offset:1024 lds
  v_cndmask_b32_e64 v94, v94, v190, s[92:93]
  v_cndmask_b32_e64 v95, v95, v191, s[94:95]
  v_exp_f32 v80, v80
  v_exp_f32 v81, v81
  v_mfma_f32_32x32x16_bf16 v[224:239], v[124:127], v[68:71], v[224:239]
  ds_read_b128 v[220:223], v26 offset:17984
  v_exp_f32 v82, v82
  v_exp_f32 v83, v83
  v_exp_f32 v84, v84
  v_mfma_f32_32x32x16_bf16 v[64:79], v[152:155], v[20:23], 0
  ds_read_b128 v[40:43], v24 offset:4112
  s_add_u32 s60, s61, 14336
  buffer_load_dwordx4 v12, s[16:19], s60 offen offset:2048 lds
  s_add_u32 s60, s61, 21504
  buffer_load_dwordx4 v12, s[16:19], s60 offen offset:3072 lds
  v_exp_f32 v85, v85
  v_exp_f32 v86, v86
  v_exp_f32 v87, v87
  v_exp_f32 v88, v88
  v_exp_f32 v89, v89
  v_exp_f32 v90, v90
  v_exp_f32 v91, v91
  v_exp_f32 v92, v92
  v_exp_f32 v93, v93
  v_exp_f32 v94, v94
  v_exp_f32 v95, v95
  v_cvt_pk_bf16_f32 v80, v80, v81
  v_cvt_pk_bf16_f32 v81, v82, v83
  v_cvt_pk_bf16_f32 v82, v84, v85
  v_cvt_pk_bf16_f32 v83, v86, v87
  v_cvt_pk_bf16_f32 v84, v88, v89
  s_lshl_b32 s96, s4, 4
  s_add_u32 s96, s96, s5
  s_lshl_b32 s96, s96, 2
  s_add_u32 s96, s96, s6
  s_lshl_b32 s96, s96, 9
  s_add_u32 s96, s96, 20971520
  v_and_b32 v60, 0x180, v1
  buffer_load_dword v60, v60, s[28:31], s96 offen sc1
  v_cvt_pk_bf16_f32 v85, v90, v91
  v_cvt_pk_bf16_f32 v86, v92, v93
  v_cvt_pk_bf16_f32 v87, v94, v95
  v_and_b32 v88, v80, v32
  v_xor_b32 v80, v80, v88
  v_and_b32 v89, v81, v33
  v_xor_b32 v81, v81, v89
  v_and_b32 v90, v82, v34
  v_xor_b32 v82, v82, v90
  v_and_b32 v91, v83, v35
  v_xor_b32 v83, v83, v91
  v_and_b32 v92, v84, v36
  v_xor_b32 v84, v84, v92
  s_add_u32 m0, s62, 4096
  s_add_u32 s60, s61, 32768
  buffer_load_dwordx4 v12, s[16:19], s60 offen offset:0 lds
  v_and_b32 v93, v85, v37
  v_xor_b32 v85, v85, v93
  v_and_b32 v94, v86, v38
  v_xor_b32 v86, v86, v94
  v_and_b32 v95, v87, v39
  v_xor_b32 v87, v87, v95
  v_mfma_f32_32x32x16_bf16 v[240:255], v[200:203], v[88:91], 0
  v_exp_f32 v96, v96
  v_exp_f32 v97, v97
  v_exp_f32 v98, v98
  v_exp_f32 v99, v99
  v_mfma_f32_32x32x16_bf16 v[240:255], v[204:207], v[92:95], v[240:255]
  s_add_u32 s60, s61, 39936
  buffer_load_dwordx4 v12, s[16:19], s60 offen offset:1024 lds
  v_exp_f32 v100, v100
  v_exp_f32 v101, v101
  v_exp_f32 v102, v102
  v_exp_f32 v103, v103
  s_lshr_b32 s96, s2, 3
  s_lshl_b32 s96, s96, 2
  s_add_u32 s96, s96, s6
  s_lshl_b32 s96, s96, 8
  v_and_b32 v61, 0x80, v1
  v_add_u32 v61, s96, v61
  v_add_u32 v61, L_p3_1-L106, v61
  v_min_u32 v61, L_ce-L106, v61
  s_getpc_b64 s[96:97]
L106:
  global_load_dword v61, v61, s[96:97]
  v_mfma_f32_32x32x16_bf16 v[240:255], v[208:211], v[80:83], v[240:255]
  ds_read_b128 v[112:115], v27 offset:19520
  v_exp_f32 v104, v104
  v_exp_f32 v105, v105
  v_exp_f32 v106, v106
  v_mfma_f32_32x32x16_bf16 v[240:255], v[212:215], v[84:87], v[240:255]
  ds_read_b128 v[116:119], v28 offset:20032
  s_add_u32 s60, s61, 47104
  buffer_load_dwordx4 v12, s[16:19], s60 offen offset:2048 lds
  v_exp_f32 v107, v107
  v_exp_f32 v108, v108
  v_exp_f32 v109, v109
  s_waitcnt lgkmcnt(2)
  v_mfma_f32_32x32x16_bf16 v[80:95], v[40:43], v[16:19], 0
  ds_read_b128 v[44:47], v24 offset:8224
  s_add_u32 s60, s61, 54272
  buffer_load_dwordx4 v12, s[16:19], s60 offen offset:3072 lds
  v_exp_f32 v110, v110
  v_exp_f32 v111, v111
  v_cvt_pk_bf16_f32 v96, v96, v97
  v_cvt_pk_bf16_f32 v97, v98, v99
  v_cvt_pk_bf16_f32 v98, v100, v101
  v_cvt_pk_bf16_f32 v99, v102, v103
  v_cvt_pk_bf16_f32 v100, v104, v105
  v_cvt_pk_bf16_f32 v101, v106, v107
  v_cvt_pk_bf16_f32 v102, v108, v109
  v_cvt_pk_bf16_f32 v103, v110, v111
  v_mfma_f32_32x32x16_bf16 v[224:239], v[216:219], v[96:99], v[224:239]
  ds_read_b128 v[120:123], v25 offset:5136
  v_exp_f32 v64, v64
  v_exp_f32 v65, v65
  v_exp_f32 v66, v66
  v_mfma_f32_32x32x16_bf16 v[224:239], v[220:223], v[100:103], v[224:239]
  ds_read_b128 v[124:127], v26 offset:5648
  v_exp_f32 v67, v67
  v_exp_f32 v68, v68
  v_exp_f32 v69, v69
  s_waitcnt lgkmcnt(2)
  v_mfma_f32_32x32x16_bf16 v[96:111], v[44:47], v[16:19], 0
  ds_read_b128 v[48:51], v24 offset:12336
  s_add_u32 m0, s62, 8192
  s_add_u32 s60, s61, 65536
  buffer_load_dwordx4 v12, s[16:19], s60 offen offset:0 lds
  s_add_u32 s60, s61, 72704
  buffer_load_dwordx4 v12, s[16:19], s60 offen offset:1024 lds
  v_exp_f32 v70, v70
  v_exp_f32 v71, v71
  v_exp_f32 v72, v72
  v_exp_f32 v73, v73
  v_exp_f32 v74, v74
  v_exp_f32 v75, v75
  v_exp_f32 v76, v76
  v_exp_f32 v77, v77
  v_exp_f32 v78, v78
  v_exp_f32 v79, v79
  v_cvt_pk_bf16_f32 v64, v64, v65
  v_cvt_pk_bf16_f32 v65, v66, v67
  v_cvt_pk_bf16_f32 v66, v68, v69
  v_cvt_pk_bf16_f32 v67, v70, v71
  v_cvt_pk_bf16_f32 v68, v72, v73
  v_cvt_pk_bf16_f32 v69, v74, v75
  v_cvt_pk_bf16_f32 v70, v76, v77
  v_cvt_pk_bf16_f32 v71, v78, v79
  v_mfma_f32_32x32x16_bf16 v[240:255], v[112:115], v[64:67], v[240:255]
  ds_read_b128 v[200:203], v25 offset:9248
  v_exp_f32 v80, v80
  v_exp_f32 v81, v81
  v_exp_f32 v82, v82
  v_mfma_f32_32x32x16_bf16 v[240:255], v[116:119], v[68:71], v[240:255]
  ds_read_b128 v[204:207], v26 offset:9760
  s_add_u32 s60, s61, 79872
  buffer_load_dwordx4 v12, s[16:19], s60 offen offset:2048 lds
  v_exp_f32 v83, v83
  v_exp_f32 v84, v84
  v_exp_f32 v85, v85
  s_waitcnt lgkmcnt(2)
  v_mfma_f32_32x32x16_bf16 v[64:79], v[48:51], v[16:19], 0
  ds_read_b128 v[52:55], v24 offset:20560
  s_add_u32 s60, s61, 87040
  buffer_load_dwordx4 v12, s[16:19], s60 offen offset:3072 lds
  v_exp_f32 v86, v86
  v_exp_f32 v87, v87
  v_exp_f32 v88, v88
  v_exp_f32 v89, v89
  v_exp_f32 v90, v90
  v_exp_f32 v91, v91
  v_exp_f32 v92, v92
  v_exp_f32 v93, v93
  v_exp_f32 v94, v94
  v_exp_f32 v95, v95
  v_cvt_pk_bf16_f32 v80, v80, v81
  v_cvt_pk_bf16_f32 v81, v82, v83
  v_cvt_pk_bf16_f32 v82, v84, v85
  v_cvt_pk_bf16_f32 v83, v86, v87
  v_cvt_pk_bf16_f32 v84, v88, v89
  v_cvt_pk_bf16_f32 v85, v90, v91
  v_cvt_pk_bf16_f32 v86, v92, v93
  v_cvt_pk_bf16_f32 v87, v94, v95
  s_add_u32 m0, s62, 12288
  s_add_u32 s60, s61, 98304
  buffer_load_dwordx4 v12, s[16:19], s60 offen offset:0 lds
  v_mfma_f32_32x32x16_bf16 v[224:239], v[120:123], v[80:83], v[224:239]
  ds_read_b128 v[208:211], v25 offset:13360
  v_exp_f32 v96, v96
  v_exp_f32 v97, v97
  v_exp_f32 v98, v98
  v_mfma_f32_32x32x16_bf16 v[224:239], v[124:127], v[84:87], v[224:239]
  ds_read_b128 v[212:215], v26 offset:13872
  v_exp_f32 v99, v99
  v_exp_f32 v100, v100
  v_exp_f32 v101, v101
  s_waitcnt lgkmcnt(2)
  v_mfma_f32_32x32x16_bf16 v[80:95], v[52:55], v[16:19], 0
  ds_read_b128 v[40:43], v24 offset:24672
  s_add_u32 s60, s61, 105472
  buffer_load_dwordx4 v12, s[16:19], s60 offen offset:1024 lds
  s_add_u32 s60, s61, 112640
  buffer_load_dwordx4 v12, s[16:19], s60 offen offset:2048 lds
  v_exp_f32 v102, v102
  v_exp_f32 v103, v103
  v_exp_f32 v104, v104
  v_exp_f32 v105, v105
  v_exp_f32 v106, v106
  v_exp_f32 v107, v107
  v_exp_f32 v108, v108
  v_exp_f32 v109, v109
  v_exp_f32 v110, v110
  v_exp_f32 v111, v111
  v_cvt_pk_bf16_f32 v96, v96, v97
  v_cvt_pk_bf16_f32 v97, v98, v99
  v_cvt_pk_bf16_f32 v98, v100, v101
  v_cvt_pk_bf16_f32 v99, v102, v103
  v_cvt_pk_bf16_f32 v100, v104, v105
  v_cvt_pk_bf16_f32 v101, v106, v107
  v_cvt_pk_bf16_f32 v102, v108, v109
  v_cvt_pk_bf16_f32 v103, v110, v111
  v_mfma_f32_32x32x16_bf16 v[224:239], v[200:203], v[96:99], v[224:239]
  ds_read_b128 v[216:219], v25 offset:21584
  v_exp_f32 v64, v64
  v_exp_f32 v65, v65
  v_exp_f32 v66, v66
  v_mfma_f32_32x32x16_bf16 v[224:239], v[204:207], v[100:103], v[224:239]
  ds_read_b128 v[220:223], v26 offset:22096
  s_add_u32 s60, s61, 119808
  buffer_load_dwordx4 v12, s[16:19], s60 offen offset:3072 lds
  v_exp_f32 v67, v67
  v_exp_f32 v68, v68
  v_exp_f32 v69, v69
  s_waitcnt lgkmcnt(2)
  v_mfma_f32_32x32x16_bf16 v[96:111], v[40:43], v[16:19], 0
  ds_read_b128 v[44:47], v24 offset:28784
  v_exp_f32 v70, v70
  v_exp_f32 v71, v71
  v_exp_f32 v72, v72
  v_exp_f32 v73, v73
  v_exp_f32 v74, v74
  s_lshl_b32 s61, s0, 1
  s_xor_b32 s61, s61, s6
  s_mul_i32 s61, s61, 229376
  s_lshl_b32 s62, s5, 8
  s_add_u32 s61, s61, s62
  s_cmp_ge_u32 s5, 14
  s_cselect_b32 s61, 1073741824, s61
  s_lshl_b32 s62, s6, 13
  s_add_u32 m0, s62, 65536
  s_add_u32 s60, s61, 128
  buffer_load_dwordx4 v11, s[20:23], s60 offen offset:0 lds
  v_exp_f32 v75, v75
  v_exp_f32 v76, v76
  v_exp_f32 v77, v77
  v_exp_f32 v78, v78
  v_exp_f32 v79, v79
  v_cvt_pk_bf16_f32 v64, v64, v65
  v_cvt_pk_bf16_f32 v65, v66, v67
  v_cvt_pk_bf16_f32 v66, v68, v69
  v_cvt_pk_bf16_f32 v67, v70, v71
  v_cvt_pk_bf16_f32 v68, v72, v73
  v_cvt_pk_bf16_f32 v69, v74, v75
  v_cvt_pk_bf16_f32 v70, v76, v77
  v_cvt_pk_bf16_f32 v71, v78, v79
  v_mfma_f32_32x32x16_bf16 v[224:239], v[208:211], v[64:67], v[224:239]
  ds_read_b128 v[112:115], v25 offset:25696
  s_add_u32 s60, s61, 27776
  buffer_load_dwordx4 v11, s[20:23], s60 offen offset:1024 lds
  v_exp_f32 v80, v80
  v_exp_f32 v81, v81
  v_exp_f32 v82, v82
  v_mfma_f32_32x32x16_bf16 v[224:239], v[212:215], v[68:71], v[224:239]
  ds_read_b128 v[116:119], v26 offset:26208
  v_exp_f32 v83, v83
  v_exp_f32 v84, v84
  v_exp_f32 v85, v85
  s_waitcnt lgkmcnt(2)
  v_mfma_f32_32x32x16_bf16 v[64:79], v[44:47], v[16:19], 0
  ds_read_b128 v[48:51], v24 offset:6160
  s_add_u32 s60, s61, 55424
  buffer_load_dwordx4 v11, s[20:23], s60 offen offset:2048 lds
  s_add_u32 s60, s61, 83072
  buffer_load_dwordx4 v11, s[20:23], s60 offen offset:3072 lds
  v_exp_f32 v86, v86
  v_exp_f32 v87, v87
  v_exp_f32 v88, v88
  v_exp_f32 v89, v89
  v_exp_f32 v90, v90
  v_exp_f32 v91, v91
  v_exp_f32 v92, v92
  v_exp_f32 v93, v93
  v_exp_f32 v94, v94
  v_exp_f32 v95, v95
  v_cvt_pk_bf16_f32 v80, v80, v81
  v_cvt_pk_bf16_f32 v81, v82, v83
  v_cvt_pk_bf16_f32 v82, v84, v85
  v_cvt_pk_bf16_f32 v83, v86, v87
  v_cvt_pk_bf16_f32 v84, v88, v89
  v_cvt_pk_bf16_f32 v85, v90, v91
  v_cvt_pk_bf16_f32 v86, v92, v93
  v_cvt_pk_bf16_f32 v87, v94, v95
  v_mfma_f32_32x32x16_bf16 v[224:239], v[216:219], v[80:83], v[224:239]
  ds_read_b128 v[120:123], v25 offset:29808
  v_exp_f32 v96, v96
  v_exp_f32 v97, v97
  v_exp_f32 v98, v98
  v_mfma_f32_32x32x16_bf16 v[224:239], v[220:223], v[84:87], v[224:239]
  ds_read_b128 v[124:127], v26 offset:30320
  s_add_u32 m0, s62, 69632
  s_add_u32 s60, s61, 114816
  buffer_load_dwordx4 v11, s[20:23], s60 offen offset:0 lds
  v_exp_f32 v99, v99
  v_exp_f32 v100, v100
  v_exp_f32 v101, v101
  s_waitcnt lgkmcnt(2)
  v_mfma_f32_32x32x16_bf16 v[80:95], v[48:51], v[20:23], 0
  ds_read_b128 v[52:55], v24 offset:10272
  s_add_u32 s60, s61, 142464
  buffer_load_dwordx4 v11, s[20:23], s60 offen offset:1024 lds
  v_exp_f32 v102, v102
  v_exp_f32 v103, v103
  v_exp_f32 v104, v104
  v_exp_f32 v105, v105
  v_exp_f32 v106, v106
  v_exp_f32 v107, v107
  v_exp_f32 v108, v108
  v_exp_f32 v109, v109
  v_exp_f32 v110, v110
  v_exp_f32 v111, v111
  v_cvt_pk_bf16_f32 v96, v96, v97
  v_cvt_pk_bf16_f32 v97, v98, v99
  v_cvt_pk_bf16_f32 v98, v100, v101
  v_cvt_pk_bf16_f32 v99, v102, v103
  v_cvt_pk_bf16_f32 v100, v104, v105
  v_cvt_pk_bf16_f32 v101, v106, v107
  v_cvt_pk_bf16_f32 v102, v108, v109
  v_cvt_pk_bf16_f32 v103, v110, v111
  v_mfma_f32_32x32x16_bf16 v[224:239], v[112:115], v[96:99], v[224:239]
  ds_read_b128 v[200:203], v27 offset:7184
  s_add_u32 s60, s61, 170112
  buffer_load_dwordx4 v11, s[20:23], s60 offen offset:2048 lds
  v_exp_f32 v64, v64
  v_exp_f32 v65, v65
  v_exp_f32 v66, v66
  v_mfma_f32_32x32x16_bf16 v[224:239], v[116:119], v[100:103], v[224:239]
  ds_read_b128 v[204:207], v28 offset:7696
  v_exp_f32 v67, v67
  v_exp_f32 v68, v68
  v_exp_f32 v69, v69
  s_waitcnt lgkmcnt(2)
  v_mfma_f32_32x32x16_bf16 v[96:111], v[52:55], v[20:23], 0
  ds_read_b128 v[40:43], v24 offset:14384
  s_add_u32 s60, s61, 197760
  buffer_load_dwordx4 v11, s[20:23], s60 offen offset:3072 lds
  v_exp_f32 v70, v70
  v_exp_f32 v71, v71
  v_exp_f32 v72, v72
  v_exp_f32 v73, v73
  v_exp_f32 v74, v74
  v_exp_f32 v75, v75
  v_exp_f32 v76, v76
  v_exp_f32 v77, v77
  v_exp_f32 v78, v78
  v_exp_f32 v79, v79
  v_cvt_pk_bf16_f32 v64, v64, v65
  v_cvt_pk_bf16_f32 v65, v66, v67
  v_cvt_pk_bf16_f32 v66, v68, v69
  v_cvt_pk_bf16_f32 v67, v70, v71
  v_cvt_pk_bf16_f32 v68, v72, v73
  v_cvt_pk_bf16_f32 v69, v74, v75
  v_cvt_pk_bf16_f32 v70, v76, v77
  v_cvt_pk_bf16_f32 v71, v78, v79
  v_mfma_f32_32x32x16_bf16 v[224:239], v[120:123], v[64:67], v[224:239]
  ds_read_b128 v[208:211], v27 offset:11296
  v_exp_f32 v80, v80
  v_exp_f32 v81, v81
  v_exp_f32 v82, v82
  v_mfma_f32_32x32x16_bf16 v[224:239], v[124:127], v[68:71], v[224:239]
  ds_read_b128 v[212:215], v28 offset:11808
  v_exp_f32 v83, v83
  v_exp_f32 v84, v84
  v_exp_f32 v85, v85
  s_waitcnt lgkmcnt(2)
  v_mfma_f32_32x32x16_bf16 v[64:79], v[40:43], v[20:23], 0
  ds_read_b128 v[44:47], v24 offset:22608
  v_exp_f32 v86, v86
  v_exp_f32 v87, v87
  v_exp_f32 v88, v88
  v_exp_f32 v89, v89
  v_exp_f32 v90, v90
  v_exp_f32 v91, v91
  v_exp_f32 v92, v92
  v_exp_f32 v93, v93
  v_exp_f32 v94, v94
  v_exp_f32 v95, v95
  v_cvt_pk_bf16_f32 v80, v80, v81
  v_cvt_pk_bf16_f32 v81, v82, v83
  v_cvt_pk_bf16_f32 v82, v84, v85
  v_cvt_pk_bf16_f32 v83, v86, v87
  v_cvt_pk_bf16_f32 v84, v88, v89
  v_cvt_pk_bf16_f32 v85, v90, v91
  v_cvt_pk_bf16_f32 v86, v92, v93
  v_cvt_pk_bf16_f32 v87, v94, v95
  v_mfma_f32_32x32x16_bf16 v[240:255], v[200:203], v[80:83], v[240:255]
  ds_read_b128 v[216:219], v27 offset:15408
  v_exp_f32 v96, v96
  v_exp_f32 v97, v97
  v_exp_f32 v98, v98
  v_mfma_f32_32x32x16_bf16 v[240:255], v[204:207], v[84:87], v[240:255]
  ds_read_b128 v[220:223], v28 offset:15920
  v_exp_f32 v99, v99
  v_exp_f32 v100, v100
  v_exp_f32 v101, v101
  s_waitcnt lgkmcnt(2)
  v_mfma_f32_32x32x16_bf16 v[80:95], v[44:47], v[20:23], 0
  ds_read_b128 v[48:51], v24 offset:26720
  v_exp_f32 v102, v102
  v_exp_f32 v103, v103
  v_exp_f32 v104, v104
  v_exp_f32 v105, v105
  v_exp_f32 v106, v106
  v_exp_f32 v107, v107
  v_exp_f32 v108, v108
  v_rcp_f32 v31, v232
  v_exp_f32 v109, v109
  v_add_u32 v29, 0xe0800000, v232
  v_exp_f32 v110, v110
  v_mul_f32 v224, v224, v31
  v_exp_f32 v111, v111
  v_mul_f32 v225, v225, v31
  v_cvt_pk_bf16_f32 v96, v96, v97
  v_mul_f32 v226, v226, v31
  v_cvt_pk_bf16_f32 v97, v98, v99
  v_mul_f32 v227, v227, v31
  v_cvt_pk_bf16_f32 v98, v100, v101
  v_mul_f32 v228, v228, v31
  v_cvt_pk_bf16_f32 v99, v102, v103
  v_mul_f32 v229, v229, v31
  v_cvt_pk_bf16_f32 v100, v104, v105
  v_mul_f32 v230, v230, v31
  v_cvt_pk_bf16_f32 v101, v106, v107
  v_mul_f32 v231, v231, v31
  v_cvt_pk_bf16_f32 v102, v108, v109
  v_cvt_pk_bf16_f32 v232, v224, v225
  v_cvt_pk_bf16_f32 v103, v110, v111
  v_cvt_pk_bf16_f32 v233, v226, v227
  v_cvt_pk_bf16_f32 v234, v228, v229
  v_cvt_pk_bf16_f32 v235, v230, v231
  v_mfma_f32_32x32x16_bf16 v[240:255], v[208:211], v[96:99], v[240:255]
  buffer_store_dwordx4 v[232:235], v1, s[28:31], s54 offen offset:0 sc1
  ds_read_b128 v[112:115], v27 offset:23632
  v_exp_f32 v64, v64
  v_exp_f32 v65, v65
  v_exp_f32 v66, v66
  v_mfma_f32_32x32x16_bf16 v[240:255], v[212:215], v[100:103], v[240:255]
  ds_read_b128 v[116:119], v28 offset:24144
  v_exp_f32 v67, v67
  v_exp_f32 v68, v68
  v_exp_f32 v69, v69
  s_waitcnt lgkmcnt(2)
  v_mfma_f32_32x32x16_bf16 v[96:111], v[48:51], v[20:23], 0
  ds_read_b128 v[52:55], v24 offset:30832
  v_exp_f32 v70, v70
  v_exp_f32 v71, v71
  v_exp_f32 v72, v72
  v_exp_f32 v73, v73
  v_exp_f32 v74, v74
  v_exp_f32 v75, v75
  v_exp_f32 v76, v76
  v_exp_f32 v77, v77
  v_exp_f32 v78, v78
  v_exp_f32 v79, v79
  v_cvt_pk_bf16_f32 v64, v64, v65
  v_cvt_pk_bf16_f32 v65, v66, v67
  v_cvt_pk_bf16_f32 v66, v68, v69
  v_cvt_pk_bf16_f32 v67, v70, v71
  v_cvt_pk_bf16_f32 v68, v72, v73
  v_cvt_pk_bf16_f32 v69, v74, v75
  v_cvt_pk_bf16_f32 v70, v76, v77
  v_cvt_pk_bf16_f32 v71, v78, v79
  v_mfma_f32_32x32x16_bf16 v[240:255], v[216:219], v[64:67], v[240:255]
  v_exp_f32 v80, v80
  v_exp_f32 v81, v81
  v_exp_f32 v82, v82
  v_exp_f32 v83, v83
  v_mfma_f32_32x32x16_bf16 v[240:255], v[220:223], v[68:71], v[240:255]
  ds_read_b128 v[120:123], v27 offset:27744
  v_exp_f32 v84, v84
  v_exp_f32 v85, v85
  v_exp_f32 v86, v86
  s_waitcnt lgkmcnt(1)
  v_mfma_f32_32x32x16_bf16 v[64:79], v[52:55], v[20:23], 0
  ds_read_b128 v[124:127], v28 offset:28256
  v_exp_f32 v87, v87
  v_exp_f32 v88, v88
  v_exp_f32 v89, v89
  v_exp_f32 v90, v90
  v_exp_f32 v91, v91
  v_exp_f32 v92, v92
  v_exp_f32 v93, v93
  v_exp_f32 v94, v94
  v_exp_f32 v95, v95
  v_cvt_pk_bf16_f32 v80, v80, v81
  v_cvt_pk_bf16_f32 v81, v82, v83
  v_cvt_pk_bf16_f32 v82, v84, v85
  v_cvt_pk_bf16_f32 v83, v86, v87
  v_cvt_pk_bf16_f32 v84, v88, v89
  v_cvt_pk_bf16_f32 v85, v90, v91
  v_cvt_pk_bf16_f32 v86, v92, v93
  v_cvt_pk_bf16_f32 v87, v94, v95
  v_mfma_f32_32x32x16_bf16 v[240:255], v[112:115], v[80:83], v[240:255]
  ds_read_b128 v[200:203], v27 offset:31856
  v_exp_f32 v96, v96
  v_exp_f32 v97, v97
  v_exp_f32 v98, v98
  v_mfma_f32_32x32x16_bf16 v[240:255], v[116:119], v[84:87], v[240:255]
  ds_read_b128 v[204:207], v28 offset:32368
  v_exp_f32 v99, v99
  v_exp_f32 v100, v100
  v_exp_f32 v101, v101
  v_exp_f32 v102, v102
  v_exp_f32 v103, v103
  v_exp_f32 v104, v104
  v_exp_f32 v105, v105
  v_exp_f32 v106, v106
  v_exp_f32 v107, v107
  v_exp_f32 v108, v108
  v_exp_f32 v109, v109
  v_exp_f32 v110, v110
  v_exp_f32 v111, v111
  v_cvt_pk_bf16_f32 v96, v96, v97
  v_cvt_pk_bf16_f32 v97, v98, v99
  v_cvt_pk_bf16_f32 v98, v100, v101
  v_cvt_pk_bf16_f32 v99, v102, v103
  v_cvt_pk_bf16_f32 v100, v104, v105
  v_cvt_pk_bf16_f32 v101, v106, v107
  v_cvt_pk_bf16_f32 v102, v108, v109
  v_cvt_pk_bf16_f32 v103, v110, v111
  s_waitcnt lgkmcnt(3)
  v_mfma_f32_32x32x16_bf16 v[240:255], v[120:123], v[96:99], v[240:255]
  s_waitcnt lgkmcnt(2)
  v_exp_f32 v64, v64
  v_exp_f32 v65, v65
  v_exp_f32 v66, v66
  v_exp_f32 v67, v67
  v_mfma_f32_32x32x16_bf16 v[240:255], v[124:127], v[100:103], v[240:255]
  v_exp_f32 v68, v68
  v_exp_f32 v69, v69
  v_exp_f32 v70, v70
  v_exp_f32 v71, v71
  v_cvt_pk_bf16_f32 v64, v64, v65
  v_cvt_pk_bf16_f32 v65, v66, v67
  v_cvt_pk_bf16_f32 v66, v68, v69
  v_cvt_pk_bf16_f32 v67, v70, v71
  v_exp_f32 v72, v72
  v_exp_f32 v73, v73
  s_waitcnt lgkmcnt(1)
  v_mfma_f32_32x32x16_bf16 v[240:255], v[200:203], v[64:67], v[240:255]
  v_exp_f32 v74, v74
  v_exp_f32 v75, v75
  v_exp_f32 v76, v76
  v_exp_f32 v77, v77
  v_exp_f32 v78, v78
  v_exp_f32 v79, v79
  v_cvt_pk_bf16_f32 v68, v72, v73
  v_cvt_pk_bf16_f32 v69, v74, v75
  v_cvt_pk_bf16_f32 v70, v76, v77
  v_cvt_pk_bf16_f32 v71, v78, v79
  s_waitcnt lgkmcnt(0)
  s_nop 0
  v_mfma_f32_32x32x16_bf16 v[240:255], v[204:207], v[68:71], v[240:255]
  s_nop 11
  v_rcp_f32 v31, v248
  v_add_u32 v14, 0xe0800000, v248
  v_max_u32 v14, v14, v29
  v_cmp_le_u32 vcc, 0x40000000, v14
  v_mul_f32 v240, v240, v31
  v_mul_f32 v241, v241, v31
  v_mul_f32 v242, v242, v31
  v_mul_f32 v243, v243, v31
  s_cbranch_vccnz L107
  v_mul_f32 v244, v244, v31
  v_mul_f32 v245, v245, v31
  v_mul_f32 v246, v246, v31
  v_mul_f32 v247, v247, v31
  v_cvt_pk_bf16_f32 v248, v240, v241
  v_cvt_pk_bf16_f32 v249, v242, v243
  v_cvt_pk_bf16_f32 v250, v244, v245
  v_cvt_pk_bf16_f32 v251, v246, v247
  buffer_store_dwordx4 v[248:251], v1, s[28:31], s54 offen offset:1024 sc1
L108:
  v_and_b32 v14, 0x1c0, v1
  v_or_b32 v14, 16711680, v14
  s_cmp_eq_u32 s51, 0
  s_waitcnt vmcnt(0)
  buffer_store_byte_d16_hi v14, v14, s[28:31], s8 offen offset:512
  v_mov_b32 v14, 17
  s_cbranch_scc1 L109
  buffer_store_dword v14, off, s[28:31], s52
L110:
L_p3_1:
  s_and_b32 s54, s6, 1
  s_lshl_b32 s54, s54, 14
  v_add_u32 v14, s54, v4
  s_lshl_b32 s57, s49, 15
  s_add_u32 s57, s57, s54
  s_add_u32 s57, s57, 26214400
  s_and_b32 s58, s0, 1
  s_lshl_b32 s58, s58, 13
  s_add_u32 s57, s57, s58
  s_barrier
  s_lshl_b32 s61, s0, 1
  s_xor_b32 s61, s61, s6
  s_xor_b32 s61, s61, 4
  s_mul_i32 s61, s61, 229376
  s_lshl_b32 s62, s5, 8
  s_add_u32 s61, s61, s62
  s_cmp_ge_u32 s5, 14
  s_cselect_b32 s61, 1073741824, s61
  s_lshl_b32 s62, s6, 13
  s_add_u32 m0, s62, 98304
  s_add_u32 s60, s61, 128
  buffer_load_dwordx4 v11, s[20:23], s60 offen offset:0 lds
  s_add_u32 s60, s61, 27776
  buffer_load_dwordx4 v11, s[20:23], s60 offen offset:1024 lds
  s_add_u32 s60, s61, 55424
  buffer_load_dwordx4 v11, s[20:23], s60 offen offset:2048 lds
  s_add_u32 s60, s61, 83072
  buffer_load_dwordx4 v11, s[20:23], s60 offen offset:3072 lds
  s_add_u32 m0, s62, 102400
  s_add_u32 s60, s61, 114816
  buffer_load_dwordx4 v11, s[20:23], s60 offen offset:0 lds
  s_add_u32 s60, s61, 142464
  buffer_load_dwordx4 v11, s[20:23], s60 offen offset:1024 lds
  s_add_u32 s60, s61, 170112
  buffer_load_dwordx4 v11, s[20:23], s60 offen offset:2048 lds
  s_add_u32 s60, s61, 197760
  buffer_load_dwordx4 v11, s[20:23], s60 offen offset:3072 lds
  ds_read_b64_tr_b16 v[128:129], v14 offset:0
  ds_read_b64_tr_b16 v[130:131], v14 offset:256
  ds_read_b64_tr_b16 v[132:133], v14 offset:512
  ds_read_b64_tr_b16 v[134:135], v14 offset:768
  ds_read_b64_tr_b16 v[136:137], v14 offset:2048
  ds_read_b64_tr_b16 v[138:139], v14 offset:2304
  ds_read_b64_tr_b16 v[140:141], v14 offset:2560
  ds_read_b64_tr_b16 v[142:143], v14 offset:2816
  ds_read_b64_tr_b16 v[144:145], v14 offset:4096
  ds_read_b64_tr_b16 v[146:147], v14 offset:4352
  ds_read_b64_tr_b16 v[148:149], v14 offset:4608
  ds_read_b64_tr_b16 v[150:151], v14 offset:4864
  s_buffer_load_dwordx2 s[44:45], s[28:31], s36 offset:512
  ds_read_b64_tr_b16 v[152:153], v14 offset:6144
  ds_read_b64_tr_b16 v[154:155], v14 offset:6400
  ds_read_b64_tr_b16 v[156:157], v14 offset:6656
  ds_read_b64_tr_b16 v[158:159], v14 offset:6912
  ds_read_b64_tr_b16 v[160:161], v14 offset:8192
  ds_read_b64_tr_b16 v[162:163], v14 offset:8448
  ds_read_b64_tr_b16 v[164:165], v14 offset:8704
  ds_read_b64_tr_b16 v[166:167], v14 offset:8960
  ds_read_b64_tr_b16 v[168:169], v14 offset:10240
  ds_read_b64_tr_b16 v[170:171], v14 offset:10496
  ds_read_b64_tr_b16 v[172:173], v14 offset:10752
  ds_read_b64_tr_b16 v[174:175], v14 offset:11008
  ds_read_b64_tr_b16 v[176:177], v14 offset:12288
  ds_read_b64_tr_b16 v[178:179], v14 offset:12544
  ds_read_b64_tr_b16 v[180:181], v14 offset:12800
  ds_read_b64_tr_b16 v[182:183], v14 offset:13056
  v_accvgpr_read_b32 v16, a224
  v_accvgpr_read_b32 v17, a225
  v_accvgpr_read_b32 v18, a226
  v_accvgpr_read_b32 v19, a227
  v_accvgpr_read_b32 v20, a228
  v_accvgpr_read_b32 v21, a229
  v_accvgpr_read_b32 v22, a230
  v_accvgpr_read_b32 v23, a231
  v_accvgpr_read_b32 v24, a232
  v_accvgpr_read_b32 v25, a233
  v_accvgpr_read_b32 v26, a234
  v_accvgpr_read_b32 v27, a235
  v_accvgpr_read_b32 v28, a236
  v_accvgpr_read_b32 v29, a237
  v_accvgpr_read_b32 v30, a238
  v_accvgpr_read_b32 v31, a239
  s_waitcnt lgkmcnt(0)
  s_nand_b32 s44, s44, s45
  s_cbranch_scc1 L111
L112:
  s_xor_b32 s58, s57, 0
  buffer_load_dwordx4 v[64:67], v1, s[28:31], s58 offen offset:0 sc1
  buffer_load_dwordx4 v[68:71], v1, s[28:31], s58 offen offset:1024 sc1
  buffer_load_dwordx4 v[72:75], v1, s[28:31], s58 offen offset:2048 sc1
  buffer_load_dwordx4 v[76:79], v1, s[28:31], s58 offen offset:3072 sc1
  s_xor_b32 s58, s57, 4096
  buffer_load_dwordx4 v[80:83], v1, s[28:31], s58 offen offset:0 sc1
  buffer_load_dwordx4 v[84:87], v1, s[28:31], s58 offen offset:1024 sc1
  buffer_load_dwordx4 v[88:91], v1, s[28:31], s58 offen offset:2048 sc1
  buffer_load_dwordx4 v[92:95], v1, s[28:31], s58 offen offset:3072 sc1
  s_xor_b32 s58, s57, 8192
  buffer_load_dwordx4 v[96:99], v1, s[28:31], s58 offen offset:0 sc1
  buffer_load_dwordx4 v[100:103], v1, s[28:31], s58 offen offset:1024 sc1
  buffer_load_dwordx4 v[104:107], v1, s[28:31], s58 offen offset:2048 sc1
  buffer_load_dwordx4 v[108:111], v1, s[28:31], s58 offen offset:3072 sc1
  s_xor_b32 s58, s57, 12288
  buffer_load_dwordx4 v[112:115], v1, s[28:31], s58 offen offset:0 sc1
  buffer_load_dwordx4 v[116:119], v1, s[28:31], s58 offen offset:1024 sc1
  buffer_load_dwordx4 v[120:123], v1, s[28:31], s58 offen offset:2048 sc1
  buffer_load_dwordx4 v[124:127], v1, s[28:31], s58 offen offset:3072 sc1
  ds_read_b64_tr_b16 v[184:185], v14 offset:14336
  ds_read_b64_tr_b16 v[186:187], v14 offset:14592
  ds_read_b64_tr_b16 v[188:189], v14 offset:14848
  ds_read_b64_tr_b16 v[190:191], v14 offset:15104
  ds_read_b64_tr_b16 v[192:193], v14 offset:32768
  ds_read_b64_tr_b16 v[194:195], v14 offset:33024
  ds_read_b64_tr_b16 v[196:197], v14 offset:33280
  ds_read_b64_tr_b16 v[198:199], v14 offset:33536
  ds_read_b64_tr_b16 v[200:201], v14 offset:34816
  ds_read_b64_tr_b16 v[202:203], v14 offset:35072
  ds_read_b64_tr_b16 v[204:205], v14 offset:35328
  ds_read_b64_tr_b16 v[206:207], v14 offset:35584
  ds_read_b64_tr_b16 v[208:209], v14 offset:36864
  ds_read_b64_tr_b16 v[210:211], v14 offset:37120
  ds_read_b64_tr_b16 v[212:213], v14 offset:37376
  ds_read_b64_tr_b16 v[214:215], v14 offset:37632
  ds_read_b64_tr_b16 v[216:217], v14 offset:38912
  ds_read_b64_tr_b16 v[218:219], v14 offset:39168
  ds_read_b64_tr_b16 v[220:221], v14 offset:39424
  ds_read_b64_tr_b16 v[222:223], v14 offset:39680
  ds_read_b64_tr_b16 v[224:225], v14 offset:40960
  ds_read_b64_tr_b16 v[226:227], v14 offset:41216
  ds_read_b64_tr_b16 v[228:229], v14 offset:41472
  ds_read_b64_tr_b16 v[230:231], v14 offset:41728
  ds_read_b64_tr_b16 v[232:233], v14 offset:43008
  ds_read_b64_tr_b16 v[234:235], v14 offset:43264
  ds_read_b64_tr_b16 v[236:237], v14 offset:43520
  ds_read_b64_tr_b16 v[238:239], v14 offset:43776
  ds_read_b64_tr_b16 v[240:241], v14 offset:45056
  ds_read_b64_tr_b16 v[242:243], v14 offset:45312
  ds_read_b64_tr_b16 v[244:245], v14 offset:45568
  ds_read_b64_tr_b16 v[246:247], v14 offset:45824
  ds_read_b64_tr_b16 v[248:249], v14 offset:47104
  ds_read_b64_tr_b16 v[250:251], v14 offset:47360
  ds_read_b64_tr_b16 v[252:253], v14 offset:47616
  ds_read_b64_tr_b16 v[254:255], v14 offset:47872
  s_xor_b32 s54, s6, 1
  s_lshl_b32 s54, s54, 12
  s_add_u32 s54, s54, 131072
  v_add_u32 v13, s54, v1
  s_lshl_b32 s56, s49, 4
  s_add_u32 s56, s56, s50
  s_lshl_b32 s55, s56, 11
  s_add_u32 s55, s55, 0
  s_lshl_b32 s56, s56, 8
  s_add_u32 s56, s56, 11534336
  v_lshlrev_b32 v15, 2, v0
  s_waitcnt lgkmcnt(0)
  s_barrier
L116:
  s_waitcnt vmcnt(15)
  v_mfma_f32_32x32x16_bf16 v[32:47], v[132:135], v[64:67], 0
  v_mfma_f32_32x32x16_bf16 v[16:31], v[128:131], v[64:67], v[16:31]
  s_xor_b32 s61, s6, s0
  s_mul_i32 s61, s61, 458752
  s_lshl_b32 s62, s5, 8
  s_add_u32 s61, s61, s62
  s_cmp_ge_u32 s5, 14
  s_cselect_b32 s61, 1073741824, s61
  s_lshl_b32 s62, s6, 14
  s_add_u32 m0, s62, 0
  s_add_u32 s60, s61, 0
  buffer_load_dwordx4 v11, s[20:23], s60 offen offset:0 lds
  s_add_u32 s60, s61, 27648
  buffer_load_dwordx4 v11, s[20:23], s60 offen offset:1024 lds
  s_waitcnt vmcnt(16)
  v_mfma_f32_32x32x16_bf16 v[32:47], v[140:143], v[68:71], v[32:47]
  v_mfma_f32_32x32x16_bf16 v[16:31], v[136:139], v[68:71], v[16:31]
  s_add_u32 s60, s61, 55296
  buffer_load_dwordx4 v11, s[20:23], s60 offen offset:2048 lds
  s_waitcnt vmcnt(16)
  v_mfma_f32_32x32x16_bf16 v[32:47], v[148:151], v[72:75], v[32:47]
  v_mfma_f32_32x32x16_bf16 v[16:31], v[144:147], v[72:75], v[16:31]
  s_add_u32 s60, s61, 82944
  buffer_load_dwordx4 v11, s[20:23], s60 offen offset:3072 lds
  s_waitcnt vmcnt(16)
  v_mfma_f32_32x32x16_bf16 v[32:47], v[156:159], v[76:79], v[32:47]
  v_mfma_f32_32x32x16_bf16 v[16:31], v[152:155], v[76:79], v[16:31]
  s_add_u32 m0, s62, 4096
  s_add_u32 s60, s61, 114688
  buffer_load_dwordx4 v11, s[20:23], s60 offen offset:0 lds
  s_waitcnt vmcnt(16)
  v_mfma_f32_32x32x16_bf16 v[32:47], v[164:167], v[80:83], v[32:47]
  v_mfma_f32_32x32x16_bf16 v[16:31], v[160:163], v[80:83], v[16:31]
  s_add_u32 s60, s61, 142336
  buffer_load_dwordx4 v11, s[20:23], s60 offen offset:1024 lds
  s_waitcnt vmcnt(16)
  v_mfma_f32_32x32x16_bf16 v[32:47], v[172:175], v[84:87], v[32:47]
  v_mfma_f32_32x32x16_bf16 v[16:31], v[168:171], v[84:87], v[16:31]
  s_add_u32 s60, s61, 169984
  buffer_load_dwordx4 v11, s[20:23], s60 offen offset:2048 lds
  s_waitcnt vmcnt(16)
  v_mfma_f32_32x32x16_bf16 v[32:47], v[180:183], v[88:91], v[32:47]
  v_mfma_f32_32x32x16_bf16 v[16:31], v[176:179], v[88:91], v[16:31]
  s_add_u32 s60, s61, 197632
  buffer_load_dwordx4 v11, s[20:23], s60 offen offset:3072 lds
  s_add_u32 m0, s62, 8192
  s_add_u32 s60, s61, 229376
  buffer_load_dwordx4 v11, s[20:23], s60 offen offset:0 lds
  s_waitcnt vmcnt(17)
  v_mfma_f32_32x32x16_bf16 v[32:47], v[188:191], v[92:95], v[32:47]
  v_mfma_f32_32x32x16_bf16 v[16:31], v[184:187], v[92:95], v[16:31]
  s_add_u32 s60, s61, 257024
  buffer_load_dwordx4 v11, s[20:23], s60 offen offset:1024 lds
  s_waitcnt vmcnt(17)
  v_mfma_f32_32x32x16_bf16 v[32:47], v[196:199], v[96:99], v[32:47]
  v_mfma_f32_32x32x16_bf16 v[16:31], v[192:195], v[96:99], v[16:31]
  s_add_u32 s60, s61, 284672
  buffer_load_dwordx4 v11, s[20:23], s60 offen offset:2048 lds
  s_waitcnt vmcnt(17)
  v_mfma_f32_32x32x16_bf16 v[32:47], v[204:207], v[100:103], v[32:47]
  v_mfma_f32_32x32x16_bf16 v[16:31], v[200:203], v[100:103], v[16:31]
  s_add_u32 s60, s61, 312320
  buffer_load_dwordx4 v11, s[20:23], s60 offen offset:3072 lds
  s_waitcnt vmcnt(17)
  v_mfma_f32_32x32x16_bf16 v[32:47], v[212:215], v[104:107], v[32:47]
  v_mfma_f32_32x32x16_bf16 v[16:31], v[208:211], v[104:107], v[16:31]
  s_add_u32 m0, s62, 12288
  s_add_u32 s60, s61, 344064
  buffer_load_dwordx4 v11, s[20:23], s60 offen offset:0 lds
  s_waitcnt vmcnt(17)
  v_mfma_f32_32x32x16_bf16 v[32:47], v[220:223], v[108:111], v[32:47]
  v_mfma_f32_32x32x16_bf16 v[16:31], v[216:219], v[108:111], v[16:31]
  s_add_u32 s60, s61, 371712
  buffer_load_dwordx4 v11, s[20:23], s60 offen offset:1024 lds
  s_waitcnt vmcnt(17)
  v_mfma_f32_32x32x16_bf16 v[32:47], v[228:231], v[112:115], v[32:47]
  s_add_u32 s60, s61, 399360
  buffer_load_dwordx4 v11, s[20:23], s60 offen offset:2048 lds
  s_waitcnt vmcnt(17)
  v_mfma_f32_32x32x16_bf16 v[32:47], v[236:239], v[116:119], v[32:47]
  s_waitcnt vmcnt(16)
  v_mfma_f32_32x32x16_bf16 v[32:47], v[244:247], v[120:123], v[32:47]
  s_add_u32 s60, s61, 427008
  buffer_load_dwordx4 v11, s[20:23], s60 offen offset:3072 lds
  s_waitcnt vmcnt(16)
  v_mfma_f32_32x32x16_bf16 v[32:47], v[252:255], v[124:127], v[32:47]
  v_mfma_f32_32x32x16_bf16 v[16:31], v[224:227], v[112:115], v[16:31]
  v_mfma_f32_32x32x16_bf16 v[16:31], v[232:235], v[116:119], v[16:31]
  s_nop 9
  ds_write_b128 v13, v[32:35] offset:0
  v_mfma_f32_32x32x16_bf16 v[16:31], v[240:243], v[120:123], v[16:31]
  ds_write_b128 v13, v[36:39] offset:1024
  v_mfma_f32_32x32x16_bf16 v[16:31], v[248:251], v[124:127], v[16:31]
  ds_write_b128 v13, v[40:43] offset:2048
  ds_write_b128 v13, v[44:47] offset:3072
  v_xor_b32 v13, 0x1000, v13
  s_waitcnt lgkmcnt(0)
  s_barrier
  ds_read_b128 v[64:67], v13 offset:0
  ds_read_b128 v[68:71], v13 offset:1024
  ds_read_b128 v[72:75], v13 offset:2048
  ds_read_b128 v[76:79], v13 offset:3072
  s_waitcnt lgkmcnt(3)
  s_nop 1
  v_pk_add_f32 v[16:17], v[16:17], v[64:65]
  v_pk_add_f32 v[18:19], v[18:19], v[66:67]
  s_waitcnt lgkmcnt(2)
  v_pk_add_f32 v[20:21], v[20:21], v[68:69]
  v_pk_add_f32 v[22:23], v[22:23], v[70:71]
  s_waitcnt lgkmcnt(1)
  v_pk_add_f32 v[24:25], v[24:25], v[72:73]
  v_pk_add_f32 v[26:27], v[26:27], v[74:75]
  s_waitcnt lgkmcnt(0)
  v_pk_add_f32 v[28:29], v[28:29], v[76:77]
  v_pk_add_f32 v[30:31], v[30:31], v[78:79]
  v_cvt_pk_bf16_f32 v80, v16, v17
  v_cvt_pk_bf16_f32 v81, v18, v19
  v_cvt_pk_bf16_f32 v82, v20, v21
  v_cvt_pk_bf16_f32 v83, v22, v23
  v_cvt_pk_bf16_f32 v84, v24, v25
  v_cvt_pk_bf16_f32 v85, v26, v27
  v_cvt_pk_bf16_f32 v86, v28, v29
  v_cvt_pk_bf16_f32 v87, v30, v31
  s_cmp_eq_u32 s51, 0
  s_cbranch_scc1 L117
  buffer_store_dwordx4 v[80:83], v1, s[32:35], s55 offen
L118:
  s_cmp_eq_u32 s51, 0
  s_cbranch_scc1 L119
  buffer_store_dwordx4 v[84:87], v1, s[32:35], s55 offen offset:1024
L120:
  v_pk_add_f32 v[88:89], v[16:17], v[18:19]
  v_pk_mul_f32 v[90:91], v[16:17], v[16:17]
  v_pk_fma_f32 v[90:91], v[18:19], v[18:19], v[90:91]
  v_pk_add_f32 v[88:89], v[88:89], v[20:21]
  v_pk_fma_f32 v[90:91], v[20:21], v[20:21], v[90:91]
  v_pk_add_f32 v[88:89], v[88:89], v[22:23]
  v_pk_fma_f32 v[90:91], v[22:23], v[22:23], v[90:91]
  v_pk_add_f32 v[88:89], v[88:89], v[24:25]
  v_pk_fma_f32 v[90:91], v[24:25], v[24:25], v[90:91]
  v_pk_add_f32 v[88:89], v[88:89], v[26:27]
  v_pk_fma_f32 v[90:91], v[26:27], v[26:27], v[90:91]
  v_pk_add_f32 v[88:89], v[88:89], v[28:29]
  v_pk_fma_f32 v[90:91], v[28:29], v[28:29], v[90:91]
  v_pk_add_f32 v[88:89], v[88:89], v[30:31]
  v_pk_fma_f32 v[90:91], v[30:31], v[30:31], v[90:91]
  v_add_f32 v88, v88, v89
  v_add_f32 v90, v90, v91
  s_nop 1
  v_permlane32_swap_b32 v88, v90
  v_add_f32 v88, v88, v90
  s_cmp_eq_u32 s51, 0
  s_cbranch_scc1 L121
  buffer_store_dword v88, v15, s[28:31], s56 offen
L122:
  v_accvgpr_read_b32 v14, a248
  v_lshlrev_b32 v64, 16, v14
  v_and_b32 v65, 0xffff0000, v14
  v_pk_add_f32 v[16:17], v[16:17], v[64:65]
  v_accvgpr_write_b32 a224, v16
  v_accvgpr_write_b32 a225, v17
  v_accvgpr_read_b32 v14, a249
  v_lshlrev_b32 v64, 16, v14
  v_and_b32 v65, 0xffff0000, v14
  v_pk_add_f32 v[18:19], v[18:19], v[64:65]
  v_accvgpr_write_b32 a226, v18
  v_accvgpr_write_b32 a227, v19
  v_accvgpr_read_b32 v14, a250
  v_lshlrev_b32 v64, 16, v14
  v_and_b32 v65, 0xffff0000, v14
  v_pk_add_f32 v[20:21], v[20:21], v[64:65]
  v_accvgpr_write_b32 a228, v20
  v_accvgpr_write_b32 a229, v21
  v_accvgpr_read_b32 v14, a251
  v_lshlrev_b32 v64, 16, v14
  v_and_b32 v65, 0xffff0000, v14
  v_pk_add_f32 v[22:23], v[22:23], v[64:65]
  v_accvgpr_write_b32 a230, v22
  v_accvgpr_write_b32 a231, v23
  v_accvgpr_read_b32 v14, a252
  v_lshlrev_b32 v64, 16, v14
  v_and_b32 v65, 0xffff0000, v14
  v_pk_add_f32 v[24:25], v[24:25], v[64:65]
  v_accvgpr_write_b32 a232, v24
  v_accvgpr_write_b32 a233, v25
  v_accvgpr_read_b32 v14, a253
  v_lshlrev_b32 v64, 16, v14
  v_and_b32 v65, 0xffff0000, v14
  v_pk_add_f32 v[26:27], v[26:27], v[64:65]
  v_accvgpr_write_b32 a234, v26
  v_accvgpr_write_b32 a235, v27
  v_accvgpr_read_b32 v14, a254
  v_lshlrev_b32 v64, 16, v14
  v_and_b32 v65, 0xffff0000, v14
  v_pk_add_f32 v[28:29], v[28:29], v[64:65]
  v_accvgpr_write_b32 a236, v28
  v_accvgpr_write_b32 a237, v29
  v_accvgpr_read_b32 v14, a255
  v_lshlrev_b32 v64, 16, v14
  v_and_b32 v65, 0xffff0000, v14
  v_pk_add_f32 v[30:31], v[30:31], v[64:65]
  v_accvgpr_write_b32 a238, v30
  v_accvgpr_write_b32 a239, v31
  v_and_b32 v14, 0x1c0, v1
  v_or_b32 v14, 16711680, v14
  s_cmp_eq_u32 s51, 0
  s_waitcnt vmcnt(0)
  buffer_store_byte_d16_hi v14, v14, s[28:31], s9 offen offset:3072
  v_mov_b32 v14, 19
  s_cbranch_scc1 L123
  buffer_store_dword v14, off, s[28:31], s52
L124:
  s_barrier
  v_add_u32 v15, 159232, v1
L125:
  ds_read_b64_tr_b16 v[64:65], v4 offset:0
  ds_read_b64_tr_b16 v[66:67], v4 offset:256
  ds_read_b64_tr_b16 v[68:69], v4 offset:512
  ds_read_b64_tr_b16 v[70:71], v4 offset:768
  ds_read_b64_tr_b16 v[72:73], v4 offset:2048
  ds_read_b64_tr_b16 v[74:75], v4 offset:2304
  ds_read_b64_tr_b16 v[76:77], v4 offset:2560
  ds_read_b64_tr_b16 v[78:79], v4 offset:2816
  ds_read_b64_tr_b16 v[80:81], v4 offset:4096
  ds_read_b64_tr_b16 v[82:83], v4 offset:4352
  ds_read_b64_tr_b16 v[84:85], v4 offset:4608
  ds_read_b64_tr_b16 v[86:87], v4 offset:4864
  s_lshl_b32 s57, s48, 17
  s_lshl_b32 s58, s5, 13
  s_add_u32 s57, s57, s58
  s_add_u32 s57, s57, 33554432
  s_cmp_ge_u32 s5, 14
  s_cselect_b32 s57, 1073741824, s57
  s_add_u32 s58, s57, 4096
  s_lshl_b32 s55, s48, 2
  s_add_u32 s55, s55, s0
  s_lshl_b32 s55, s55, 13
  s_add_u32 s55, s55, 0
  s_lshl_b32 s56, s48, 12
  s_add_u32 s56, s56, 11534336
  v_lshlrev_b32 v111, 2, v0
  s_cmp_ge_u32 s5, 14
  s_cselect_b32 s55, 1073741824, s55
  s_cselect_b32 s56, 1073741824, s56
  s_buffer_load_dwordx4 s[44:47], s[28:31], s38 offset:7168
  s_waitcnt lgkmcnt(0)
  s_nand_b64 s[44:45], s[44:45], s[46:47]
  s_cbranch_scc1 L126
L127:
  s_xor_b32 s54, s55, 0
  buffer_load_dwordx4 v[128:131], v1, s[32:35], s54 offen offset:0 sc1
  buffer_load_dwordx4 v[132:135], v1, s[32:35], s54 offen offset:1024 sc1
  buffer_load_dwordx4 v[136:139], v1, s[32:35], s54 offen offset:2048 sc1
  buffer_load_dwordx4 v[140:143], v1, s[32:35], s54 offen offset:3072 sc1
  s_xor_b32 s54, s55, 4096
  buffer_load_dwordx4 v[144:147], v1, s[32:35], s54 offen offset:0 sc1
  buffer_load_dwordx4 v[148:151], v1, s[32:35], s54 offen offset:1024 sc1
  buffer_load_dwordx4 v[152:155], v1, s[32:35], s54 offen offset:2048 sc1
  buffer_load_dwordx4 v[156:159], v1, s[32:35], s54 offen offset:3072 sc1
  s_xor_b32 s54, s55, 8192
  buffer_load_dwordx4 v[160:163], v1, s[32:35], s54 offen offset:0 sc1
  buffer_load_dwordx4 v[164:167], v1, s[32:35], s54 offen offset:1024 sc1
  buffer_load_dwordx4 v[168:171], v1, s[32:35], s54 offen offset:2048 sc1
  buffer_load_dwordx4 v[172:175], v1, s[32:35], s54 offen offset:3072 sc1
  s_xor_b32 s54, s55, 12288
  buffer_load_dwordx4 v[176:179], v1, s[32:35], s54 offen offset:0 sc1
  buffer_load_dwordx4 v[180:183], v1, s[32:35], s54 offen offset:1024 sc1
  ds_read_b64_tr_b16 v[88:89], v4 offset:6144
  ds_read_b64_tr_b16 v[90:91], v4 offset:6400
  ds_read_b64_tr_b16 v[92:93], v4 offset:6656
  ds_read_b64_tr_b16 v[94:95], v4 offset:6912
  s_waitcnt vmcnt(13)
  v_mfma_f32_32x32x16_bf16 v[16:31], v[64:67], v[128:131], 0
  v_mfma_f32_32x32x16_bf16 v[32:47], v[68:71], v[128:131], 0
  buffer_load_dwordx4 v[184:187], v1, s[32:35], s54 offen offset:2048 sc1
  ds_read_b64_tr_b16 v[64:65], v4 offset:8192
  ds_read_b64_tr_b16 v[66:67], v4 offset:8448
  ds_read_b64_tr_b16 v[68:69], v4 offset:8704
  ds_read_b64_tr_b16 v[70:71], v4 offset:8960
  s_waitcnt vmcnt(13)
  v_mfma_f32_32x32x16_bf16 v[16:31], v[72:75], v[132:135], v[16:31]
  v_mfma_f32_32x32x16_bf16 v[32:47], v[76:79], v[132:135], v[32:47]
  buffer_load_dwordx4 v[188:191], v1, s[32:35], s54 offen offset:3072 sc1
  ds_read_b64_tr_b16 v[72:73], v4 offset:10240
  ds_read_b64_tr_b16 v[74:75], v4 offset:10496
  ds_read_b64_tr_b16 v[76:77], v4 offset:10752
  ds_read_b64_tr_b16 v[78:79], v4 offset:11008
  s_waitcnt vmcnt(13)
  v_mfma_f32_32x32x16_bf16 v[16:31], v[80:83], v[136:139], v[16:31]
  v_mfma_f32_32x32x16_bf16 v[32:47], v[84:87], v[136:139], v[32:47]
  buffer_load_dword v96, v111, s[28:31], s56 offen offset:0 sc1
  buffer_load_dword v97, v111, s[28:31], s56 offen offset:256 sc1
  buffer_load_dword v98, v111, s[28:31], s56 offen offset:512 sc1
  buffer_load_dword v99, v111, s[28:31], s56 offen offset:768 sc1
  ds_read_b64_tr_b16 v[80:81], v4 offset:12288
  ds_read_b64_tr_b16 v[82:83], v4 offset:12544
  ds_read_b64_tr_b16 v[84:85], v4 offset:12800
  ds_read_b64_tr_b16 v[86:87], v4 offset:13056
  s_waitcnt vmcnt(16) lgkmcnt(14)
  v_mfma_f32_32x32x16_bf16 v[16:31], v[88:91], v[140:143], v[16:31]
  s_waitcnt lgkmcnt(12)
  v_mfma_f32_32x32x16_bf16 v[32:47], v[92:95], v[140:143], v[32:47]
  buffer_load_dword v100, v111, s[28:31], s56 offen offset:1024 sc1
  buffer_load_dword v101, v111, s[28:31], s56 offen offset:1280 sc1
  buffer_load_dword v102, v111, s[28:31], s56 offen offset:1536 sc1
  buffer_load_dword v103, v111, s[28:31], s56 offen offset:1792 sc1
  ds_read_b64_tr_b16 v[88:89], v4 offset:14336
  ds_read_b64_tr_b16 v[90:91], v4 offset:14592
  ds_read_b64_tr_b16 v[92:93], v4 offset:14848
  ds_read_b64_tr_b16 v[94:95], v4 offset:15104
  s_waitcnt vmcnt(19) lgkmcnt(14)
  v_mfma_f32_32x32x16_bf16 v[16:31], v[64:67], v[144:147], v[16:31]
  s_waitcnt lgkmcnt(12)
  v_mfma_f32_32x32x16_bf16 v[32:47], v[68:71], v[144:147], v[32:47]
  buffer_load_dword v104, v111, s[28:31], s56 offen offset:2048 sc1
  buffer_load_dword v105, v111, s[28:31], s56 offen offset:2304 sc1
  buffer_load_dword v106, v111, s[28:31], s56 offen offset:2560 sc1
  buffer_load_dword v107, v111, s[28:31], s56 offen offset:2816 sc1
  ds_read_b64_tr_b16 v[64:65], v4 offset:16384
  ds_read_b64_tr_b16 v[66:67], v4 offset:16640
  ds_read_b64_tr_b16 v[68:69], v4 offset:16896
  ds_read_b64_tr_b16 v[70:71], v4 offset:17152
  s_waitcnt vmcnt(22) lgkmcnt(14)
  v_mfma_f32_32x32x16_bf16 v[16:31], v[72:75], v[148:151], v[16:31]
  s_waitcnt lgkmcnt(12)
  v_mfma_f32_32x32x16_bf16 v[32:47], v[76:79], v[148:151], v[32:47]
  buffer_load_dword v108, v111, s[28:31], s56 offen offset:3072 sc1
  buffer_load_dword v109, v111, s[28:31], s56 offen offset:3328 sc1
  buffer_load_dword v110, v111, s[28:31], s56 offen offset:3584 sc1
  buffer_load_dword v111, v111, s[28:31], s56 offen offset:3840 sc1
  ds_read_b64_tr_b16 v[72:73], v4 offset:18432
  ds_read_b64_tr_b16 v[74:75], v4 offset:18688
  ds_read_b64_tr_b16 v[76:77], v4 offset:18944
  ds_read_b64_tr_b16 v[78:79], v4 offset:19200
  s_waitcnt vmcnt(25) lgkmcnt(14)
  v_mfma_f32_32x32x16_bf16 v[16:31], v[80:83], v[152:155], v[16:31]
  s_waitcnt lgkmcnt(12)
  v_mfma_f32_32x32x16_bf16 v[32:47], v[84:87], v[152:155], v[32:47]
  s_xor_b32 s54, s55, 16384
  buffer_load_dwordx4 v[192:195], v1, s[32:35], s54 offen offset:0 sc1
  ds_read_b64_tr_b16 v[80:81], v4 offset:20480
  ds_read_b64_tr_b16 v[82:83], v4 offset:20736
  ds_read_b64_tr_b16 v[84:85], v4 offset:20992
  ds_read_b64_tr_b16 v[86:87], v4 offset:21248
  s_waitcnt vmcnt(25) lgkmcnt(14)
  v_mfma_f32_32x32x16_bf16 v[16:31], v[88:91], v[156:159], v[16:31]
  s_waitcnt lgkmcnt(12)
  v_mfma_f32_32x32x16_bf16 v[32:47], v[92:95], v[156:159], v[32:47]
  buffer_load_dwordx4 v[196:199], v1, s[32:35], s54 offen offset:1024 sc1
  ds_read_b64_tr_b16 v[88:89], v4 offset:22528
  ds_read_b64_tr_b16 v[90:91], v4 offset:22784
  ds_read_b64_tr_b16 v[92:93], v4 offset:23040
  ds_read_b64_tr_b16 v[94:95], v4 offset:23296
  s_waitcnt vmcnt(25) lgkmcnt(14)
  v_mfma_f32_32x32x16_bf16 v[16:31], v[64:67], v[160:163], v[16:31]
  s_waitcnt lgkmcnt(12)
  v_mfma_f32_32x32x16_bf16 v[32:47], v[68:71], v[160:163], v[32:47]
  buffer_load_dwordx4 v[200:203], v1, s[32:35], s54 offen offset:2048 sc1
  ds_read_b64_tr_b16 v[64:65], v4 offset:24576
  ds_read_b64_tr_b16 v[66:67], v4 offset:24832
  ds_read_b64_tr_b16 v[68:69], v4 offset:25088
  ds_read_b64_tr_b16 v[70:71], v4 offset:25344
  s_waitcnt vmcnt(25) lgkmcnt(14)
  v_mfma_f32_32x32x16_bf16 v[16:31], v[72:75], v[164:167], v[16:31]
  s_waitcnt lgkmcnt(12)
  v_mfma_f32_32x32x16_bf16 v[32:47], v[76:79], v[164:167], v[32:47]
  buffer_load_dwordx4 v[204:207], v1, s[32:35], s54 offen offset:3072 sc1
  ds_read_b64_tr_b16 v[72:73], v4 offset:26624
  ds_read_b64_tr_b16 v[74:75], v4 offset:26880
  ds_read_b64_tr_b16 v[76:77], v4 offset:27136
  ds_read_b64_tr_b16 v[78:79], v4 offset:27392
  s_waitcnt vmcnt(25) lgkmcnt(14)
  v_mfma_f32_32x32x16_bf16 v[16:31], v[80:83], v[168:171], v[16:31]
  s_waitcnt lgkmcnt(12)
  v_mfma_f32_32x32x16_bf16 v[32:47], v[84:87], v[168:171], v[32:47]
  s_xor_b32 s54, s55, 20480
  buffer_load_dwordx4 v[208:211], v1, s[32:35], s54 offen offset:0 sc1
  ds_read_b64_tr_b16 v[80:81], v4 offset:28672
  ds_read_b64_tr_b16 v[82:83], v4 offset:28928
  ds_read_b64_tr_b16 v[84:85], v4 offset:29184
  ds_read_b64_tr_b16 v[86:87], v4 offset:29440
  s_waitcnt vmcnt(25) lgkmcnt(14)
  v_mfma_f32_32x32x16_bf16 v[16:31], v[88:91], v[172:175], v[16:31]
  s_waitcnt lgkmcnt(12)
  v_mfma_f32_32x32x16_bf16 v[32:47], v[92:95], v[172:175], v[32:47]
  buffer_load_dwordx4 v[212:215], v1, s[32:35], s54 offen offset:1024 sc1
  ds_read_b64_tr_b16 v[88:89], v4 offset:30720
  ds_read_b64_tr_b16 v[90:91], v4 offset:30976
  ds_read_b64_tr_b16 v[92:93], v4 offset:31232
  ds_read_b64_tr_b16 v[94:95], v4 offset:31488
  s_waitcnt vmcnt(25) lgkmcnt(14)
  v_mfma_f32_32x32x16_bf16 v[16:31], v[64:67], v[176:179], v[16:31]
  s_waitcnt lgkmcnt(12)
  v_mfma_f32_32x32x16_bf16 v[32:47], v[68:71], v[176:179], v[32:47]
  buffer_load_dwordx4 v[216:219], v1, s[32:35], s54 offen offset:2048 sc1
  ds_read_b64_tr_b16 v[64:65], v4 offset:32768
  ds_read_b64_tr_b16 v[66:67], v4 offset:33024
  ds_read_b64_tr_b16 v[68:69], v4 offset:33280
  ds_read_b64_tr_b16 v[70:71], v4 offset:33536
  s_waitcnt vmcnt(25) lgkmcnt(14)
  v_mfma_f32_32x32x16_bf16 v[16:31], v[72:75], v[180:183], v[16:31]
  s_waitcnt lgkmcnt(12)
  v_mfma_f32_32x32x16_bf16 v[32:47], v[76:79], v[180:183], v[32:47]
  buffer_load_dwordx4 v[220:223], v1, s[32:35], s54 offen offset:3072 sc1
  ds_read_b64_tr_b16 v[72:73], v4 offset:34816
  ds_read_b64_tr_b16 v[74:75], v4 offset:35072
  ds_read_b64_tr_b16 v[76:77], v4 offset:35328
  ds_read_b64_tr_b16 v[78:79], v4 offset:35584
  s_waitcnt vmcnt(25) lgkmcnt(14)
  v_mfma_f32_32x32x16_bf16 v[16:31], v[80:83], v[184:187], v[16:31]
  s_waitcnt lgkmcnt(12)
  v_mfma_f32_32x32x16_bf16 v[32:47], v[84:87], v[184:187], v[32:47]
  s_xor_b32 s54, s55, 24576
  buffer_load_dwordx4 v[224:227], v1, s[32:35], s54 offen offset:0 sc1
  ds_read_b64_tr_b16 v[80:81], v4 offset:36864
  ds_read_b64_tr_b16 v[82:83], v4 offset:37120
  ds_read_b64_tr_b16 v[84:85], v4 offset:37376
  ds_read_b64_tr_b16 v[86:87], v4 offset:37632
  s_waitcnt vmcnt(25) lgkmcnt(14)
  v_mfma_f32_32x32x16_bf16 v[16:31], v[88:91], v[188:191], v[16:31]
  s_waitcnt lgkmcnt(12)
  v_mfma_f32_32x32x16_bf16 v[32:47], v[92:95], v[188:191], v[32:47]
  buffer_load_dwordx4 v[228:231], v1, s[32:35], s54 offen offset:1024 sc1
  ds_read_b64_tr_b16 v[88:89], v4 offset:38912
  ds_read_b64_tr_b16 v[90:91], v4 offset:39168
  ds_read_b64_tr_b16 v[92:93], v4 offset:39424
  ds_read_b64_tr_b16 v[94:95], v4 offset:39680
  s_waitcnt vmcnt(9) lgkmcnt(14)
  v_mfma_f32_32x32x16_bf16 v[16:31], v[64:67], v[192:195], v[16:31]
  s_waitcnt lgkmcnt(12)
  v_mfma_f32_32x32x16_bf16 v[32:47], v[68:71], v[192:195], v[32:47]
  buffer_load_dwordx4 v[232:235], v1, s[32:35], s54 offen offset:2048 sc1
  ds_read_b64_tr_b16 v[64:65], v4 offset:40960
  ds_read_b64_tr_b16 v[66:67], v4 offset:41216
  ds_read_b64_tr_b16 v[68:69], v4 offset:41472
  ds_read_b64_tr_b16 v[70:71], v4 offset:41728
  s_waitcnt vmcnt(9) lgkmcnt(14)
  v_mfma_f32_32x32x16_bf16 v[16:31], v[72:75], v[196:199], v[16:31]
  s_waitcnt lgkmcnt(12)
  v_mfma_f32_32x32x16_bf16 v[32:47], v[76:79], v[196:199], v[32:47]
  buffer_load_dwordx4 v[236:239], v1, s[32:35], s54 offen offset:3072 sc1
  ds_read_b64_tr_b16 v[72:73], v4 offset:43008
  ds_read_b64_tr_b16 v[74:75], v4 offset:43264
  ds_read_b64_tr_b16 v[76:77], v4 offset:43520
  ds_read_b64_tr_b16 v[78:79], v4 offset:43776
  s_waitcnt vmcnt(9) lgkmcnt(14)
  v_mfma_f32_32x32x16_bf16 v[16:31], v[80:83], v[200:203], v[16:31]
  s_waitcnt lgkmcnt(12)
  v_mfma_f32_32x32x16_bf16 v[32:47], v[84:87], v[200:203], v[32:47]
  s_xor_b32 s54, s55, 28672
  buffer_load_dwordx4 v[240:243], v1, s[32:35], s54 offen offset:0 sc1
  ds_read_b64_tr_b16 v[80:81], v4 offset:45056
  ds_read_b64_tr_b16 v[82:83], v4 offset:45312
  ds_read_b64_tr_b16 v[84:85], v4 offset:45568
  ds_read_b64_tr_b16 v[86:87], v4 offset:45824
  v_add_f32 v96, v96, v104
  v_add_f32 v97, v97, v105
  v_add_f32 v98, v98, v106
  v_add_f32 v99, v99, v107
  v_add_f32 v100, v100, v108
  v_add_f32 v101, v101, v109
  v_add_f32 v102, v102, v110
  s_waitcnt vmcnt(9) lgkmcnt(14)
  v_mfma_f32_32x32x16_bf16 v[16:31], v[88:91], v[204:207], v[16:31]
  s_waitcnt lgkmcnt(12)
  v_mfma_f32_32x32x16_bf16 v[32:47], v[92:95], v[204:207], v[32:47]
  buffer_load_dwordx4 v[244:247], v1, s[32:35], s54 offen offset:1024 sc1
  ds_read_b64_tr_b16 v[88:89], v4 offset:47104
  ds_read_b64_tr_b16 v[90:91], v4 offset:47360
  ds_read_b64_tr_b16 v[92:93], v4 offset:47616
  ds_read_b64_tr_b16 v[94:95], v4 offset:47872
  v_add_f32 v103, v103, v111
  v_add_f32 v96, v96, v100
  v_add_f32 v97, v97, v101
  v_add_f32 v98, v98, v102
  v_add_f32 v99, v99, v103
  v_add_f32 v96, v96, v98
  s_waitcnt vmcnt(9) lgkmcnt(14)
  v_mfma_f32_32x32x16_bf16 v[16:31], v[64:67], v[208:211], v[16:31]
  s_waitcnt lgkmcnt(12)
  v_mfma_f32_32x32x16_bf16 v[32:47], v[68:71], v[208:211], v[32:47]
  buffer_load_dwordx4 v[248:251], v1, s[32:35], s54 offen offset:2048 sc1
  v_add_f32 v97, v97, v99
  v_add_f32 v96, v96, v97
  v_mov_b32 v97, v96
  s_nop 0
  s_nop 0
  v_permlane32_swap_b32 v96, v97
  s_waitcnt vmcnt(9) lgkmcnt(10)
  v_mfma_f32_32x32x16_bf16 v[16:31], v[72:75], v[212:215], v[16:31]
  s_waitcnt lgkmcnt(8)
  ds_read_b64_tr_b16 v[64:65], v4 offset:49152
  ds_read_b64_tr_b16 v[66:67], v4 offset:49408
  ds_read_b64_tr_b16 v[68:69], v4 offset:49664
  ds_read_b64_tr_b16 v[70:71], v4 offset:49920
  v_mfma_f32_32x32x16_bf16 v[32:47], v[76:79], v[212:215], v[32:47]
  buffer_load_dwordx4 v[252:255], v1, s[32:35], s54 offen offset:3072 sc1
  s_mov_b32 s99, 0x3b000000
  v_mul_f32 v96, 0xbb000000, v96
  v_mul_f32 v98, v96, v96
  v_fma_f32 v97, v97, s99, -v98
  v_cvt_pk_bf16_f32 v112, v96, v96
  v_max_f32 v97, 0, v97
  s_waitcnt vmcnt(9) lgkmcnt(10)
  v_mfma_f32_32x32x16_bf16 v[16:31], v[80:83], v[216:219], v[16:31]
  s_waitcnt lgkmcnt(8)
  ds_read_b64_tr_b16 v[72:73], v4 offset:51200
  ds_read_b64_tr_b16 v[74:75], v4 offset:51456
  ds_read_b64_tr_b16 v[76:77], v4 offset:51712
  ds_read_b64_tr_b16 v[78:79], v4 offset:51968
  v_mfma_f32_32x32x16_bf16 v[32:47], v[84:87], v[216:219], v[32:47]
  s_lshl_b32 s96, s4, 4
  s_add_u32 s96, s96, s5
  s_lshl_b32 s96, s96, 2
  s_add_u32 s96, s96, s6
  s_lshl_b32 s96, s96, 9
  s_add_u32 s96, s96, 20971520
  v_and_b32 v14, 0x180, v1
  s_waitcnt vmcnt(8) lgkmcnt(10)
  v_mfma_f32_32x32x16_bf16 v[16:31], v[88:91], v[220:223], v[16:31]
  s_waitcnt lgkmcnt(8)
  buffer_load_dword v14, v14, s[28:31], s96 offen sc1
  ds_read_b64_tr_b16 v[80:81], v4 offset:53248
  ds_read_b64_tr_b16 v[82:83], v4 offset:53504
  ds_read_b64_tr_b16 v[84:85], v4 offset:53760
  ds_read_b64_tr_b16 v[86:87], v4 offset:54016
  v_mfma_f32_32x32x16_bf16 v[32:47], v[92:95], v[220:223], v[32:47]
  ds_read_b64_tr_b16 v[88:89], v4 offset:55296
  ds_read_b64_tr_b16 v[90:91], v4 offset:55552
  ds_read_b64_tr_b16 v[92:93], v4 offset:55808
  ds_read_b64_tr_b16 v[94:95], v4 offset:56064
  v_add_f32 v98, 0x3727c5ac, v97
  v_rsq_f32 v122, v98
  v_lshlrev_b32 v99, 16, v112
  v_sub_f32 v99, v96, v99
  v_mul_f32 v97, v97, v122
  s_waitcnt vmcnt(8) lgkmcnt(14)
  v_mfma_f32_32x32x16_bf16 v[16:31], v[64:67], v[224:227], v[16:31]
  s_waitcnt lgkmcnt(12)
  v_mfma_f32_32x32x16_bf16 v[32:47], v[68:71], v[224:227], v[32:47]
  ds_read_b64_tr_b16 v[64:65], v4 offset:57344
  ds_read_b64_tr_b16 v[66:67], v4 offset:57600
  ds_read_b64_tr_b16 v[68:69], v4 offset:57856
  ds_read_b64_tr_b16 v[70:71], v4 offset:58112
  v_mul_f32 v97, v97, v122
  v_add_f32 v97, 0x3727c5ac, v97
  v_rsq_f32 v97, v97
  v_mov_b32 v114, v112
  v_mul_f32 v122, v97, v122
  v_rcp_f32 v120, v122
  s_waitcnt vmcnt(7) lgkmcnt(14)
  v_mfma_f32_32x32x16_bf16 v[16:31], v[72:75], v[228:231], v[16:31]
  s_waitcnt lgkmcnt(12)
  v_mfma_f32_32x32x16_bf16 v[32:47], v[76:79], v[228:231], v[32:47]
  ds_read_b64_tr_b16 v[72:73], v4 offset:59392
  ds_read_b64_tr_b16 v[74:75], v4 offset:59648
  ds_read_b64_tr_b16 v[76:77], v4 offset:59904
  ds_read_b64_tr_b16 v[78:79], v4 offset:60160
  v_cvt_pk_bf16_f32 v113, v99, v120
  v_and_b32 v96, 0xffff0000, v113
  v_sub_f32 v96, v120, v96
  v_cvt_pk_bf16_f32 v115, v99, v96
  v_mul_f32 v116, 0xc0135761, v122
  v_mul_f32 v118, v122, v122
  s_waitcnt vmcnt(6) lgkmcnt(14)
  v_mfma_f32_32x32x16_bf16 v[16:31], v[80:83], v[232:235], v[16:31]
  s_waitcnt lgkmcnt(12)
  v_mfma_f32_32x32x16_bf16 v[32:47], v[84:87], v[232:235], v[32:47]
  ds_read_b64_tr_b16 v[80:81], v4 offset:61440
  ds_read_b64_tr_b16 v[82:83], v4 offset:61696
  ds_read_b64_tr_b16 v[84:85], v4 offset:61952
  ds_read_b64_tr_b16 v[86:87], v4 offset:62208
  v_mul_f32 v118, v118, v116
  v_mul_f32 v118, 0x3d372713, v118
  s_waitcnt vmcnt(5) lgkmcnt(14)
  v_mfma_f32_32x32x16_bf16 v[16:31], v[88:91], v[236:239], v[16:31]
  s_waitcnt lgkmcnt(12)
  v_mfma_f32_32x32x16_bf16 v[32:47], v[92:95], v[236:239], v[32:47]
  ds_read_b64_tr_b16 v[88:89], v4 offset:63488
  ds_read_b64_tr_b16 v[90:91], v4 offset:63744
  ds_read_b64_tr_b16 v[92:93], v4 offset:64000
  ds_read_b64_tr_b16 v[94:95], v4 offset:64256
  s_waitcnt vmcnt(4) lgkmcnt(14)
  v_mfma_f32_32x32x16_bf16 v[16:31], v[64:67], v[240:243], v[16:31]
  s_waitcnt lgkmcnt(12)
  v_mfma_f32_32x32x16_bf16 v[32:47], v[68:71], v[240:243], v[32:47]
  ds_read_b128 v[64:67], v15 offset:0
  ds_read_b128 v[68:71], v15 offset:1024
  s_waitcnt vmcnt(3) lgkmcnt(12)
  v_mfma_f32_32x32x16_bf16 v[16:31], v[72:75], v[244:247], v[16:31]
  s_waitcnt lgkmcnt(10)
  v_mfma_f32_32x32x16_bf16 v[32:47], v[76:79], v[244:247], v[32:47]
  s_waitcnt vmcnt(2) lgkmcnt(8)
  v_mfma_f32_32x32x16_bf16 v[16:31], v[80:83], v[248:251], v[16:31]
  s_waitcnt lgkmcnt(6)
  v_mfma_f32_32x32x16_bf16 v[32:47], v[84:87], v[248:251], v[32:47]
  s_waitcnt vmcnt(1) lgkmcnt(4)
  v_mfma_f32_32x32x16_bf16 v[16:31], v[88:91], v[252:255], v[16:31]
  s_waitcnt lgkmcnt(2)
  v_mfma_f32_32x32x16_bf16 v[32:47], v[92:95], v[252:255], v[32:47]
  s_waitcnt lgkmcnt(1)
  v_mfma_f32_32x32x16_bf16 v[16:31], v[64:67], v[112:115], v[16:31]
  s_waitcnt lgkmcnt(0)
  v_mfma_f32_32x32x16_bf16 v[32:47], v[68:71], v[112:115], v[32:47]
  s_nop 9
  v_pk_mul_f32 v[124:125], v[16:17], v[16:17]
  v_pk_mul_f32 v[126:127], v[18:19], v[18:19]
  v_pk_fma_f32 v[124:125], v[124:125], v[118:119], v[116:117] op_sel_hi:[1,0,0]
  v_pk_fma_f32 v[126:127], v[126:127], v[118:119], v[116:117] op_sel_hi:[1,0,0]
  v_pk_mul_f32 v[124:125], v[124:125], v[16:17]
  v_pk_mul_f32 v[126:127], v[126:127], v[18:19]
  v_exp_f32 v124, v124
  v_exp_f32 v125, v125
  v_exp_f32 v126, v126
  v_exp_f32 v127, v127
  v_pk_fma_f32 v[124:125], v[124:125], v[120:121], v[120:121] op_sel_hi:[1,0,0]
  v_pk_fma_f32 v[126:127], v[126:127], v[120:121], v[120:121] op_sel_hi:[1,0,0]
  v_rcp_f32 v124, v124
  v_rcp_f32 v125, v125
  v_rcp_f32 v126, v126
  v_rcp_f32 v127, v127
  v_pk_mul_f32 v[16:17], v[16:17], v[124:125]
  v_pk_mul_f32 v[18:19], v[18:19], v[126:127]
  v_cvt_pk_bf16_f32 v16, v16, v17
  v_cvt_pk_bf16_f32 v17, v18, v19
  v_pk_mul_f32 v[124:125], v[20:21], v[20:21]
  v_pk_mul_f32 v[126:127], v[22:23], v[22:23]
  v_pk_fma_f32 v[124:125], v[124:125], v[118:119], v[116:117] op_sel_hi:[1,0,0]
  v_pk_fma_f32 v[126:127], v[126:127], v[118:119], v[116:117] op_sel_hi:[1,0,0]
  v_pk_mul_f32 v[124:125], v[124:125], v[20:21]
  v_pk_mul_f32 v[126:127], v[126:127], v[22:23]
  v_exp_f32 v124, v124
  v_exp_f32 v125, v125
  v_exp_f32 v126, v126
  v_exp_f32 v127, v127
  v_pk_fma_f32 v[124:125], v[124:125], v[120:121], v[120:121] op_sel_hi:[1,0,0]
  v_pk_fma_f32 v[126:127], v[126:127], v[120:121], v[120:121] op_sel_hi:[1,0,0]
  v_rcp_f32 v124, v124
  v_rcp_f32 v125, v125
  v_rcp_f32 v126, v126
  v_rcp_f32 v127, v127
  v_pk_mul_f32 v[20:21], v[20:21], v[124:125]
  v_pk_mul_f32 v[22:23], v[22:23], v[126:127]
  v_cvt_pk_bf16_f32 v18, v20, v21
  v_cvt_pk_bf16_f32 v19, v22, v23
  v_pk_mul_f32 v[124:125], v[24:25], v[24:25]
  v_pk_mul_f32 v[126:127], v[26:27], v[26:27]
  v_pk_fma_f32 v[124:125], v[124:125], v[118:119], v[116:117] op_sel_hi:[1,0,0]
  v_pk_fma_f32 v[126:127], v[126:127], v[118:119], v[116:117] op_sel_hi:[1,0,0]
  v_pk_mul_f32 v[124:125], v[124:125], v[24:25]
  v_pk_mul_f32 v[126:127], v[126:127], v[26:27]
  v_exp_f32 v124, v124
  v_exp_f32 v125, v125
  v_exp_f32 v126, v126
  v_exp_f32 v127, v127
  v_pk_fma_f32 v[124:125], v[124:125], v[120:121], v[120:121] op_sel_hi:[1,0,0]
  v_pk_fma_f32 v[126:127], v[126:127], v[120:121], v[120:121] op_sel_hi:[1,0,0]
  v_rcp_f32 v124, v124
  v_rcp_f32 v125, v125
  v_rcp_f32 v126, v126
  v_rcp_f32 v127, v127
  v_pk_mul_f32 v[24:25], v[24:25], v[124:125]
  v_pk_mul_f32 v[26:27], v[26:27], v[126:127]
  v_cvt_pk_bf16_f32 v20, v24, v25
  v_cvt_pk_bf16_f32 v21, v26, v27
  v_pk_mul_f32 v[124:125], v[28:29], v[28:29]
  v_pk_mul_f32 v[126:127], v[30:31], v[30:31]
  v_pk_fma_f32 v[124:125], v[124:125], v[118:119], v[116:117] op_sel_hi:[1,0,0]
  v_pk_fma_f32 v[126:127], v[126:127], v[118:119], v[116:117] op_sel_hi:[1,0,0]
  v_pk_mul_f32 v[124:125], v[124:125], v[28:29]
  v_pk_mul_f32 v[126:127], v[126:127], v[30:31]
  v_exp_f32 v124, v124
  v_exp_f32 v125, v125
  v_exp_f32 v126, v126
  v_exp_f32 v127, v127
  v_pk_fma_f32 v[124:125], v[124:125], v[120:121], v[120:121] op_sel_hi:[1,0,0]
  v_pk_fma_f32 v[126:127], v[126:127], v[120:121], v[120:121] op_sel_hi:[1,0,0]
  v_rcp_f32 v124, v124
  v_rcp_f32 v125, v125
  v_rcp_f32 v126, v126
  v_rcp_f32 v127, v127
  v_pk_mul_f32 v[28:29], v[28:29], v[124:125]
  v_pk_mul_f32 v[30:31], v[30:31], v[126:127]
  v_cvt_pk_bf16_f32 v22, v28, v29
  v_cvt_pk_bf16_f32 v23, v30, v31
  buffer_store_dwordx4 v[16:19], v1, s[28:31], s57 offen offset:0 sc1
  ds_read_b64_tr_b16 v[64:65], v5 offset:0
  ds_read_b64_tr_b16 v[66:67], v5 offset:256
  ds_read_b64_tr_b16 v[68:69], v5 offset:2048
  ds_read_b64_tr_b16 v[70:71], v5 offset:2304
  ds_read_b64_tr_b16 v[72:73], v5 offset:4096
  ds_read_b64_tr_b16 v[74:75], v5 offset:4352
  ds_read_b64_tr_b16 v[76:77], v5 offset:6144
  ds_read_b64_tr_b16 v[78:79], v5 offset:6400
  ds_read_b64_tr_b16 v[80:81], v5 offset:8192
  ds_read_b64_tr_b16 v[82:83], v5 offset:8448
  ds_read_b64_tr_b16 v[84:85], v5 offset:10240
  ds_read_b64_tr_b16 v[86:87], v5 offset:10496
  buffer_store_dwordx4 v[20:23], v1, s[28:31], s57 offen offset:1024 sc1
  ds_read_b64_tr_b16 v[88:89], v5 offset:12288
  ds_read_b64_tr_b16 v[90:91], v5 offset:12544
  s_waitcnt lgkmcnt(10)
  v_mfma_f32_32x32x16_bf16 v[48:63], v[64:67], v[128:131], 0
  ds_read_b64_tr_b16 v[92:93], v5 offset:14336
  ds_read_b64_tr_b16 v[94:95], v5 offset:14592
  v_mul_f32 v124, v32, v32
  v_mfma_f32_32x32x16_bf16 v[48:63], v[68:71], v[132:135], v[48:63]
  s_waitcnt lgkmcnt(8)
  ds_read_b64_tr_b16 v[64:65], v5 offset:16384
  ds_read_b64_tr_b16 v[66:67], v5 offset:16640
  v_mul_f32 v125, v33, v33
  v_mul_f32 v126, v34, v34
  v_mul_f32 v127, v35, v35
  v_mfma_f32_32x32x16_bf16 v[48:63], v[72:75], v[136:139], v[48:63]
  ds_read_b64_tr_b16 v[68:69], v5 offset:18432
  ds_read_b64_tr_b16 v[70:71], v5 offset:18688
  v_fma_f32 v124, v124, v118, v116
  v_fma_f32 v125, v125, v118, v116
  v_fma_f32 v126, v126, v118, v116
  v_fma_f32 v127, v127, v118, v116
  v_mfma_f32_32x32x16_bf16 v[48:63], v[76:79], v[140:143], v[48:63]
  s_waitcnt lgkmcnt(8)
  ds_read_b64_tr_b16 v[72:73], v5 offset:20480
  ds_read_b64_tr_b16 v[74:75], v5 offset:20736
  v_mul_f32 v124, v124, v32
  v_mul_f32 v125, v125, v33
  v_mul_f32 v126, v126, v34
  v_mul_f32 v127, v127, v35
  v_mfma_f32_32x32x16_bf16 v[48:63], v[80:83], v[144:147], v[48:63]
  ds_read_b64_tr_b16 v[76:77], v5 offset:22528
  ds_read_b64_tr_b16 v[78:79], v5 offset:22784
  v_exp_f32 v124, v124
  v_exp_f32 v125, v125
  v_exp_f32 v126, v126
  v_exp_f32 v127, v127
  v_mfma_f32_32x32x16_bf16 v[48:63], v[84:87], v[148:151], v[48:63]
  s_waitcnt lgkmcnt(8)
  ds_read_b64_tr_b16 v[80:81], v5 offset:24576
  ds_read_b64_tr_b16 v[82:83], v5 offset:24832
  v_fma_f32 v124, v124, v120, v120
  v_fma_f32 v125, v125, v120, v120
  v_fma_f32 v126, v126, v120, v120
  v_mfma_f32_32x32x16_bf16 v[48:63], v[88:91], v[152:155], v[48:63]
  ds_read_b64_tr_b16 v[84:85], v5 offset:26624
  ds_read_b64_tr_b16 v[86:87], v5 offset:26880
  v_fma_f32 v127, v127, v120, v120
  v_rcp_f32 v124, v124
  v_rcp_f32 v125, v125
  v_rcp_f32 v126, v126
  v_mfma_f32_32x32x16_bf16 v[48:63], v[92:95], v[156:159], v[48:63]
  s_waitcnt lgkmcnt(8)
  ds_read_b64_tr_b16 v[88:89], v5 offset:28672
  ds_read_b64_tr_b16 v[90:91], v5 offset:28928
  v_rcp_f32 v127, v127
  v_mul_f32 v32, v32, v124
  v_mul_f32 v33, v33, v125
  v_mul_f32 v34, v34, v126
  v_mfma_f32_32x32x16_bf16 v[48:63], v[64:67], v[160:163], v[48:63]
  ds_read_b64_tr_b16 v[92:93], v5 offset:30720
  ds_read_b64_tr_b16 v[94:95], v5 offset:30976
  v_mul_f32 v35, v35, v127
  v_cvt_pk_bf16_f32 v32, v32, v33
  v_cvt_pk_bf16_f32 v33, v34, v35
  v_mul_f32 v124, v36, v36
  v_mfma_f32_32x32x16_bf16 v[48:63], v[68:71], v[164:167], v[48:63]
  s_waitcnt lgkmcnt(8)
  ds_read_b64_tr_b16 v[64:65], v5 offset:32768
  ds_read_b64_tr_b16 v[66:67], v5 offset:33024
  v_mul_f32 v125, v37, v37
  v_mul_f32 v126, v38, v38
  v_mul_f32 v127, v39, v39
  v_fma_f32 v124, v124, v118, v116
  v_mfma_f32_32x32x16_bf16 v[48:63], v[72:75], v[168:171], v[48:63]
  ds_read_b64_tr_b16 v[68:69], v5 offset:34816
  ds_read_b64_tr_b16 v[70:71], v5 offset:35072
  v_fma_f32 v125, v125, v118, v116
  v_fma_f32 v126, v126, v118, v116
  v_fma_f32 v127, v127, v118, v116
  v_mul_f32 v124, v124, v36
  v_mfma_f32_32x32x16_bf16 v[48:63], v[76:79], v[172:175], v[48:63]
  s_waitcnt lgkmcnt(8)
  ds_read_b64_tr_b16 v[72:73], v5 offset:36864
  ds_read_b64_tr_b16 v[74:75], v5 offset:37120
  v_mul_f32 v125, v125, v37
  v_mul_f32 v126, v126, v38
  v_mul_f32 v127, v127, v39
  v_mfma_f32_32x32x16_bf16 v[48:63], v[80:83], v[176:179], v[48:63]
  ds_read_b64_tr_b16 v[76:77], v5 offset:38912
  ds_read_b64_tr_b16 v[78:79], v5 offset:39168
  v_exp_f32 v124, v124
  v_exp_f32 v125, v125
  v_exp_f32 v126, v126
  v_exp_f32 v127, v127
  v_mfma_f32_32x32x16_bf16 v[48:63], v[84:87], v[180:183], v[48:63]
  s_waitcnt lgkmcnt(8)
  ds_read_b64_tr_b16 v[80:81], v5 offset:40960
  ds_read_b64_tr_b16 v[82:83], v5 offset:41216
  v_fma_f32 v124, v124, v120, v120
  v_fma_f32 v125, v125, v120, v120
  v_fma_f32 v126, v126, v120, v120
  v_fma_f32 v127, v127, v120, v120
  v_mfma_f32_32x32x16_bf16 v[48:63], v[88:91], v[184:187], v[48:63]
  s_waitcnt vmcnt(2)
  v_and_b32 v14, 0x1c0, v1
  v_or_b32 v14, 16711680, v14
  s_cmp_eq_u32 s51, 0
  s_waitcnt vmcnt(0)
  buffer_store_byte_d16_hi v14, v14, s[28:31], s10 offen offset:1024
  v_mov_b32 v14, 20
  s_cbranch_scc1 L131
  buffer_store_dword v14, off, s[28:31], s52
L132:
  v_rcp_f32 v124, v124
  v_rcp_f32 v125, v125
  v_rcp_f32 v126, v126
  v_rcp_f32 v127, v127
  v_mul_f32 v36, v36, v124
  v_mul_f32 v37, v37, v125
  v_mul_f32 v38, v38, v126
  v_mul_f32 v39, v39, v127
  v_cvt_pk_bf16_f32 v34, v36, v37
  v_cvt_pk_bf16_f32 v35, v38, v39
  v_mfma_f32_32x32x16_bf16 v[48:63], v[92:95], v[188:191], v[48:63]
  s_waitcnt lgkmcnt(6)
  buffer_store_dwordx4 v[32:35], v1, s[28:31], s57 offen offset:2048 sc1
  ds_read_b64_tr_b16 v[84:85], v5 offset:43008
  ds_read_b64_tr_b16 v[86:87], v5 offset:43264
  ds_read_b64_tr_b16 v[88:89], v5 offset:45056
  ds_read_b64_tr_b16 v[90:91], v5 offset:45312
  v_mul_f32 v124, v40, v40
  v_mul_f32 v125, v41, v41
  v_mul_f32 v126, v42, v42
  v_mfma_f32_32x32x16_bf16 v[48:63], v[64:67], v[192:195], v[48:63]
  s_lshr_b32 s96, s6, 1
  v_mul_f32 v127, v43, v43
  v_fma_f32 v124, v124, v118, v116
  v_fma_f32 v125, v125, v118, v116
  v_fma_f32 v126, v126, v118, v116
  v_fma_f32 v127, v127, v118, v116
  v_mfma_f32_32x32x16_bf16 v[48:63], v[68:71], v[196:199], v[48:63]
  s_waitcnt lgkmcnt(8)
  ds_read_b64_tr_b16 v[92:93], v5 offset:47104
  ds_read_b64_tr_b16 v[94:95], v5 offset:47360
  s_mul_i32 s96, s96, 57344
  v_mul_f32 v124, v124, v40
  v_mul_f32 v125, v125, v41
  v_mul_f32 v126, v126, v42
  v_mul_f32 v127, v127, v43
  v_exp_f32 v124, v124
  v_mfma_f32_32x32x16_bf16 v[48:63], v[72:75], v[200:203], v[48:63]
  s_waitcnt lgkmcnt(8)
  ds_read_b64_tr_b16 v[64:65], v5 offset:49152
  ds_read_b64_tr_b16 v[66:67], v5 offset:49408
  s_and_b32 s97, s6, 1
  v_exp_f32 v125, v125
  v_exp_f32 v126, v126
  v_exp_f32 v127, v127
  v_fma_f32 v124, v124, v120, v120
  v_fma_f32 v125, v125, v120, v120
  v_mfma_f32_32x32x16_bf16 v[48:63], v[76:79], v[204:207], v[48:63]
  s_waitcnt lgkmcnt(8)
  ds_read_b64_tr_b16 v[68:69], v5 offset:51200
  ds_read_b64_tr_b16 v[70:71], v5 offset:51456
  s_lshl_b32 s97, s97, 10
  v_fma_f32 v126, v126, v120, v120
  v_fma_f32 v127, v127, v120, v120
  v_rcp_f32 v124, v124
  v_rcp_f32 v125, v125
  v_mfma_f32_32x32x16_bf16 v[48:63], v[80:83], v[208:211], v[48:63]
  s_waitcnt lgkmcnt(8)
  ds_read_b64_tr_b16 v[72:73], v5 offset:53248
  ds_read_b64_tr_b16 v[74:75], v5 offset:53504
  s_add_u32 s96, s96, s97
  v_rcp_f32 v126, v126
  v_rcp_f32 v127, v127
  v_mul_f32 v40, v40, v124
  v_mul_f32 v41, v41, v125
  v_mul_f32 v42, v42, v126
  v_mfma_f32_32x32x16_bf16 v[48:63], v[84:87], v[212:215], v[48:63]
  s_waitcnt lgkmcnt(8)
  ds_read_b64_tr_b16 v[76:77], v5 offset:55296
  ds_read_b64_tr_b16 v[78:79], v5 offset:55552
  s_add_u32 s96, s96, 33554432
  v_mul_f32 v43, v43, v127
  v_cvt_pk_bf16_f32 v36, v40, v41
  v_cvt_pk_bf16_f32 v37, v42, v43
  v_mul_f32 v124, v44, v44
  v_mfma_f32_32x32x16_bf16 v[48:63], v[88:91], v[216:219], v[48:63]
  s_waitcnt lgkmcnt(8)
  ds_read_b64_tr_b16 v[80:81], v5 offset:57344
  ds_read_b64_tr_b16 v[82:83], v5 offset:57600
  s_lshl_b32 s59, s49, 17
  v_mul_f32 v125, v45, v45
  v_mul_f32 v126, v46, v46
  v_mul_f32 v127, v47, v47
  v_fma_f32 v124, v124, v118, v116
  v_fma_f32 v125, v125, v118, v116
  v_mfma_f32_32x32x16_bf16 v[48:63], v[92:95], v[220:223], v[48:63]
  s_waitcnt lgkmcnt(8)
  ds_read_b64_tr_b16 v[84:85], v5 offset:59392
  ds_read_b64_tr_b16 v[86:87], v5 offset:59648
  s_xor_b32 s63, s59, 0x20000
  v_fma_f32 v126, v126, v118, v116
  v_fma_f32 v127, v127, v118, v116
  v_mul_f32 v124, v124, v44
  v_mul_f32 v125, v125, v45
  v_mul_f32 v126, v126, v46
  v_mfma_f32_32x32x16_bf16 v[48:63], v[64:67], v[224:227], v[48:63]
  s_waitcnt lgkmcnt(8)
  ds_read_b64_tr_b16 v[88:89], v5 offset:61440
  ds_read_b64_tr_b16 v[90:91], v5 offset:61696
  s_add_u32 s59, s59, s96
  v_mul_f32 v127, v127, v47
  v_exp_f32 v124, v124
  v_exp_f32 v125, v125
  v_exp_f32 v126, v126
  v_exp_f32 v127, v127
  v_mfma_f32_32x32x16_bf16 v[48:63], v[68:71], v[228:231], v[48:63]
  s_waitcnt lgkmcnt(8)
  ds_read_b64_tr_b16 v[92:93], v5 offset:63488
  ds_read_b64_tr_b16 v[94:95], v5 offset:63744
  s_add_u32 s63, s63, s96
  v_fma_f32 v124, v124, v120, v120
  v_fma_f32 v125, v125, v120, v120
  v_fma_f32 v126, v126, v120, v120
  v_fma_f32 v127, v127, v120, v120
  v_mfma_f32_32x32x16_bf16 v[48:63], v[72:75], v[232:235], v[48:63]
  s_waitcnt lgkmcnt(8)
  ds_read_b128 v[64:67], v15 offset:2048
  v_rcp_f32 v124, v124
  v_rcp_f32 v125, v125
  v_rcp_f32 v126, v126
  v_mfma_f32_32x32x16_bf16 v[48:63], v[76:79], v[236:239], v[48:63]
  s_waitcnt lgkmcnt(5)
  ds_read_b64_tr_b16 v[68:69], v5 offset:512
  ds_read_b64_tr_b16 v[70:71], v5 offset:768
  ds_read_b64_tr_b16 v[72:73], v5 offset:2560
  ds_read_b64_tr_b16 v[74:75], v5 offset:2816
  v_rcp_f32 v127, v127
  v_mul_f32 v44, v44, v124
  v_mul_f32 v45, v45, v125
  v_mul_f32 v46, v46, v126
  v_mfma_f32_32x32x16_bf16 v[48:63], v[80:83], v[240:243], v[48:63]
  v_mul_f32 v47, v47, v127
  v_cvt_pk_bf16_f32 v38, v44, v45
  v_cvt_pk_bf16_f32 v39, v46, v47
  v_mfma_f32_32x32x16_bf16 v[48:63], v[84:87], v[244:247], v[48:63]
  s_waitcnt lgkmcnt(5)
  buffer_store_dwordx4 v[36:39], v1, s[28:31], s57 offen offset:3072 sc1
  ds_read_b64_tr_b16 v[76:77], v5 offset:4608
  ds_read_b64_tr_b16 v[78:79], v5 offset:4864
  ds_read_b64_tr_b16 v[80:81], v5 offset:6656
  ds_read_b64_tr_b16 v[82:83], v5 offset:6912
  v_mfma_f32_32x32x16_bf16 v[48:63], v[88:91], v[248:251], v[48:63]
  ds_read_b64_tr_b16 v[84:85], v5 offset:8704
  ds_read_b64_tr_b16 v[86:87], v5 offset:8960
  v_mfma_f32_32x32x16_bf16 v[48:63], v[92:95], v[252:255], v[48:63]
  s_waitcnt lgkmcnt(10)
  ds_read_b64_tr_b16 v[88:89], v5 offset:10752
  ds_read_b64_tr_b16 v[90:91], v5 offset:11008
  v_mfma_f32_32x32x16_bf16 v[48:63], v[64:67], v[112:115], v[48:63]
  s_waitcnt lgkmcnt(8)
  ds_read_b64_tr_b16 v[92:93], v5 offset:12800
  ds_read_b64_tr_b16 v[94:95], v5 offset:13056
  v_mfma_f32_32x32x16_bf16 v[16:31], v[68:71], v[128:131], 0
  s_buffer_load_dwordx4 s[44:47], s[28:31], s37 offset:5120
  s_nop 6
  v_mul_f32 v124, v48, v48
  v_mfma_f32_32x32x16_bf16 v[16:31], v[72:75], v[132:135], v[16:31]
  s_waitcnt lgkmcnt(6)
  ds_read_b64_tr_b16 v[64:65], v5 offset:14848
  ds_read_b64_tr_b16 v[66:67], v5 offset:15104
  ds_read_b64_tr_b16 v[68:69], v5 offset:16896
  ds_read_b64_tr_b16 v[70:71], v5 offset:17152
  v_mul_f32 v125, v49, v49
  v_mul_f32 v126, v50, v50
  v_mul_f32 v127, v51, v51
  v_mfma_f32_32x32x16_bf16 v[16:31], v[76:79], v[136:139], v[16:31]
  ds_read_b64_tr_b16 v[72:73], v5 offset:18944
  ds_read_b64_tr_b16 v[74:75], v5 offset:19200
  v_fma_f32 v124, v124, v118, v116
  v_fma_f32 v125, v125, v118, v116
  v_fma_f32 v126, v126, v118, v116
  v_fma_f32 v127, v127, v118, v116
  v_mfma_f32_32x32x16_bf16 v[16:31], v[80:83], v[140:143], v[16:31]
  s_waitcnt lgkmcnt(8)
  ds_read_b64_tr_b16 v[76:77], v5 offset:20992
  ds_read_b64_tr_b16 v[78:79], v5 offset:21248
  v_mul_f32 v124, v124, v48
  v_mul_f32 v125, v125, v49
  v_mul_f32 v126, v126, v50
  v_mfma_f32_32x32x16_bf16 v[16:31], v[84:87], v[144:147], v[16:31]
  ds_read_b64_tr_b16 v[80:81], v5 offset:23040
  ds_read_b64_tr_b16 v[82:83], v5 offset:23296
  v_mul_f32 v127, v127, v51
  v_exp_f32 v124, v124
  v_exp_f32 v125, v125
  v_exp_f32 v126, v126
  v_mfma_f32_32x32x16_bf16 v[16:31], v[88:91], v[148:151], v[16:31]
  s_waitcnt lgkmcnt(8)
  ds_read_b64_tr_b16 v[84:85], v5 offset:25088
  ds_read_b64_tr_b16 v[86:87], v5 offset:25344
  v_exp_f32 v127, v127
  v_fma_f32 v124, v124, v120, v120
  v_fma_f32 v125, v125, v120, v120
  v_fma_f32 v126, v126, v120, v120
  v_mfma_f32_32x32x16_bf16 v[16:31], v[92:95], v[152:155], v[16:31]
  ds_read_b64_tr_b16 v[88:89], v5 offset:27136
  ds_read_b64_tr_b16 v[90:91], v5 offset:27392
  v_fma_f32 v127, v127, v120, v120
  v_rcp_f32 v124, v124
  v_rcp_f32 v125, v125
  v_rcp_f32 v126, v126
  v_mfma_f32_32x32x16_bf16 v[16:31], v[64:67], v[156:159], v[16:31]
  s_waitcnt lgkmcnt(8)
  ds_read_b64_tr_b16 v[92:93], v5 offset:29184
  ds_read_b64_tr_b16 v[94:95], v5 offset:29440
  v_rcp_f32 v127, v127
  v_mul_f32 v48, v48, v124
  v_mul_f32 v49, v49, v125
  v_mfma_f32_32x32x16_bf16 v[16:31], v[68:71], v[160:163], v[16:31]
  s_waitcnt lgkmcnt(0)
  s_or_b32 s47, s47, 0xffff0000
  s_nand_b64 s[44:45], s[44:45], s[46:47]
  s_cbranch_scc1 L133
L134:
  v_mul_f32 v50, v50, v126
  v_mul_f32 v51, v51, v127
  v_cvt_pk_bf16_f32 v48, v48, v49
  v_cvt_pk_bf16_f32 v49, v50, v51
  v_mul_f32 v124, v52, v52
  v_mul_f32 v125, v53, v53
  v_mfma_f32_32x32x16_bf16 v[16:31], v[72:75], v[164:167], v[16:31]
  ds_read_b64_tr_b16 v[64:65], v5 offset:31232
  ds_read_b64_tr_b16 v[66:67], v5 offset:31488
  s_add_u32 s96, s59, 0
  buffer_load_dwordx4 v[128:131], v1, s[28:31], s96 offen sc1
  ds_read_b64_tr_b16 v[68:69], v5 offset:33280
  ds_read_b64_tr_b16 v[70:71], v5 offset:33536
  v_mul_f32 v126, v54, v54
  v_mul_f32 v127, v55, v55
  v_fma_f32 v124, v124, v118, v116
  v_fma_f32 v125, v125, v118, v116
  v_fma_f32 v126, v126, v118, v116
  v_mfma_f32_32x32x16_bf16 v[16:31], v[76:79], v[168:171], v[16:31]
  s_add_u32 s96, s63, 0
  buffer_load_dwordx4 v[132:135], v1, s[28:31], s96 offen sc1
  ds_read_b64_tr_b16 v[72:73], v5 offset:35328
  ds_read_b64_tr_b16 v[74:75], v5 offset:35584
  v_fma_f32 v127, v127, v118, v116
  v_mul_f32 v124, v124, v52
  v_mul_f32 v125, v125, v53
  v_mul_f32 v126, v126, v54
  v_mul_f32 v127, v127, v55
  v_exp_f32 v124, v124
  v_mfma_f32_32x32x16_bf16 v[16:31], v[80:83], v[172:175], v[16:31]
  s_add_u32 s96, s59, 8192
  buffer_load_dwordx4 v[136:139], v1, s[28:31], s96 offen sc1
  ds_read_b64_tr_b16 v[76:77], v5 offset:37376
  ds_read_b64_tr_b16 v[78:79], v5 offset:37632
  v_exp_f32 v125, v125
  v_exp_f32 v126, v126
  v_exp_f32 v127, v127
  v_fma_f32 v124, v124, v120, v120
  v_mfma_f32_32x32x16_bf16 v[16:31], v[84:87], v[176:179], v[16:31]
  s_add_u32 s96, s63, 8192
  buffer_load_dwordx4 v[140:143], v1, s[28:31], s96 offen sc1
  ds_read_b64_tr_b16 v[80:81], v5 offset:39424
  ds_read_b64_tr_b16 v[82:83], v5 offset:39680
  v_fma_f32 v125, v125, v120, v120
  v_fma_f32 v126, v126, v120, v120
  v_fma_f32 v127, v127, v120, v120
  v_rcp_f32 v124, v124
  v_rcp_f32 v125, v125
  v_rcp_f32 v126, v126
  v_mfma_f32_32x32x16_bf16 v[16:31], v[88:91], v[180:183], v[16:31]
  s_add_u32 s96, s59, 16384
  buffer_load_dwordx4 v[144:147], v1, s[28:31], s96 offen sc1
  ds_read_b64_tr_b16 v[84:85], v5 offset:41472
  ds_read_b64_tr_b16 v[86:87], v5 offset:41728
  s_waitcnt lgkmcnt(10)
  v_rcp_f32 v127, v127
  v_mul_f32 v52, v52, v124
  v_mul_f32 v53, v53, v125
  v_mul_f32 v54, v54, v126
  v_mul_f32 v55, v55, v127
  v_mfma_f32_32x32x16_bf16 v[16:31], v[92:95], v[184:187], v[16:31]
  s_add_u32 s96, s63, 16384
  buffer_load_dwordx4 v[148:151], v1, s[28:31], s96 offen sc1
  v_and_b32 v14, 0x1c0, v1
  v_or_b32 v14, 16711680, v14
  s_cmp_eq_u32 s51, 0
  s_waitcnt vmcnt(6)
  buffer_store_byte_d16_hi v14, v14, s[28:31], s10 offen offset:1536
  v_mov_b32 v14, 21
  s_cbranch_scc1 L138
  buffer_store_dword v14, off, s[28:31], s52
L139:
  v_cvt_pk_bf16_f32 v50, v52, v53
  v_cvt_pk_bf16_f32 v51, v54, v55
  v_mul_f32 v124, v56, v56
  v_mul_f32 v125, v57, v57
  v_mul_f32 v126, v58, v58
  v_mul_f32 v127, v59, v59
  v_fma_f32 v124, v124, v118, v116
  v_fma_f32 v125, v125, v118, v116
  v_fma_f32 v126, v126, v118, v116
  v_fma_f32 v127, v127, v118, v116
  v_mul_f32 v124, v124, v56
  v_mfma_f32_32x32x16_bf16 v[16:31], v[64:67], v[188:191], v[16:31]
  s_waitcnt lgkmcnt(6)
  buffer_store_dwordx4 v[48:51], v1, s[28:31], s58 offen offset:0 sc1
  ds_read_b64_tr_b16 v[88:89], v5 offset:43520
  ds_read_b64_tr_b16 v[90:91], v5 offset:43776
  s_add_u32 s96, s59, 24576
  buffer_load_dwordx4 v[152:155], v1, s[28:31], s96 offen sc1
  ds_read_b64_tr_b16 v[92:93], v5 offset:45568
  ds_read_b64_tr_b16 v[94:95], v5 offset:45824
  v_mul_f32 v125, v125, v57
  v_mul_f32 v126, v126, v58
  v_mul_f32 v127, v127, v59
  v_exp_f32 v124, v124
  v_mfma_f32_32x32x16_bf16 v[16:31], v[68:71], v[192:195], v[16:31]
  ds_read_b64_tr_b16 v[64:65], v5 offset:47616
  ds_read_b64_tr_b16 v[66:67], v5 offset:47872
  v_exp_f32 v125, v125
  v_exp_f32 v126, v126
  v_exp_f32 v127, v127
  v_fma_f32 v124, v124, v120, v120
  v_mfma_f32_32x32x16_bf16 v[16:31], v[72:75], v[196:199], v[16:31]
  s_add_u32 s96, s63, 24576
  buffer_load_dwordx4 v[156:159], v1, s[28:31], s96 offen sc1
  ds_read_b64_tr_b16 v[68:69], v5 offset:49664
  ds_read_b64_tr_b16 v[70:71], v5 offset:49920
  s_waitcnt lgkmcnt(10)
  v_fma_f32 v125, v125, v120, v120
  v_fma_f32 v126, v126, v120, v120
  v_fma_f32 v127, v127, v120, v120
  v_rcp_f32 v124, v124
  v_rcp_f32 v125, v125
  v_mfma_f32_32x32x16_bf16 v[16:31], v[76:79], v[200:203], v[16:31]
  ds_read_b64_tr_b16 v[72:73], v5 offset:51712
  ds_read_b64_tr_b16 v[74:75], v5 offset:51968
  v_rcp_f32 v126, v126
  v_rcp_f32 v127, v127
  v_mul_f32 v56, v56, v124
  v_mul_f32 v57, v57, v125
  v_mfma_f32_32x32x16_bf16 v[16:31], v[80:83], v[204:207], v[16:31]
  s_add_u32 s96, s59, 32768
  buffer_load_dwordx4 v[160:163], v1, s[28:31], s96 offen sc1
  ds_read_b64_tr_b16 v[76:77], v5 offset:53760
  ds_read_b64_tr_b16 v[78:79], v5 offset:54016
  s_waitcnt lgkmcnt(10)
  v_mul_f32 v58, v58, v126
  v_mul_f32 v59, v59, v127
  v_cvt_pk_bf16_f32 v52, v56, v57
  v_cvt_pk_bf16_f32 v53, v58, v59
  v_mul_f32 v124, v60, v60
  v_mfma_f32_32x32x16_bf16 v[16:31], v[84:87], v[208:211], v[16:31]
  ds_read_b64_tr_b16 v[80:81], v5 offset:55808
  ds_read_b64_tr_b16 v[82:83], v5 offset:56064
  v_mul_f32 v125, v61, v61
  v_mul_f32 v126, v62, v62
  v_mul_f32 v127, v63, v63
  v_fma_f32 v124, v124, v118, v116
  v_mfma_f32_32x32x16_bf16 v[16:31], v[88:91], v[212:215], v[16:31]
  s_add_u32 s96, s63, 32768
  buffer_load_dwordx4 v[164:167], v1, s[28:31], s96 offen sc1
  ds_read_b64_tr_b16 v[84:85], v5 offset:57856
  ds_read_b64_tr_b16 v[86:87], v5 offset:58112
  s_waitcnt lgkmcnt(10)
  v_fma_f32 v125, v125, v118, v116
  v_fma_f32 v126, v126, v118, v116
  v_fma_f32 v127, v127, v118, v116
  v_mul_f32 v124, v124, v60
  v_mul_f32 v125, v125, v61
  v_mfma_f32_32x32x16_bf16 v[16:31], v[92:95], v[216:219], v[16:31]
  ds_read_b64_tr_b16 v[88:89], v5 offset:59904
  ds_read_b64_tr_b16 v[90:91], v5 offset:60160
  v_mul_f32 v126, v126, v62
  v_mul_f32 v127, v127, v63
  v_exp_f32 v124, v124
  v_exp_f32 v125, v125
  v_mfma_f32_32x32x16_bf16 v[16:31], v[64:67], v[220:223], v[16:31]
  s_add_u32 s96, s59, 40960
  buffer_load_dwordx4 v[168:171], v1, s[28:31], s96 offen sc1
  ds_read_b64_tr_b16 v[92:93], v5 offset:61952
  ds_read_b64_tr_b16 v[94:95], v5 offset:62208
  s_waitcnt lgkmcnt(10)
  v_exp_f32 v126, v126
  v_exp_f32 v127, v127
  v_fma_f32 v124, v124, v120, v120
  v_fma_f32 v125, v125, v120, v120
  v_mfma_f32_32x32x16_bf16 v[16:31], v[68:71], v[224:227], v[16:31]
  ds_read_b64_tr_b16 v[64:65], v5 offset:64000
  ds_read_b64_tr_b16 v[66:67], v5 offset:64256
  v_fma_f32 v126, v126, v120, v120
  v_fma_f32 v127, v127, v120, v120
  v_rcp_f32 v124, v124
  v_rcp_f32 v125, v125
  v_mfma_f32_32x32x16_bf16 v[16:31], v[72:75], v[228:231], v[16:31]
  s_add_u32 s96, s63, 40960
  buffer_load_dwordx4 v[172:175], v1, s[28:31], s96 offen sc1
  s_buffer_load_dwordx4 s[44:47], s[28:31], s37 offset:5632
  v_rcp_f32 v126, v126
  v_rcp_f32 v127, v127
  v_mul_f32 v60, v60, v124
  v_mul_f32 v61, v61, v125
  v_mul_f32 v62, v62, v126
  v_mul_f32 v63, v63, v127
  s_waitcnt lgkmcnt(10)
  v_mfma_f32_32x32x16_bf16 v[16:31], v[76:79], v[232:235], v[16:31]
  s_waitcnt lgkmcnt(8)
  ds_read_b128 v[68:71], v15 offset:3072
  v_cvt_pk_bf16_f32 v54, v60, v61
  v_cvt_pk_bf16_f32 v55, v62, v63
  v_mfma_f32_32x32x16_bf16 v[16:31], v[80:83], v[236:239], v[16:31]
  s_waitcnt lgkmcnt(5)
  buffer_store_dwordx4 v[52:55], v1, s[28:31], s58 offen offset:1024 sc1
  s_add_u32 s96, s59, 49152
  buffer_load_dwordx4 v[176:179], v1, s[28:31], s96 offen sc1
  v_mfma_f32_32x32x16_bf16 v[16:31], v[84:87], v[240:243], v[16:31]
  v_mfma_f32_32x32x16_bf16 v[16:31], v[88:91], v[244:247], v[16:31]
  s_add_u32 s96, s63, 49152
  buffer_load_dwordx4 v[180:183], v1, s[28:31], s96 offen sc1
  s_waitcnt lgkmcnt(1)
  v_mfma_f32_32x32x16_bf16 v[16:31], v[92:95], v[248:251], v[16:31]
  v_mfma_f32_32x32x16_bf16 v[16:31], v[64:67], v[252:255], v[16:31]
  s_waitcnt lgkmcnt(0)
  v_mfma_f32_32x32x16_bf16 v[16:31], v[68:71], v[112:115], v[16:31]
  s_waitcnt vmcnt(17)
  v_mfma_f32_32x32x16_bf16 a[224:239], a[0:3], v[128:131], a[224:239]
  s_or_b32 s47, s47, 0xffff0000
  s_nand_b64 s[44:45], s[44:45], s[46:47]
  s_cbranch_scc1 L140
L141:
  v_mfma_f32_32x32x16_bf16 v[32:47], a[4:7], v[128:131], 0
  s_add_u32 s96, s59, 2048
  buffer_load_dwordx4 v[184:187], v1, s[28:31], s96 offen sc1
  s_nop 3
  v_mul_f32 v124, v16, v16
  v_mul_f32 v125, v17, v17
  v_mul_f32 v126, v18, v18
  v_mul_f32 v127, v19, v19
  v_fma_f32 v124, v124, v118, v116
  v_fma_f32 v125, v125, v118, v116
  s_waitcnt vmcnt(17)
  v_mfma_f32_32x32x16_bf16 v[48:63], a[0:3], v[132:135], 0
  s_add_u32 s96, s63, 2048
  buffer_load_dwordx4 v[188:191], v1, s[28:31], s96 offen sc1
  v_fma_f32 v126, v126, v118, v116
  v_fma_f32 v127, v127, v118, v116
  v_mul_f32 v124, v124, v16
  v_mul_f32 v125, v125, v17
  v_mfma_f32_32x32x16_bf16 v[240:255], a[4:7], v[132:135], 0
  s_add_u32 s96, s59, 10240
  buffer_load_dwordx4 v[192:195], v1, s[28:31], s96 offen sc1
  v_mul_f32 v126, v126, v18
  v_mul_f32 v127, v127, v19
  v_exp_f32 v124, v124
  s_waitcnt vmcnt(18)
  v_mfma_f32_32x32x16_bf16 a[224:239], a[8:11], v[136:139], a[224:239]
  s_add_u32 s96, s63, 10240
  buffer_load_dwordx4 v[196:199], v1, s[28:31], s96 offen sc1
  v_exp_f32 v125, v125
  v_exp_f32 v126, v126
  v_mfma_f32_32x32x16_bf16 v[32:47], a[12:15], v[136:139], v[32:47]
  s_add_u32 s96, s59, 18432
  buffer_load_dwordx4 v[200:203], v1, s[28:31], s96 offen sc1
  v_exp_f32 v127, v127
  v_fma_f32 v124, v124, v120, v120
  v_fma_f32 v125, v125, v120, v120
  s_waitcnt vmcnt(19)
  v_mfma_f32_32x32x16_bf16 v[48:63], a[8:11], v[140:143], v[48:63]
  s_add_u32 s96, s63, 18432
  buffer_load_dwordx4 v[204:207], v1, s[28:31], s96 offen sc1
  v_fma_f32 v126, v126, v120, v120
  v_fma_f32 v127, v127, v120, v120
  v_rcp_f32 v124, v124
  v_mfma_f32_32x32x16_bf16 v[240:255], a[12:15], v[140:143], v[240:255]
  s_add_u32 s96, s59, 26624
  buffer_load_dwordx4 v[208:211], v1, s[28:31], s96 offen sc1
  v_rcp_f32 v125, v125
  v_rcp_f32 v126, v126
  s_waitcnt vmcnt(20)
  v_mfma_f32_32x32x16_bf16 a[224:239], a[16:19], v[144:147], a[224:239]
  v_rcp_f32 v127, v127
  v_mul_f32 v16, v16, v124
  v_mul_f32 v17, v17, v125
  v_mul_f32 v18, v18, v126
  v_mul_f32 v19, v19, v127
  v_mfma_f32_32x32x16_bf16 v[32:47], a[20:23], v[144:147], v[32:47]
  s_add_u32 s96, s63, 26624
  buffer_load_dwordx4 v[212:215], v1, s[28:31], s96 offen sc1
  v_cvt_pk_bf16_f32 v16, v16, v17
  v_cvt_pk_bf16_f32 v17, v18, v19
  v_mul_f32 v124, v20, v20
  v_mul_f32 v125, v21, v21
  s_waitcnt vmcnt(20)
  v_mfma_f32_32x32x16_bf16 v[48:63], a[16:19], v[148:151], v[48:63]
  v_mul_f32 v126, v22, v22
  v_mul_f32 v127, v23, v23
  v_fma_f32 v124, v124, v118, v116
  v_fma_f32 v125, v125, v118, v116
  v_fma_f32 v126, v126, v118, v116
  v_fma_f32 v127, v127, v118, v116
  v_mfma_f32_32x32x16_bf16 v[240:255], a[20:23], v[148:151], v[240:255]
  s_add_u32 s96, s59, 34816
  buffer_load_dwordx4 v[216:219], v1, s[28:31], s96 offen sc1
  v_mul_f32 v124, v124, v20
  v_mul_f32 v125, v125, v21
  v_mul_f32 v126, v126, v22
  v_mul_f32 v127, v127, v23
  s_waitcnt vmcnt(17)
  v_mfma_f32_32x32x16_bf16 a[224:239], a[24:27], v[152:155], a[224:239]
  v_and_b32 v14, 0x1c0, v1
  v_or_b32 v14, 16711680, v14
  s_cmp_eq_u32 s51, 0
  s_waitcnt vmcnt(11)
  buffer_store_byte_d16_hi v14, v14, s[28:31], s10 offen offset:2048
  v_mov_b32 v14, 22
  s_cbranch_scc1 L145
  buffer_store_dword v14, off, s[28:31], s52
L146:
  v_mfma_f32_32x32x16_bf16 v[32:47], a[28:31], v[152:155], v[32:47]
  s_add_u32 s96, s63, 34816
  buffer_load_dwordx4 v[220:223], v1, s[28:31], s96 offen sc1
  v_exp_f32 v124, v124
  v_mfma_f32_32x32x16_bf16 v[48:63], a[24:27], v[156:159], v[48:63]
  v_exp_f32 v125, v125
  v_exp_f32 v126, v126
  v_exp_f32 v127, v127
  v_mfma_f32_32x32x16_bf16 v[240:255], a[28:31], v[156:159], v[240:255]
  s_add_u32 s96, s59, 43008
  buffer_load_dwordx4 v[224:227], v1, s[28:31], s96 offen sc1
  v_fma_f32 v124, v124, v120, v120
  v_fma_f32 v125, v125, v120, v120
  v_fma_f32 v126, v126, v120, v120
  v_fma_f32 v127, v127, v120, v120
  v_mfma_f32_32x32x16_bf16 a[224:239], a[32:35], v[160:163], a[224:239]
  v_rcp_f32 v124, v124
  v_rcp_f32 v125, v125
  v_rcp_f32 v126, v126
  v_mfma_f32_32x32x16_bf16 v[32:47], a[36:39], v[160:163], v[32:47]
  s_add_u32 s96, s63, 43008
  buffer_load_dwordx4 v[228:231], v1, s[28:31], s96 offen sc1
  v_rcp_f32 v127, v127
  v_mul_f32 v20, v20, v124
  v_mul_f32 v21, v21, v125
  v_mfma_f32_32x32x16_bf16 v[48:63], a[32:35], v[164:167], v[48:63]
  v_mul_f32 v22, v22, v126
  v_mul_f32 v23, v23, v127
  v_cvt_pk_bf16_f32 v18, v20, v21
  v_cvt_pk_bf16_f32 v19, v22, v23
  v_mul_f32 v124, v24, v24
  v_mfma_f32_32x32x16_bf16 v[240:255], a[36:39], v[164:167], v[240:255]
  buffer_store_dwordx4 v[16:19], v1, s[28:31], s58 offen offset:2048 sc1
  s_add_u32 s96, s59, 51200
  buffer_load_dwordx4 v[232:235], v1, s[28:31], s96 offen sc1
  v_mul_f32 v125, v25, v25
  v_mul_f32 v126, v26, v26
  v_mul_f32 v127, v27, v27
  v_fma_f32 v124, v124, v118, v116
  v_mfma_f32_32x32x16_bf16 a[224:239], a[40:43], v[168:171], a[224:239]
  v_fma_f32 v125, v125, v118, v116
  v_fma_f32 v126, v126, v118, v116
  v_fma_f32 v127, v127, v118, v116
  v_mul_f32 v124, v124, v24
  v_mul_f32 v125, v125, v25
  v_mul_f32 v126, v126, v26
  v_mfma_f32_32x32x16_bf16 v[32:47], a[44:47], v[168:171], v[32:47]
  s_add_u32 s96, s63, 51200
  buffer_load_dwordx4 v[236:239], v1, s[28:31], s96 offen sc1
  v_mul_f32 v127, v127, v27
  v_exp_f32 v124, v124
  v_exp_f32 v125, v125
  v_mfma_f32_32x32x16_bf16 v[48:63], a[40:43], v[172:175], v[48:63]
  s_buffer_load_dwordx4 s[44:47], s[28:31], s37 offset:6144
  v_exp_f32 v126, v126
  v_exp_f32 v127, v127
  v_mfma_f32_32x32x16_bf16 v[240:255], a[44:47], v[172:175], v[240:255]
  v_fma_f32 v124, v124, v120, v120
  v_fma_f32 v125, v125, v120, v120
  v_fma_f32 v126, v126, v120, v120
  v_fma_f32 v127, v127, v120, v120
  v_rcp_f32 v124, v124
  s_waitcnt vmcnt(18)
  v_mfma_f32_32x32x16_bf16 a[224:239], a[48:51], v[176:179], a[224:239]
  v_rcp_f32 v125, v125
  v_rcp_f32 v126, v126
  v_rcp_f32 v127, v127
  v_mfma_f32_32x32x16_bf16 v[32:47], a[52:55], v[176:179], v[32:47]
  v_mul_f32 v24, v24, v124
  v_mul_f32 v25, v25, v125
  v_mul_f32 v26, v26, v126
  v_mul_f32 v27, v27, v127
  v_cvt_pk_bf16_f32 v20, v24, v25
  v_cvt_pk_bf16_f32 v21, v26, v27
  s_waitcnt vmcnt(17)
  v_mfma_f32_32x32x16_bf16 v[48:63], a[48:51], v[180:183], v[48:63]
  v_mul_f32 v124, v28, v28
  v_mul_f32 v125, v29, v29
  v_mul_f32 v126, v30, v30
  v_mul_f32 v127, v31, v31
  v_fma_f32 v124, v124, v118, v116
  v_fma_f32 v125, v125, v118, v116
  v_mfma_f32_32x32x16_bf16 v[240:255], a[52:55], v[180:183], v[240:255]
  v_fma_f32 v126, v126, v118, v116
  v_fma_f32 v127, v127, v118, v116
  v_mul_f32 v124, v124, v28
  v_mul_f32 v125, v125, v29
  v_mul_f32 v126, v126, v30
  v_mul_f32 v127, v127, v31
  v_exp_f32 v124, v124
  v_exp_f32 v125, v125
  v_exp_f32 v126, v126
  v_exp_f32 v127, v127
  v_fma_f32 v124, v124, v120, v120
  v_fma_f32 v125, v125, v120, v120
  v_fma_f32 v126, v126, v120, v120
  v_fma_f32 v127, v127, v120, v120
  v_rcp_f32 v124, v124
  v_rcp_f32 v125, v125
  v_rcp_f32 v126, v126
  v_rcp_f32 v127, v127
  v_mul_f32 v28, v28, v124
  v_mul_f32 v29, v29, v125
  v_mul_f32 v30, v30, v126
  v_mul_f32 v31, v31, v127
  v_cvt_pk_bf16_f32 v22, v28, v29
  v_cvt_pk_bf16_f32 v23, v30, v31
  s_waitcnt vmcnt(16)
  v_mfma_f32_32x32x16_bf16 a[224:239], a[56:59], v[184:187], a[224:239]
  buffer_store_dwordx4 v[20:23], v1, s[28:31], s58 offen offset:3072 sc1
  v_mfma_f32_32x32x16_bf16 v[32:47], a[60:63], v[184:187], v[32:47]
  s_waitcnt vmcnt(16)
  v_mfma_f32_32x32x16_bf16 v[48:63], a[56:59], v[188:191], v[48:63]
  s_waitcnt lgkmcnt(0)
  s_or_b32 s47, s47, 0xffff0000
  s_nand_b64 s[44:45], s[44:45], s[46:47]
  s_cbranch_scc1 L147
L148:
  v_mfma_f32_32x32x16_bf16 v[240:255], a[60:63], v[188:191], v[240:255]
  s_add_u32 s96, s59, 4096
  buffer_load_dwordx4 v[128:131], v1, s[28:31], s96 offen sc1
  s_waitcnt vmcnt(16)
  v_mfma_f32_32x32x16_bf16 a[224:239], a[64:67], v[192:195], a[224:239]
  s_add_u32 s96, s63, 4096
  buffer_load_dwordx4 v[132:135], v1, s[28:31], s96 offen sc1
  v_mfma_f32_32x32x16_bf16 v[32:47], a[68:71], v[192:195], v[32:47]
  s_add_u32 s96, s59, 12288
  buffer_load_dwordx4 v[136:139], v1, s[28:31], s96 offen sc1
  s_waitcnt vmcnt(17)
  v_mfma_f32_32x32x16_bf16 v[48:63], a[64:67], v[196:199], v[48:63]
  s_add_u32 s96, s63, 12288
  buffer_load_dwordx4 v[140:143], v1, s[28:31], s96 offen sc1
  v_mfma_f32_32x32x16_bf16 v[240:255], a[68:71], v[196:199], v[240:255]
  s_add_u32 s96, s59, 20480
  buffer_load_dwordx4 v[144:147], v1, s[28:31], s96 offen sc1
  s_waitcnt vmcnt(18)
  v_mfma_f32_32x32x16_bf16 a[224:239], a[72:75], v[200:203], a[224:239]
  s_add_u32 s96, s63, 20480
  buffer_load_dwordx4 v[148:151], v1, s[28:31], s96 offen sc1
  v_mfma_f32_32x32x16_bf16 v[32:47], a[76:79], v[200:203], v[32:47]
  s_add_u32 s96, s59, 28672
  buffer_load_dwordx4 v[152:155], v1, s[28:31], s96 offen sc1
  s_waitcnt vmcnt(19)
  v_mfma_f32_32x32x16_bf16 v[48:63], a[72:75], v[204:207], v[48:63]
  v_mfma_f32_32x32x16_bf16 v[240:255], a[76:79], v[204:207], v[240:255]
  s_add_u32 s96, s63, 28672
  buffer_load_dwordx4 v[156:159], v1, s[28:31], s96 offen sc1
  s_waitcnt vmcnt(19)
  v_mfma_f32_32x32x16_bf16 a[224:239], a[80:83], v[208:211], a[224:239]
  v_mfma_f32_32x32x16_bf16 v[32:47], a[84:87], v[208:211], v[32:47]
  s_add_u32 s96, s59, 36864
  buffer_load_dwordx4 v[160:163], v1, s[28:31], s96 offen sc1
  s_waitcnt vmcnt(19)
  v_mfma_f32_32x32x16_bf16 v[48:63], a[80:83], v[212:215], v[48:63]
  v_and_b32 v14, 0x1c0, v1
  v_or_b32 v14, 16711680, v14
  s_cmp_eq_u32 s51, 0
  s_waitcnt vmcnt(9)
  buffer_store_byte_d16_hi v14, v14, s[28:31], s10 offen offset:2560
  v_mov_b32 v14, 23
  s_cbranch_scc1 L152
  buffer_store_dword v14, off, s[28:31], s52
L153:
  v_mfma_f32_32x32x16_bf16 v[240:255], a[84:87], v[212:215], v[240:255]
  s_add_u32 s96, s63, 36864
  buffer_load_dwordx4 v[164:167], v1, s[28:31], s96 offen sc1
  v_mfma_f32_32x32x16_bf16 a[224:239], a[88:91], v[216:219], a[224:239]
  s_barrier
  v_mfma_f32_32x32x16_bf16 v[32:47], a[92:95], v[216:219], v[32:47]
  s_add_u32 s96, s59, 45056
  buffer_load_dwordx4 v[168:171], v1, s[28:31], s96 offen sc1
  v_mfma_f32_32x32x16_bf16 v[48:63], a[88:91], v[220:223], v[48:63]
  v_mfma_f32_32x32x16_bf16 v[240:255], a[92:95], v[220:223], v[240:255]
  s_add_u32 s96, s63, 45056
  buffer_load_dwordx4 v[172:175], v1, s[28:31], s96 offen sc1
  v_mfma_f32_32x32x16_bf16 a[224:239], a[96:99], v[224:227], a[224:239]
  v_mfma_f32_32x32x16_bf16 v[32:47], a[100:103], v[224:227], v[32:47]
  s_add_u32 s96, s59, 53248
  buffer_load_dwordx4 v[176:179], v1, s[28:31], s96 offen sc1
  v_mfma_f32_32x32x16_bf16 v[48:63], a[96:99], v[228:231], v[48:63]
  s_buffer_load_dwordx4 s[44:47], s[28:31], s37 offset:6656
  v_mfma_f32_32x32x16_bf16 v[240:255], a[100:103], v[228:231], v[240:255]
  s_add_u32 s96, s63, 53248
  buffer_load_dwordx4 v[180:183], v1, s[28:31], s96 offen sc1
  v_mfma_f32_32x32x16_bf16 a[224:239], a[104:107], v[232:235], a[224:239]
  v_mfma_f32_32x32x16_bf16 v[32:47], a[108:111], v[232:235], v[32:47]
  v_mfma_f32_32x32x16_bf16 v[48:63], a[104:107], v[236:239], v[48:63]
  v_mfma_f32_32x32x16_bf16 v[240:255], a[108:111], v[236:239], v[240:255]
  s_waitcnt vmcnt(15)
  v_mfma_f32_32x32x16_bf16 a[224:239], a[112:115], v[128:131], a[224:239]
  v_mfma_f32_32x32x16_bf16 v[32:47], a[116:119], v[128:131], v[32:47]
  s_waitcnt vmcnt(14)
  v_mfma_f32_32x32x16_bf16 v[48:63], a[112:115], v[132:135], v[48:63]
  s_waitcnt lgkmcnt(0)
  s_or_b32 s47, s47, 0xffff0000
  s_nand_b64 s[44:45], s[44:45], s[46:47]
  s_cbranch_scc1 L154
L155:
  v_mfma_f32_32x32x16_bf16 v[240:255], a[116:119], v[132:135], v[240:255]
  s_add_u32 s96, s59, 6144
  buffer_load_dwordx4 v[184:187], v1, s[28:31], s96 offen sc1
  s_waitcnt vmcnt(14)
  v_mfma_f32_32x32x16_bf16 a[224:239], a[120:123], v[136:139], a[224:239]
  s_add_u32 s96, s63, 6144
  buffer_load_dwordx4 v[188:191], v1, s[28:31], s96 offen sc1
  v_mfma_f32_32x32x16_bf16 v[32:47], a[124:127], v[136:139], v[32:47]
  s_add_u32 s96, s59, 14336
  buffer_load_dwordx4 v[192:195], v1, s[28:31], s96 offen sc1
  s_waitcnt vmcnt(15)
  v_mfma_f32_32x32x16_bf16 v[48:63], a[120:123], v[140:143], v[48:63]
  s_add_u32 s96, s63, 14336
  buffer_load_dwordx4 v[196:199], v1, s[28:31], s96 offen sc1
  v_mfma_f32_32x32x16_bf16 v[240:255], a[124:127], v[140:143], v[240:255]
  s_add_u32 s96, s59, 22528
  buffer_load_dwordx4 v[200:203], v1, s[28:31], s96 offen sc1
  s_waitcnt vmcnt(16)
  v_mfma_f32_32x32x16_bf16 a[224:239], a[128:131], v[144:147], a[224:239]
  s_add_u32 s96, s63, 22528
  buffer_load_dwordx4 v[204:207], v1, s[28:31], s96 offen sc1
  v_mfma_f32_32x32x16_bf16 v[32:47], a[132:135], v[144:147], v[32:47]
  s_add_u32 s96, s59, 30720
  buffer_load_dwordx4 v[208:211], v1, s[28:31], s96 offen sc1
  s_waitcnt vmcnt(17)
  v_mfma_f32_32x32x16_bf16 v[48:63], a[128:131], v[148:151], v[48:63]
  v_mfma_f32_32x32x16_bf16 v[240:255], a[132:135], v[148:151], v[240:255]
  s_add_u32 s96, s63, 30720
  buffer_load_dwordx4 v[212:215], v1, s[28:31], s96 offen sc1
  s_waitcnt vmcnt(17)
  v_mfma_f32_32x32x16_bf16 a[224:239], a[136:139], v[152:155], a[224:239]
  v_mfma_f32_32x32x16_bf16 v[32:47], a[140:143], v[152:155], v[32:47]
  s_add_u32 s96, s59, 38912
  buffer_load_dwordx4 v[216:219], v1, s[28:31], s96 offen sc1
  s_waitcnt vmcnt(17)
  v_mfma_f32_32x32x16_bf16 v[48:63], a[136:139], v[156:159], v[48:63]
  v_mfma_f32_32x32x16_bf16 v[240:255], a[140:143], v[156:159], v[240:255]
  s_add_u32 s96, s63, 38912
  buffer_load_dwordx4 v[220:223], v1, s[28:31], s96 offen sc1
  s_waitcnt vmcnt(17)
  v_mfma_f32_32x32x16_bf16 a[224:239], a[144:147], v[160:163], a[224:239]
  v_mfma_f32_32x32x16_bf16 v[32:47], a[148:151], v[160:163], v[32:47]
  s_add_u32 s96, s59, 47104
  buffer_load_dwordx4 v[224:227], v1, s[28:31], s96 offen sc1
  s_waitcnt vmcnt(15)
  v_mfma_f32_32x32x16_bf16 v[48:63], a[144:147], v[164:167], v[48:63]
  v_mfma_f32_32x32x16_bf16 v[240:255], a[148:151], v[164:167], v[240:255]
  s_add_u32 s96, s63, 47104
  buffer_load_dwordx4 v[228:231], v1, s[28:31], s96 offen sc1
  s_waitcnt vmcnt(15)
  v_mfma_f32_32x32x16_bf16 a[224:239], a[152:155], v[168:171], a[224:239]
  v_mfma_f32_32x32x16_bf16 v[32:47], a[156:159], v[168:171], v[32:47]
  s_add_u32 s96, s59, 55296
  buffer_load_dwordx4 v[232:235], v1, s[28:31], s96 offen sc1
  s_waitcnt vmcnt(15)
  v_mfma_f32_32x32x16_bf16 v[48:63], a[152:155], v[172:175], v[48:63]
  v_mfma_f32_32x32x16_bf16 v[240:255], a[156:159], v[172:175], v[240:255]
  s_add_u32 s96, s63, 55296
  buffer_load_dwordx4 v[236:239], v1, s[28:31], s96 offen sc1
  s_waitcnt vmcnt(15)
  v_mfma_f32_32x32x16_bf16 a[224:239], a[160:163], v[176:179], a[224:239]
  v_mfma_f32_32x32x16_bf16 v[32:47], a[164:167], v[176:179], v[32:47]
  s_waitcnt vmcnt(14)
  v_mfma_f32_32x32x16_bf16 v[48:63], a[160:163], v[180:183], v[48:63]
  v_mfma_f32_32x32x16_bf16 v[240:255], a[164:167], v[180:183], v[240:255]
  s_xor_b32 s96, s6, 0
  s_mul_i32 s96, s96, 12288
  s_add_u32 s96, s96, 98304
  v_add_u32 v16, s96, v1
  s_xor_b32 s96, s6, 1
  s_mul_i32 s96, s96, 12288
  s_add_u32 s96, s96, 98304
  v_add_u32 v17, s96, v1
  s_xor_b32 s96, s6, 2
  s_mul_i32 s96, s96, 12288
  s_add_u32 s96, s96, 102400
  v_add_u32 v18, s96, v1
  s_xor_b32 s96, s6, 3
  s_mul_i32 s96, s96, 12288
  s_add_u32 s96, s96, 106496
  v_add_u32 v19, s96, v1
  v_and_b32 v15, 31, v0
  v_lshrrev_b32 v14, 5, v0
  v_lshlrev_b32 v15, 10, v15
  v_lshl_add_u32 v15, v14, 4, v15
  s_lshl_b32 s55, s49, 15
  s_lshl_b32 s56, s50, 6
  s_add_u32 s55, s55, s56
  s_waitcnt vmcnt(13)
  v_mfma_f32_32x32x16_bf16 a[224:239], a[168:171], v[184:187], a[224:239]
  v_mfma_f32_32x32x16_bf16 v[32:47], a[172:175], v[184:187], v[32:47]
  s_waitcnt vmcnt(12)
  v_mfma_f32_32x32x16_bf16 v[48:63], a[168:171], v[188:191], v[48:63]
  v_mfma_f32_32x32x16_bf16 v[240:255], a[172:175], v[188:191], v[240:255]
  s_waitcnt vmcnt(11)
  v_mfma_f32_32x32x16_bf16 a[224:239], a[176:179], v[192:195], a[224:239]
  v_mfma_f32_32x32x16_bf16 v[32:47], a[180:183], v[192:195], v[32:47]
  s_waitcnt vmcnt(10)
  v_mfma_f32_32x32x16_bf16 v[48:63], a[176:179], v[196:199], v[48:63]
  v_mfma_f32_32x32x16_bf16 v[240:255], a[180:183], v[196:199], v[240:255]
  s_waitcnt vmcnt(9)
  v_mfma_f32_32x32x16_bf16 a[224:239], a[184:187], v[200:203], a[224:239]
  v_mfma_f32_32x32x16_bf16 v[32:47], a[188:191], v[200:203], v[32:47]
  s_waitcnt vmcnt(8)
  v_mfma_f32_32x32x16_bf16 v[48:63], a[184:187], v[204:207], v[48:63]
  v_mfma_f32_32x32x16_bf16 v[240:255], a[188:191], v[204:207], v[240:255]
  s_waitcnt vmcnt(7)
  v_mfma_f32_32x32x16_bf16 a[224:239], a[192:195], v[208:211], a[224:239]
  v_mfma_f32_32x32x16_bf16 v[32:47], a[196:199], v[208:211], v[32:47]
  s_waitcnt vmcnt(6)
  v_mfma_f32_32x32x16_bf16 v[48:63], a[192:195], v[212:215], v[48:63]
  v_mfma_f32_32x32x16_bf16 v[240:255], a[196:199], v[212:215], v[240:255]
  s_waitcnt vmcnt(5)
  v_mfma_f32_32x32x16_bf16 a[224:239], a[200:203], v[216:219], a[224:239]
  v_mfma_f32_32x32x16_bf16 v[32:47], a[204:207], v[216:219], v[32:47]
  s_waitcnt vmcnt(4)
  v_mfma_f32_32x32x16_bf16 v[48:63], a[200:203], v[220:223], v[48:63]
  v_mfma_f32_32x32x16_bf16 v[240:255], a[204:207], v[220:223], v[240:255]
  s_waitcnt vmcnt(2)
  v_mfma_f32_32x32x16_bf16 v[240:255], a[212:215], v[228:231], v[240:255]
  s_waitcnt vmcnt(0)
  v_mfma_f32_32x32x16_bf16 v[240:255], a[220:223], v[236:239], v[240:255]
  v_mfma_f32_32x32x16_bf16 v[48:63], a[208:211], v[228:231], v[48:63]
  v_mfma_f32_32x32x16_bf16 v[48:63], a[216:219], v[236:239], v[48:63]
  s_nop 9
  ds_write_b128 v19, v[240:243] offset:0
  ds_write_b128 v19, v[244:247] offset:1024
  ds_write_b128 v19, v[248:251] offset:2048
  ds_write_b128 v19, v[252:255] offset:3072
  v_mfma_f32_32x32x16_bf16 v[32:47], a[212:215], v[224:227], v[32:47]
  v_mfma_f32_32x32x16_bf16 v[32:47], a[220:223], v[232:235], v[32:47]
  ds_write_b128 v18, v[48:51] offset:0
  ds_write_b128 v18, v[52:55] offset:1024
  ds_write_b128 v18, v[56:59] offset:2048
  ds_write_b128 v18, v[60:63] offset:3072
  v_mfma_f32_32x32x16_bf16 a[224:239], a[208:211], v[224:227], a[224:239]
  v_mfma_f32_32x32x16_bf16 a[224:239], a[216:219], v[232:235], a[224:239]
  s_nop 5
  ds_write_b128 v17, v[32:35] offset:0
  ds_write_b128 v17, v[36:39] offset:1024
  ds_write_b128 v17, v[40:43] offset:2048
  ds_write_b128 v17, v[44:47] offset:3072
  s_nop 1
  v_accvgpr_read_b32 v64, a224
  v_accvgpr_read_b32 v65, a225
  v_accvgpr_read_b32 v66, a226
  v_accvgpr_read_b32 v67, a227
  v_accvgpr_read_b32 v68, a228
  v_accvgpr_read_b32 v69, a229
  v_accvgpr_read_b32 v70, a230
  v_accvgpr_read_b32 v71, a231
  v_accvgpr_read_b32 v72, a232
  v_accvgpr_read_b32 v73, a233
  v_accvgpr_read_b32 v74, a234
  v_accvgpr_read_b32 v75, a235
  v_accvgpr_read_b32 v76, a236
  v_accvgpr_read_b32 v77, a237
  v_accvgpr_read_b32 v78, a238
  v_accvgpr_read_b32 v79, a239
  s_waitcnt lgkmcnt(0)
  s_barrier
  ds_read_b128 v[80:83], v16 offset:0
  ds_read_b128 v[84:87], v16 offset:1024
  ds_read_b128 v[88:91], v16 offset:2048
  ds_read_b128 v[92:95], v16 offset:3072
  ds_read_b128 v[96:99], v16 offset:4096
  ds_read_b128 v[100:103], v16 offset:5120
  ds_read_b128 v[104:107], v16 offset:6144
  ds_read_b128 v[108:111], v16 offset:7168
  ds_read_b128 v[112:115], v16 offset:8192
  ds_read_b128 v[116:119], v16 offset:9216
  ds_read_b128 v[120:123], v16 offset:10240
  ds_read_b128 v[124:127], v16 offset:11264
  s_waitcnt lgkmcnt(11)
  v_pk_add_f32 v[64:65], v[64:65], v[80:81]
  v_pk_add_f32 v[66:67], v[66:67], v[82:83]
  s_waitcnt lgkmcnt(10)
  v_pk_add_f32 v[68:69], v[68:69], v[84:85]
  v_pk_add_f32 v[70:71], v[70:71], v[86:87]
  s_waitcnt lgkmcnt(9)
  v_pk_add_f32 v[72:73], v[72:73], v[88:89]
  v_pk_add_f32 v[74:75], v[74:75], v[90:91]
  s_waitcnt lgkmcnt(8)
  v_pk_add_f32 v[76:77], v[76:77], v[92:93]
  v_pk_add_f32 v[78:79], v[78:79], v[94:95]
  s_waitcnt lgkmcnt(7)
  v_pk_add_f32 v[64:65], v[64:65], v[96:97]
  v_pk_add_f32 v[66:67], v[66:67], v[98:99]
  s_waitcnt lgkmcnt(6)
  v_pk_add_f32 v[68:69], v[68:69], v[100:101]
  v_pk_add_f32 v[70:71], v[70:71], v[102:103]
  s_waitcnt lgkmcnt(5)
  v_pk_add_f32 v[72:73], v[72:73], v[104:105]
  v_pk_add_f32 v[74:75], v[74:75], v[106:107]
  s_waitcnt lgkmcnt(4)
  v_pk_add_f32 v[76:77], v[76:77], v[108:109]
  v_pk_add_f32 v[78:79], v[78:79], v[110:111]
  s_waitcnt lgkmcnt(3)
  v_pk_add_f32 v[64:65], v[64:65], v[112:113]
  v_pk_add_f32 v[66:67], v[66:67], v[114:115]
  s_waitcnt lgkmcnt(2)
  v_pk_add_f32 v[68:69], v[68:69], v[116:117]
  v_pk_add_f32 v[70:71], v[70:71], v[118:119]
  s_waitcnt lgkmcnt(1)
  v_pk_add_f32 v[72:73], v[72:73], v[120:121]
  v_pk_add_f32 v[74:75], v[74:75], v[122:123]
  s_waitcnt lgkmcnt(0)
  v_pk_add_f32 v[76:77], v[76:77], v[124:125]
  v_pk_add_f32 v[78:79], v[78:79], v[126:127]
  v_cvt_pk_bf16_f32 v16, v64, v65
  v_cvt_pk_bf16_f32 v17, v66, v67
  v_cvt_pk_bf16_f32 v18, v68, v69
  v_cvt_pk_bf16_f32 v19, v70, v71
  v_cvt_pk_bf16_f32 v20, v72, v73
  v_cvt_pk_bf16_f32 v21, v74, v75
  v_cvt_pk_bf16_f32 v22, v76, v77
  v_cvt_pk_bf16_f32 v23, v78, v79
  buffer_store_dwordx4 v[16:19], v15, s[32:35], s55 offen
  buffer_store_dwordx4 v[20:23], v15, s[32:35], s55 offen offset:32
L_end:
  s_endpgm
L25:
  v_mov_b32 v116, s51
  v_lshrrev_b32 v117, 7, v7
  v_sub_u32 v117, s4, v117
  v_lshlrev_b32 v117, 2, v117
  s_mov_b64 exec, 7
  buffer_store_dword v116, v6, s[28:31], s55 offen sc1
  s_mov_b64 exec, -1
  buffer_load_dword v116, v7, s[28:31], s55 offen sc1
  buffer_load_dword v117, v117, s[44:47], 0 offen sc1
  s_waitcnt vmcnt(0)
  v_or_b32 v116, v116, v117
  s_sub_u32 s7, s7, 1
  s_cbranch_scc0 L26
  s_endpgm
L27:
  s_mov_b32 s7, 30003
  v_mov_b32 v99, s51
L29:
  s_buffer_load_dword s57, s[28:31], s53 glc
  s_waitcnt lgkmcnt(0)
  s_cmp_lg_u32 s57, 0
  s_cbranch_scc1 L28
  s_and_b32 s96, s7, 3
  s_or_b32 s96, s96, s6
  s_cbranch_scc1 L30
  s_mov_b64 exec, 7
  buffer_store_dword v99, v6, s[28:31], s55 offen sc1
  s_mov_b64 exec, -1
L30:
  s_sub_u32 s7, s7, 1
  s_cbranch_scc0 L29
  s_endpgm
L33:
  s_sub_u32 s7, s7, 1
  s_cbranch_scc1 L32
  buffer_load_dwordx4 v[128:131], v96, s[28:31], s61 offen offset:0 sc1
  buffer_load_dwordx4 v[132:135], v1, s[28:31], s62 offen offset:1024 sc1
  buffer_load_dwordx4 v[136:139], v96, s[28:31], s61 offen offset:2048 sc1
  buffer_load_dwordx4 v[140:143], v1, s[28:31], s62 offen offset:3072 sc1
  buffer_load_dwordx4 v[144:147], v97, s[28:31], s63 offen offset:0 sc1
  buffer_load_dwordx4 v[148:151], v1, s[28:31], s59 offen offset:1024 sc1
  buffer_load_dwordx4 v[152:155], v97, s[28:31], s63 offen offset:2048 sc1
  buffer_load_dwordx4 v[156:159], v1, s[28:31], s59 offen offset:3072 sc1
  s_mov_b32 s96, 1073741824
  buffer_load_dword a232, off, s[28:31], s96
  buffer_load_dword a232, off, s[28:31], s96
  buffer_load_dword a232, off, s[28:31], s96
  buffer_load_dword a232, off, s[28:31], s96
  buffer_load_dword a232, off, s[28:31], s96
  buffer_load_dword a232, off, s[28:31], s96
  buffer_load_dword a232, off, s[28:31], s96
  buffer_load_dword a232, off, s[28:31], s96
  buffer_load_dword a232, off, s[28:31], s96
  buffer_load_dword a232, off, s[28:31], s96
  s_branch L31
L35:
  ds_read_b128 v[40:43], v24 offset:0
  ds_read_b128 v[44:47], v24 offset:4112
  ds_read_b128 v[48:51], v24 offset:8224
  ds_read_b128 v[52:55], v24 offset:12336
  ds_read_b128 v[56:59], v24 offset:16448
  ds_read_b128 v[60:63], v24 offset:20560
  ds_read_b128 v[64:67], v24 offset:24672
  ds_read_b128 v[68:71], v24 offset:28784
  ds_read_b128 v[72:75], v24 offset:32896
  s_waitcnt lgkmcnt(0)
  v_mfma_f32_32x32x16_bf16 v[96:111], v[72:75], v[16:19], 0
  v_mfma_f32_32x32x16_bf16 v[112:127], v[40:43], v[16:19], 0
  s_nop 11
  v_cndmask_b32_e64 v112, v112, v96, s[64:65]
  v_cndmask_b32_e64 v113, v113, v97, s[66:67]
  v_cndmask_b32_e64 v114, v114, v98, s[68:69]
  v_cndmask_b32_e64 v115, v115, v99, s[70:71]
  v_cndmask_b32_e64 v116, v116, v100, s[72:73]
  v_cndmask_b32_e64 v117, v117, v101, s[74:75]
  v_cndmask_b32_e64 v118, v118, v102, s[76:77]
  v_cndmask_b32_e64 v119, v119, v103, s[78:79]
  v_cndmask_b32_e64 v120, v120, v104, s[80:81]
  v_cndmask_b32_e64 v121, v121, v105, s[82:83]
  v_cndmask_b32_e64 v122, v122, v106, s[84:85]
  v_cndmask_b32_e64 v123, v123, v107, s[86:87]
  v_cndmask_b32_e64 v124, v124, v108, s[88:89]
  v_cndmask_b32_e64 v125, v125, v109, s[90:91]
  v_cndmask_b32_e64 v126, v126, v110, s[92:93]
  v_cndmask_b32_e64 v127, v127, v111, s[94:95]
  v_mov_b32 v29, v112
  v_max3_f32 v29, v29, v112, v113
  v_max3_f32 v29, v29, v114, v115
  v_max3_f32 v29, v29, v116, v117
  v_max3_f32 v29, v29, v118, v119
  v_max3_f32 v29, v29, v120, v121
  v_max3_f32 v29, v29, v122, v123
  v_max3_f32 v29, v29, v124, v125
  v_max3_f32 v29, v29, v126, v127
  v_mfma_f32_32x32x16_bf16 v[96:111], v[44:47], v[16:19], 0
  s_nop 11
  v_max3_f32 v29, v29, v96, v97
  v_max3_f32 v29, v29, v98, v99
  v_max3_f32 v29, v29, v100, v101
  v_max3_f32 v29, v29, v102, v103
  v_max3_f32 v29, v29, v104, v105
  v_max3_f32 v29, v29, v106, v107
  v_max3_f32 v29, v29, v108, v109
  v_max3_f32 v29, v29, v110, v111
  v_mfma_f32_32x32x16_bf16 v[112:127], v[48:51], v[16:19], 0
  s_nop 11
  v_max3_f32 v29, v29, v112, v113
  v_max3_f32 v29, v29, v114, v115
  v_max3_f32 v29, v29, v116, v117
  v_max3_f32 v29, v29, v118, v119
  v_max3_f32 v29, v29, v120, v121
  v_max3_f32 v29, v29, v122, v123
  v_max3_f32 v29, v29, v124, v125
  v_max3_f32 v29, v29, v126, v127
  v_mfma_f32_32x32x16_bf16 v[96:111], v[52:55], v[16:19], 0
  s_nop 11
  v_max3_f32 v29, v29, v96, v97
  v_max3_f32 v29, v29, v98, v99
  v_max3_f32 v29, v29, v100, v101
  v_max3_f32 v29, v29, v102, v103
  v_max3_f32 v29, v29, v104, v105
  v_max3_f32 v29, v29, v106, v107
  v_max3_f32 v29, v29, v108, v109
  v_max3_f32 v29, v29, v110, v111
  v_mfma_f32_32x32x16_bf16 v[112:127], v[56:59], v[16:19], 0
  s_nop 11
  v_max3_f32 v29, v29, v112, v113
  v_max3_f32 v29, v29, v114, v115
  v_max3_f32 v29, v29, v116, v117
  v_max3_f32 v29, v29, v118, v119
  v_max3_f32 v29, v29, v120, v121
  v_max3_f32 v29, v29, v122, v123
  v_max3_f32 v29, v29, v124, v125
  v_max3_f32 v29, v29, v126, v127
  v_mfma_f32_32x32x16_bf16 v[96:111], v[60:63], v[16:19], 0
  s_nop 11
  v_max3_f32 v29, v29, v96, v97
  v_max3_f32 v29, v29, v98, v99
  v_max3_f32 v29, v29, v100, v101
  v_max3_f32 v29, v29, v102, v103
  v_max3_f32 v29, v29, v104, v105
  v_max3_f32 v29, v29, v106, v107
  v_max3_f32 v29, v29, v108, v109
  v_max3_f32 v29, v29, v110, v111
  v_mfma_f32_32x32x16_bf16 v[112:127], v[64:67], v[16:19], 0
  s_nop 11
  v_max3_f32 v29, v29, v112, v113
  v_max3_f32 v29, v29, v114, v115
  v_max3_f32 v29, v29, v116, v117
  v_max3_f32 v29, v29, v118, v119
  v_max3_f32 v29, v29, v120, v121
  v_max3_f32 v29, v29, v122, v123
  v_max3_f32 v29, v29, v124, v125
  v_max3_f32 v29, v29, v126, v127
  v_mfma_f32_32x32x16_bf16 v[96:111], v[68:71], v[16:19], 0
  s_nop 11
  v_max3_f32 v29, v29, v96, v97
  v_max3_f32 v29, v29, v98, v99
  v_max3_f32 v29, v29, v100, v101
  v_max3_f32 v29, v29, v102, v103
  v_max3_f32 v29, v29, v104, v105
  v_max3_f32 v29, v29, v106, v107
  v_max3_f32 v29, v29, v108, v109
  v_max3_f32 v29, v29, v110, v111
  v_mov_b32 v31, v29
  s_nop 1
  v_permlane32_swap_b32 v29, v31
  v_max_f32 v29, v29, v31
  v_sub_f32 v192, 0, v29
  v_sub_f32 v193, 0, v29
  v_sub_f32 v194, 0, v29
  v_sub_f32 v195, 0, v29
  v_sub_f32 v196, 0, v29
  v_sub_f32 v197, 0, v29
  v_sub_f32 v198, 0, v29
  v_sub_f32 v199, 0, v29
  v_sub_f32 v200, 0, v29
  v_sub_f32 v201, 0, v29
  v_sub_f32 v202, 0, v29
  v_sub_f32 v203, 0, v29
  v_sub_f32 v204, 0, v29
  v_sub_f32 v205, 0, v29
  v_sub_f32 v206, 0, v29
  v_sub_f32 v207, 0, v29
  s_nop 1
  v_mfma_f32_32x32x16_bf16 v[96:111], v[72:75], v[16:19], v[192:207]
  v_mfma_f32_32x32x16_bf16 v[112:127], v[40:43], v[16:19], v[192:207]
  s_nop 11
  v_cndmask_b32_e64 v112, v112, v96, s[64:65]
  v_cndmask_b32_e64 v113, v113, v97, s[66:67]
  v_cndmask_b32_e64 v114, v114, v98, s[68:69]
  v_cndmask_b32_e64 v115, v115, v99, s[70:71]
  v_cndmask_b32_e64 v116, v116, v100, s[72:73]
  v_cndmask_b32_e64 v117, v117, v101, s[74:75]
  v_cndmask_b32_e64 v118, v118, v102, s[76:77]
  v_cndmask_b32_e64 v119, v119, v103, s[78:79]
  v_cndmask_b32_e64 v120, v120, v104, s[80:81]
  v_cndmask_b32_e64 v121, v121, v105, s[82:83]
  v_cndmask_b32_e64 v122, v122, v106, s[84:85]
  v_cndmask_b32_e64 v123, v123, v107, s[86:87]
  v_cndmask_b32_e64 v124, v124, v108, s[88:89]
  v_cndmask_b32_e64 v125, v125, v109, s[90:91]
  v_cndmask_b32_e64 v126, v126, v110, s[92:93]
  v_cndmask_b32_e64 v127, v127, v111, s[94:95]
  ds_read_b128 v[208:211], v25 offset:1024
  ds_read_b128 v[212:215], v26 offset:1536
  v_exp_f32 v112, v112
  v_exp_f32 v113, v113
  v_exp_f32 v114, v114
  v_exp_f32 v115, v115
  v_exp_f32 v116, v116
  v_exp_f32 v117, v117
  v_exp_f32 v118, v118
  v_exp_f32 v119, v119
  v_exp_f32 v120, v120
  v_exp_f32 v121, v121
  v_exp_f32 v122, v122
  v_exp_f32 v123, v123
  v_exp_f32 v124, v124
  v_exp_f32 v125, v125
  v_exp_f32 v126, v126
  v_exp_f32 v127, v127
  v_cvt_pk_bf16_f32 v112, v112, v113
  v_cvt_pk_bf16_f32 v113, v114, v115
  v_cvt_pk_bf16_f32 v114, v116, v117
  v_cvt_pk_bf16_f32 v115, v118, v119
  v_cvt_pk_bf16_f32 v116, v120, v121
  v_cvt_pk_bf16_f32 v117, v122, v123
  v_cvt_pk_bf16_f32 v118, v124, v125
  v_cvt_pk_bf16_f32 v119, v126, v127
  ds_read_b128 v[216:219], v25 offset:33920
  ds_read_b128 v[220:223], v26 offset:34432
  v_and_b32 v120, v112, v32
  v_xor_b32 v112, v112, v120
  v_and_b32 v121, v113, v33
  v_xor_b32 v113, v113, v121
  v_and_b32 v122, v114, v34
  v_xor_b32 v114, v114, v122
  v_and_b32 v123, v115, v35
  v_xor_b32 v115, v115, v123
  v_and_b32 v124, v116, v36
  v_xor_b32 v116, v116, v124
  v_and_b32 v125, v117, v37
  v_xor_b32 v117, v117, v125
  v_and_b32 v126, v118, v38
  v_xor_b32 v118, v118, v126
  v_and_b32 v127, v119, v39
  v_xor_b32 v119, v119, v127
  s_waitcnt lgkmcnt(1)
  v_mfma_f32_32x32x16_bf16 v[224:239], v[216:219], v[120:123], 0
  s_waitcnt lgkmcnt(0)
  v_mfma_f32_32x32x16_bf16 v[224:239], v[220:223], v[124:127], v[224:239]
  v_mfma_f32_32x32x16_bf16 v[224:239], v[208:211], v[112:115], v[224:239]
  v_mfma_f32_32x32x16_bf16 v[224:239], v[212:215], v[116:119], v[224:239]
  s_nop 15
  v_mfma_f32_32x32x16_bf16 v[96:111], v[44:47], v[16:19], v[192:207]
  ds_read_b128 v[208:211], v25 offset:5136
  ds_read_b128 v[212:215], v26 offset:5648
  s_nop 9
  v_exp_f32 v96, v96
  v_exp_f32 v97, v97
  v_exp_f32 v98, v98
  v_exp_f32 v99, v99
  v_exp_f32 v100, v100
  v_exp_f32 v101, v101
  v_exp_f32 v102, v102
  v_exp_f32 v103, v103
  v_exp_f32 v104, v104
  v_exp_f32 v105, v105
  v_exp_f32 v106, v106
  v_exp_f32 v107, v107
  v_exp_f32 v108, v108
  v_exp_f32 v109, v109
  v_exp_f32 v110, v110
  v_exp_f32 v111, v111
  v_cvt_pk_bf16_f32 v96, v96, v97
  v_cvt_pk_bf16_f32 v97, v98, v99
  v_cvt_pk_bf16_f32 v98, v100, v101
  v_cvt_pk_bf16_f32 v99, v102, v103
  v_cvt_pk_bf16_f32 v100, v104, v105
  v_cvt_pk_bf16_f32 v101, v106, v107
  v_cvt_pk_bf16_f32 v102, v108, v109
  v_cvt_pk_bf16_f32 v103, v110, v111
  s_waitcnt lgkmcnt(1)
  v_mfma_f32_32x32x16_bf16 v[224:239], v[208:211], v[96:99], v[224:239]
  s_waitcnt lgkmcnt(0)
  v_mfma_f32_32x32x16_bf16 v[224:239], v[212:215], v[100:103], v[224:239]
  s_nop 15
  v_mfma_f32_32x32x16_bf16 v[112:127], v[48:51], v[16:19], v[192:207]
  ds_read_b128 v[208:211], v25 offset:9248
  ds_read_b128 v[212:215], v26 offset:9760
  s_nop 9
  v_exp_f32 v112, v112
  v_exp_f32 v113, v113
  v_exp_f32 v114, v114
  v_exp_f32 v115, v115
  v_exp_f32 v116, v116
  v_exp_f32 v117, v117
  v_exp_f32 v118, v118
  v_exp_f32 v119, v119
  v_exp_f32 v120, v120
  v_exp_f32 v121, v121
  v_exp_f32 v122, v122
  v_exp_f32 v123, v123
  v_exp_f32 v124, v124
  v_exp_f32 v125, v125
  v_exp_f32 v126, v126
  v_exp_f32 v127, v127
  v_cvt_pk_bf16_f32 v112, v112, v113
  v_cvt_pk_bf16_f32 v113, v114, v115
  v_cvt_pk_bf16_f32 v114, v116, v117
  v_cvt_pk_bf16_f32 v115, v118, v119
  v_cvt_pk_bf16_f32 v116, v120, v121
  v_cvt_pk_bf16_f32 v117, v122, v123
  v_cvt_pk_bf16_f32 v118, v124, v125
  v_cvt_pk_bf16_f32 v119, v126, v127
  s_waitcnt lgkmcnt(1)
  v_mfma_f32_32x32x16_bf16 v[224:239], v[208:211], v[112:115], v[224:239]
  s_waitcnt lgkmcnt(0)
  v_mfma_f32_32x32x16_bf16 v[224:239], v[212:215], v[116:119], v[224:239]
  s_nop 15
  v_mfma_f32_32x32x16_bf16 v[96:111], v[52:55], v[16:19], v[192:207]
  ds_read_b128 v[208:211], v25 offset:13360
  ds_read_b128 v[212:215], v26 offset:13872
  s_nop 9
  v_exp_f32 v96, v96
  v_exp_f32 v97, v97
  v_exp_f32 v98, v98
  v_exp_f32 v99, v99
  v_exp_f32 v100, v100
  v_exp_f32 v101, v101
  v_exp_f32 v102, v102
  v_exp_f32 v103, v103
  v_exp_f32 v104, v104
  v_exp_f32 v105, v105
  v_exp_f32 v106, v106
  v_exp_f32 v107, v107
  v_exp_f32 v108, v108
  v_exp_f32 v109, v109
  v_exp_f32 v110, v110
  v_exp_f32 v111, v111
  v_cvt_pk_bf16_f32 v96, v96, v97
  v_cvt_pk_bf16_f32 v97, v98, v99
  v_cvt_pk_bf16_f32 v98, v100, v101
  v_cvt_pk_bf16_f32 v99, v102, v103
  v_cvt_pk_bf16_f32 v100, v104, v105
  v_cvt_pk_bf16_f32 v101, v106, v107
  v_cvt_pk_bf16_f32 v102, v108, v109
  v_cvt_pk_bf16_f32 v103, v110, v111
  s_waitcnt lgkmcnt(1)
  v_mfma_f32_32x32x16_bf16 v[224:239], v[208:211], v[96:99], v[224:239]
  s_waitcnt lgkmcnt(0)
  v_mfma_f32_32x32x16_bf16 v[224:239], v[212:215], v[100:103], v[224:239]
  s_nop 15
  v_mfma_f32_32x32x16_bf16 v[112:127], v[56:59], v[16:19], v[192:207]
  ds_read_b128 v[208:211], v25 offset:17472
  ds_read_b128 v[212:215], v26 offset:17984
  s_nop 9
  v_exp_f32 v112, v112
  v_exp_f32 v113, v113
  v_exp_f32 v114, v114
  v_exp_f32 v115, v115
  v_exp_f32 v116, v116
  v_exp_f32 v117, v117
  v_exp_f32 v118, v118
  v_exp_f32 v119, v119
  v_exp_f32 v120, v120
  v_exp_f32 v121, v121
  v_exp_f32 v122, v122
  v_exp_f32 v123, v123
  v_exp_f32 v124, v124
  v_exp_f32 v125, v125
  v_exp_f32 v126, v126
  v_exp_f32 v127, v127
  v_cvt_pk_bf16_f32 v112, v112, v113
  v_cvt_pk_bf16_f32 v113, v114, v115
  v_cvt_pk_bf16_f32 v114, v116, v117
  v_cvt_pk_bf16_f32 v115, v118, v119
  v_cvt_pk_bf16_f32 v116, v120, v121
  v_cvt_pk_bf16_f32 v117, v122, v123
  v_cvt_pk_bf16_f32 v118, v124, v125
  v_cvt_pk_bf16_f32 v119, v126, v127
  s_waitcnt lgkmcnt(1)
  v_mfma_f32_32x32x16_bf16 v[224:239], v[208:211], v[112:115], v[224:239]
  s_waitcnt lgkmcnt(0)
  v_mfma_f32_32x32x16_bf16 v[224:239], v[212:215], v[116:119], v[224:239]
  s_nop 15
  v_mfma_f32_32x32x16_bf16 v[96:111], v[60:63], v[16:19], v[192:207]
  ds_read_b128 v[208:211], v25 offset:21584
  ds_read_b128 v[212:215], v26 offset:22096
  s_nop 9
  v_exp_f32 v96, v96
  v_exp_f32 v97, v97
  v_exp_f32 v98, v98
  v_exp_f32 v99, v99
  v_exp_f32 v100, v100
  v_exp_f32 v101, v101
  v_exp_f32 v102, v102
  v_exp_f32 v103, v103
  v_exp_f32 v104, v104
  v_exp_f32 v105, v105
  v_exp_f32 v106, v106
  v_exp_f32 v107, v107
  v_exp_f32 v108, v108
  v_exp_f32 v109, v109
  v_exp_f32 v110, v110
  v_exp_f32 v111, v111
  v_cvt_pk_bf16_f32 v96, v96, v97
  v_cvt_pk_bf16_f32 v97, v98, v99
  v_cvt_pk_bf16_f32 v98, v100, v101
  v_cvt_pk_bf16_f32 v99, v102, v103
  v_cvt_pk_bf16_f32 v100, v104, v105
  v_cvt_pk_bf16_f32 v101, v106, v107
  v_cvt_pk_bf16_f32 v102, v108, v109
  v_cvt_pk_bf16_f32 v103, v110, v111
  s_waitcnt lgkmcnt(1)
  v_mfma_f32_32x32x16_bf16 v[224:239], v[208:211], v[96:99], v[224:239]
  s_waitcnt lgkmcnt(0)
  v_mfma_f32_32x32x16_bf16 v[224:239], v[212:215], v[100:103], v[224:239]
  s_nop 15
  v_mfma_f32_32x32x16_bf16 v[112:127], v[64:67], v[16:19], v[192:207]
  ds_read_b128 v[208:211], v25 offset:25696
  ds_read_b128 v[212:215], v26 offset:26208
  s_nop 9
  v_exp_f32 v112, v112
  v_exp_f32 v113, v113
  v_exp_f32 v114, v114
  v_exp_f32 v115, v115
  v_exp_f32 v116, v116
  v_exp_f32 v117, v117
  v_exp_f32 v118, v118
  v_exp_f32 v119, v119
  v_exp_f32 v120, v120
  v_exp_f32 v121, v121
  v_exp_f32 v122, v122
  v_exp_f32 v123, v123
  v_exp_f32 v124, v124
  v_exp_f32 v125, v125
  v_exp_f32 v126, v126
  v_exp_f32 v127, v127
  v_cvt_pk_bf16_f32 v112, v112, v113
  v_cvt_pk_bf16_f32 v113, v114, v115
  v_cvt_pk_bf16_f32 v114, v116, v117
  v_cvt_pk_bf16_f32 v115, v118, v119
  v_cvt_pk_bf16_f32 v116, v120, v121
  v_cvt_pk_bf16_f32 v117, v122, v123
  v_cvt_pk_bf16_f32 v118, v124, v125
  v_cvt_pk_bf16_f32 v119, v126, v127
  s_waitcnt lgkmcnt(1)
  v_mfma_f32_32x32x16_bf16 v[224:239], v[208:211], v[112:115], v[224:239]
  s_waitcnt lgkmcnt(0)
  v_mfma_f32_32x32x16_bf16 v[224:239], v[212:215], v[116:119], v[224:239]
  s_nop 15
  v_mfma_f32_32x32x16_bf16 v[96:111], v[68:71], v[16:19], v[192:207]
  ds_read_b128 v[208:211], v25 offset:29808
  ds_read_b128 v[212:215], v26 offset:30320
  s_nop 9
  v_exp_f32 v96, v96
  v_exp_f32 v97, v97
  v_exp_f32 v98, v98
  v_exp_f32 v99, v99
  v_exp_f32 v100, v100
  v_exp_f32 v101, v101
  v_exp_f32 v102, v102
  v_exp_f32 v103, v103
  v_exp_f32 v104, v104
  v_exp_f32 v105, v105
  v_exp_f32 v106, v106
  v_exp_f32 v107, v107
  v_exp_f32 v108, v108
  v_exp_f32 v109, v109
  v_exp_f32 v110, v110
  v_exp_f32 v111, v111
  v_cvt_pk_bf16_f32 v96, v96, v97
  v_cvt_pk_bf16_f32 v97, v98, v99
  v_cvt_pk_bf16_f32 v98, v100, v101
  v_cvt_pk_bf16_f32 v99, v102, v103
  v_cvt_pk_bf16_f32 v100, v104, v105
  v_cvt_pk_bf16_f32 v101, v106, v107
  v_cvt_pk_bf16_f32 v102, v108, v109
  v_cvt_pk_bf16_f32 v103, v110, v111
  s_waitcnt lgkmcnt(1)
  v_mfma_f32_32x32x16_bf16 v[224:239], v[208:211], v[96:99], v[224:239]
  s_waitcnt lgkmcnt(0)
  v_mfma_f32_32x32x16_bf16 v[224:239], v[212:215], v[100:103], v[224:239]
  s_nop 15
  v_rcp_f32 v31, v232
  s_nop 0
  v_mul_f32 v224, v224, v31
  v_mul_f32 v225, v225, v31
  v_mul_f32 v226, v226, v31
  v_mul_f32 v227, v227, v31
  v_mul_f32 v228, v228, v31
  v_mul_f32 v229, v229, v31
  v_mul_f32 v230, v230, v31
  v_mul_f32 v231, v231, v31
  v_cvt_pk_bf16_f32 v232, v224, v225
  v_cvt_pk_bf16_f32 v233, v226, v227
  v_cvt_pk_bf16_f32 v234, v228, v229
  v_cvt_pk_bf16_f32 v235, v230, v231
  buffer_store_dwordx4 v[232:235], v1, s[28:31], s54 offen offset:0 sc1
  ds_read_b128 v[40:43], v24 offset:2048
  ds_read_b128 v[44:47], v24 offset:6160
  ds_read_b128 v[48:51], v24 offset:10272
  ds_read_b128 v[52:55], v24 offset:14384
  ds_read_b128 v[56:59], v24 offset:18496
  ds_read_b128 v[60:63], v24 offset:22608
  ds_read_b128 v[64:67], v24 offset:26720
  ds_read_b128 v[68:71], v24 offset:30832
  ds_read_b128 v[72:75], v24 offset:34944
  s_waitcnt lgkmcnt(0)
  v_mfma_f32_32x32x16_bf16 v[96:111], v[72:75], v[20:23], 0
  v_mfma_f32_32x32x16_bf16 v[112:127], v[40:43], v[20:23], 0
  s_nop 11
  v_cndmask_b32_e64 v112, v112, v96, s[64:65]
  v_cndmask_b32_e64 v113, v113, v97, s[66:67]
  v_cndmask_b32_e64 v114, v114, v98, s[68:69]
  v_cndmask_b32_e64 v115, v115, v99, s[70:71]
  v_cndmask_b32_e64 v116, v116, v100, s[72:73]
  v_cndmask_b32_e64 v117, v117, v101, s[74:75]
  v_cndmask_b32_e64 v118, v118, v102, s[76:77]
  v_cndmask_b32_e64 v119, v119, v103, s[78:79]
  v_cndmask_b32_e64 v120, v120, v104, s[80:81]
  v_cndmask_b32_e64 v121, v121, v105, s[82:83]
  v_cndmask_b32_e64 v122, v122, v106, s[84:85]
  v_cndmask_b32_e64 v123, v123, v107, s[86:87]
  v_cndmask_b32_e64 v124, v124, v108, s[88:89]
  v_cndmask_b32_e64 v125, v125, v109, s[90:91]
  v_cndmask_b32_e64 v126, v126, v110, s[92:93]
  v_cndmask_b32_e64 v127, v127, v111, s[94:95]
  v_mov_b32 v29, v112
  v_max3_f32 v29, v29, v112, v113
  v_max3_f32 v29, v29, v114, v115
  v_max3_f32 v29, v29, v116, v117
  v_max3_f32 v29, v29, v118, v119
  v_max3_f32 v29, v29, v120, v121
  v_max3_f32 v29, v29, v122, v123
  v_max3_f32 v29, v29, v124, v125
  v_max3_f32 v29, v29, v126, v127
  v_mfma_f32_32x32x16_bf16 v[96:111], v[44:47], v[20:23], 0
  s_nop 11
  v_max3_f32 v29, v29, v96, v97
  v_max3_f32 v29, v29, v98, v99
  v_max3_f32 v29, v29, v100, v101
  v_max3_f32 v29, v29, v102, v103
  v_max3_f32 v29, v29, v104, v105
  v_max3_f32 v29, v29, v106, v107
  v_max3_f32 v29, v29, v108, v109
  v_max3_f32 v29, v29, v110, v111
  v_mfma_f32_32x32x16_bf16 v[112:127], v[48:51], v[20:23], 0
  s_nop 11
  v_max3_f32 v29, v29, v112, v113
  v_max3_f32 v29, v29, v114, v115
  v_max3_f32 v29, v29, v116, v117
  v_max3_f32 v29, v29, v118, v119
  v_max3_f32 v29, v29, v120, v121
  v_max3_f32 v29, v29, v122, v123
  v_max3_f32 v29, v29, v124, v125
  v_max3_f32 v29, v29, v126, v127
  v_mfma_f32_32x32x16_bf16 v[96:111], v[52:55], v[20:23], 0
  s_nop 11
  v_max3_f32 v29, v29, v96, v97
  v_max3_f32 v29, v29, v98, v99
  v_max3_f32 v29, v29, v100, v101
  v_max3_f32 v29, v29, v102, v103
  v_max3_f32 v29, v29, v104, v105
  v_max3_f32 v29, v29, v106, v107
  v_max3_f32 v29, v29, v108, v109
  v_max3_f32 v29, v29, v110, v111
  v_mfma_f32_32x32x16_bf16 v[112:127], v[56:59], v[20:23], 0
  s_nop 11
  v_max3_f32 v29, v29, v112, v113
  v_max3_f32 v29, v29, v114, v115
  v_max3_f32 v29, v29, v116, v117
  v_max3_f32 v29, v29, v118, v119
  v_max3_f32 v29, v29, v120, v121
  v_max3_f32 v29, v29, v122, v123
  v_max3_f32 v29, v29, v124, v125
  v_max3_f32 v29, v29, v126, v127
  v_mfma_f32_32x32x16_bf16 v[96:111], v[60:63], v[20:23], 0
  s_nop 11
  v_max3_f32 v29, v29, v96, v97
  v_max3_f32 v29, v29, v98, v99
  v_max3_f32 v29, v29, v100, v101
  v_max3_f32 v29, v29, v102, v103
  v_max3_f32 v29, v29, v104, v105
  v_max3_f32 v29, v29, v106, v107
  v_max3_f32 v29, v29, v108, v109
  v_max3_f32 v29, v29, v110, v111
  v_mfma_f32_32x32x16_bf16 v[112:127], v[64:67], v[20:23], 0
  s_nop 11
  v_max3_f32 v29, v29, v112, v113
  v_max3_f32 v29, v29, v114, v115
  v_max3_f32 v29, v29, v116, v117
  v_max3_f32 v29, v29, v118, v119
  v_max3_f32 v29, v29, v120, v121
  v_max3_f32 v29, v29, v122, v123
  v_max3_f32 v29, v29, v124, v125
  v_max3_f32 v29, v29, v126, v127
  v_mfma_f32_32x32x16_bf16 v[96:111], v[68:71], v[20:23], 0
  s_nop 11
  v_max3_f32 v29, v29, v96, v97
  v_max3_f32 v29, v29, v98, v99
  v_max3_f32 v29, v29, v100, v101
  v_max3_f32 v29, v29, v102, v103
  v_max3_f32 v29, v29, v104, v105
  v_max3_f32 v29, v29, v106, v107
  v_max3_f32 v29, v29, v108, v109
  v_max3_f32 v29, v29, v110, v111
  v_mov_b32 v31, v29
  s_nop 1
  v_permlane32_swap_b32 v29, v31
  v_max_f32 v29, v29, v31
  v_sub_f32 v192, 0, v29
  v_sub_f32 v193, 0, v29
  v_sub_f32 v194, 0, v29
  v_sub_f32 v195, 0, v29
  v_sub_f32 v196, 0, v29
  v_sub_f32 v197, 0, v29
  v_sub_f32 v198, 0, v29
  v_sub_f32 v199, 0, v29
  v_sub_f32 v200, 0, v29
  v_sub_f32 v201, 0, v29
  v_sub_f32 v202, 0, v29
  v_sub_f32 v203, 0, v29
  v_sub_f32 v204, 0, v29
  v_sub_f32 v205, 0, v29
  v_sub_f32 v206, 0, v29
  v_sub_f32 v207, 0, v29
  s_nop 1
  v_mfma_f32_32x32x16_bf16 v[96:111], v[72:75], v[20:23], v[192:207]
  v_mfma_f32_32x32x16_bf16 v[112:127], v[40:43], v[20:23], v[192:207]
  s_nop 11
  v_cndmask_b32_e64 v112, v112, v96, s[64:65]
  v_cndmask_b32_e64 v113, v113, v97, s[66:67]
  v_cndmask_b32_e64 v114, v114, v98, s[68:69]
  v_cndmask_b32_e64 v115, v115, v99, s[70:71]
  v_cndmask_b32_e64 v116, v116, v100, s[72:73]
  v_cndmask_b32_e64 v117, v117, v101, s[74:75]
  v_cndmask_b32_e64 v118, v118, v102, s[76:77]
  v_cndmask_b32_e64 v119, v119, v103, s[78:79]
  v_cndmask_b32_e64 v120, v120, v104, s[80:81]
  v_cndmask_b32_e64 v121, v121, v105, s[82:83]
  v_cndmask_b32_e64 v122, v122, v106, s[84:85]
  v_cndmask_b32_e64 v123, v123, v107, s[86:87]
  v_cndmask_b32_e64 v124, v124, v108, s[88:89]
  v_cndmask_b32_e64 v125, v125, v109, s[90:91]
  v_cndmask_b32_e64 v126, v126, v110, s[92:93]
  v_cndmask_b32_e64 v127, v127, v111, s[94:95]
  ds_read_b128 v[208:211], v27 offset:3072
  ds_read_b128 v[212:215], v28 offset:3584
  v_exp_f32 v112, v112
  v_exp_f32 v113, v113
  v_exp_f32 v114, v114
  v_exp_f32 v115, v115
  v_exp_f32 v116, v116
  v_exp_f32 v117, v117
  v_exp_f32 v118, v118
  v_exp_f32 v119, v119
  v_exp_f32 v120, v120
  v_exp_f32 v121, v121
  v_exp_f32 v122, v122
  v_exp_f32 v123, v123
  v_exp_f32 v124, v124
  v_exp_f32 v125, v125
  v_exp_f32 v126, v126
  v_exp_f32 v127, v127
  v_cvt_pk_bf16_f32 v112, v112, v113
  v_cvt_pk_bf16_f32 v113, v114, v115
  v_cvt_pk_bf16_f32 v114, v116, v117
  v_cvt_pk_bf16_f32 v115, v118, v119
  v_cvt_pk_bf16_f32 v116, v120, v121
  v_cvt_pk_bf16_f32 v117, v122, v123
  v_cvt_pk_bf16_f32 v118, v124, v125
  v_cvt_pk_bf16_f32 v119, v126, v127
  ds_read_b128 v[216:219], v27 offset:35968
  ds_read_b128 v[220:223], v28 offset:36480
  v_and_b32 v120, v112, v32
  v_xor_b32 v112, v112, v120
  v_and_b32 v121, v113, v33
  v_xor_b32 v113, v113, v121
  v_and_b32 v122, v114, v34
  v_xor_b32 v114, v114, v122
  v_and_b32 v123, v115, v35
  v_xor_b32 v115, v115, v123
  v_and_b32 v124, v116, v36
  v_xor_b32 v116, v116, v124
  v_and_b32 v125, v117, v37
  v_xor_b32 v117, v117, v125
  v_and_b32 v126, v118, v38
  v_xor_b32 v118, v118, v126
  v_and_b32 v127, v119, v39
  v_xor_b32 v119, v119, v127
  s_waitcnt lgkmcnt(1)
  v_mfma_f32_32x32x16_bf16 v[224:239], v[216:219], v[120:123], 0
  s_waitcnt lgkmcnt(0)
  v_mfma_f32_32x32x16_bf16 v[224:239], v[220:223], v[124:127], v[224:239]
  v_mfma_f32_32x32x16_bf16 v[224:239], v[208:211], v[112:115], v[224:239]
  v_mfma_f32_32x32x16_bf16 v[224:239], v[212:215], v[116:119], v[224:239]
  s_nop 15
  v_mfma_f32_32x32x16_bf16 v[96:111], v[44:47], v[20:23], v[192:207]
  ds_read_b128 v[208:211], v27 offset:7184
  ds_read_b128 v[212:215], v28 offset:7696
  s_nop 9
  v_exp_f32 v96, v96
  v_exp_f32 v97, v97
  v_exp_f32 v98, v98
  v_exp_f32 v99, v99
  v_exp_f32 v100, v100
  v_exp_f32 v101, v101
  v_exp_f32 v102, v102
  v_exp_f32 v103, v103
  v_exp_f32 v104, v104
  v_exp_f32 v105, v105
  v_exp_f32 v106, v106
  v_exp_f32 v107, v107
  v_exp_f32 v108, v108
  v_exp_f32 v109, v109
  v_exp_f32 v110, v110
  v_exp_f32 v111, v111
  v_cvt_pk_bf16_f32 v96, v96, v97
  v_cvt_pk_bf16_f32 v97, v98, v99
  v_cvt_pk_bf16_f32 v98, v100, v101
  v_cvt_pk_bf16_f32 v99, v102, v103
  v_cvt_pk_bf16_f32 v100, v104, v105
  v_cvt_pk_bf16_f32 v101, v106, v107
  v_cvt_pk_bf16_f32 v102, v108, v109
  v_cvt_pk_bf16_f32 v103, v110, v111
  s_waitcnt lgkmcnt(1)
  v_mfma_f32_32x32x16_bf16 v[224:239], v[208:211], v[96:99], v[224:239]
  s_waitcnt lgkmcnt(0)
  v_mfma_f32_32x32x16_bf16 v[224:239], v[212:215], v[100:103], v[224:239]
  s_nop 15
  v_mfma_f32_32x32x16_bf16 v[112:127], v[48:51], v[20:23], v[192:207]
  ds_read_b128 v[208:211], v27 offset:11296
  ds_read_b128 v[212:215], v28 offset:11808
  s_nop 9
  v_exp_f32 v112, v112
  v_exp_f32 v113, v113
  v_exp_f32 v114, v114
  v_exp_f32 v115, v115
  v_exp_f32 v116, v116
  v_exp_f32 v117, v117
  v_exp_f32 v118, v118
  v_exp_f32 v119, v119
  v_exp_f32 v120, v120
  v_exp_f32 v121, v121
  v_exp_f32 v122, v122
  v_exp_f32 v123, v123
  v_exp_f32 v124, v124
  v_exp_f32 v125, v125
  v_exp_f32 v126, v126
  v_exp_f32 v127, v127
  v_cvt_pk_bf16_f32 v112, v112, v113
  v_cvt_pk_bf16_f32 v113, v114, v115
  v_cvt_pk_bf16_f32 v114, v116, v117
  v_cvt_pk_bf16_f32 v115, v118, v119
  v_cvt_pk_bf16_f32 v116, v120, v121
  v_cvt_pk_bf16_f32 v117, v122, v123
  v_cvt_pk_bf16_f32 v118, v124, v125
  v_cvt_pk_bf16_f32 v119, v126, v127
  s_waitcnt lgkmcnt(1)
  v_mfma_f32_32x32x16_bf16 v[224:239], v[208:211], v[112:115], v[224:239]
  s_waitcnt lgkmcnt(0)
  v_mfma_f32_32x32x16_bf16 v[224:239], v[212:215], v[116:119], v[224:239]
  s_nop 15
  v_mfma_f32_32x32x16_bf16 v[96:111], v[52:55], v[20:23], v[192:207]
  ds_read_b128 v[208:211], v27 offset:15408
  ds_read_b128 v[212:215], v28 offset:15920
  s_nop 9
  v_exp_f32 v96, v96
  v_exp_f32 v97, v97
  v_exp_f32 v98, v98
  v_exp_f32 v99, v99
  v_exp_f32 v100, v100
  v_exp_f32 v101, v101
  v_exp_f32 v102, v102
  v_exp_f32 v103, v103
  v_exp_f32 v104, v104
  v_exp_f32 v105, v105
  v_exp_f32 v106, v106
  v_exp_f32 v107, v107
  v_exp_f32 v108, v108
  v_exp_f32 v109, v109
  v_exp_f32 v110, v110
  v_exp_f32 v111, v111
  v_cvt_pk_bf16_f32 v96, v96, v97
  v_cvt_pk_bf16_f32 v97, v98, v99
  v_cvt_pk_bf16_f32 v98, v100, v101
  v_cvt_pk_bf16_f32 v99, v102, v103
  v_cvt_pk_bf16_f32 v100, v104, v105
  v_cvt_pk_bf16_f32 v101, v106, v107
  v_cvt_pk_bf16_f32 v102, v108, v109
  v_cvt_pk_bf16_f32 v103, v110, v111
  s_waitcnt lgkmcnt(1)
  v_mfma_f32_32x32x16_bf16 v[224:239], v[208:211], v[96:99], v[224:239]
  s_waitcnt lgkmcnt(0)
  v_mfma_f32_32x32x16_bf16 v[224:239], v[212:215], v[100:103], v[224:239]
  s_nop 15
  v_mfma_f32_32x32x16_bf16 v[112:127], v[56:59], v[20:23], v[192:207]
  ds_read_b128 v[208:211], v27 offset:19520
  ds_read_b128 v[212:215], v28 offset:20032
  s_nop 9
  v_exp_f32 v112, v112
  v_exp_f32 v113, v113
  v_exp_f32 v114, v114
  v_exp_f32 v115, v115
  v_exp_f32 v116, v116
  v_exp_f32 v117, v117
  v_exp_f32 v118, v118
  v_exp_f32 v119, v119
  v_exp_f32 v120, v120
  v_exp_f32 v121, v121
  v_exp_f32 v122, v122
  v_exp_f32 v123, v123
  v_exp_f32 v124, v124
  v_exp_f32 v125, v125
  v_exp_f32 v126, v126
  v_exp_f32 v127, v127
  v_cvt_pk_bf16_f32 v112, v112, v113
  v_cvt_pk_bf16_f32 v113, v114, v115
  v_cvt_pk_bf16_f32 v114, v116, v117
  v_cvt_pk_bf16_f32 v115, v118, v119
  v_cvt_pk_bf16_f32 v116, v120, v121
  v_cvt_pk_bf16_f32 v117, v122, v123
  v_cvt_pk_bf16_f32 v118, v124, v125
  v_cvt_pk_bf16_f32 v119, v126, v127
  s_waitcnt lgkmcnt(1)
  v_mfma_f32_32x32x16_bf16 v[224:239], v[208:211], v[112:115], v[224:239]
  s_waitcnt lgkmcnt(0)
  v_mfma_f32_32x32x16_bf16 v[224:239], v[212:215], v[116:119], v[224:239]
  s_nop 15
  v_mfma_f32_32x32x16_bf16 v[96:111], v[60:63], v[20:23], v[192:207]
  ds_read_b128 v[208:211], v27 offset:23632
  ds_read_b128 v[212:215], v28 offset:24144
  s_nop 9
  v_exp_f32 v96, v96
  v_exp_f32 v97, v97
  v_exp_f32 v98, v98
  v_exp_f32 v99, v99
  v_exp_f32 v100, v100
  v_exp_f32 v101, v101
  v_exp_f32 v102, v102
  v_exp_f32 v103, v103
  v_exp_f32 v104, v104
  v_exp_f32 v105, v105
  v_exp_f32 v106, v106
  v_exp_f32 v107, v107
  v_exp_f32 v108, v108
  v_exp_f32 v109, v109
  v_exp_f32 v110, v110
  v_exp_f32 v111, v111
  v_cvt_pk_bf16_f32 v96, v96, v97
  v_cvt_pk_bf16_f32 v97, v98, v99
  v_cvt_pk_bf16_f32 v98, v100, v101
  v_cvt_pk_bf16_f32 v99, v102, v103
  v_cvt_pk_bf16_f32 v100, v104, v105
  v_cvt_pk_bf16_f32 v101, v106, v107
  v_cvt_pk_bf16_f32 v102, v108, v109
  v_cvt_pk_bf16_f32 v103, v110, v111
  s_waitcnt lgkmcnt(1)
  v_mfma_f32_32x32x16_bf16 v[224:239], v[208:211], v[96:99], v[224:239]
  s_waitcnt lgkmcnt(0)
  v_mfma_f32_32x32x16_bf16 v[224:239], v[212:215], v[100:103], v[224:239]
  s_nop 15
  v_mfma_f32_32x32x16_bf16 v[112:127], v[64:67], v[20:23], v[192:207]
  ds_read_b128 v[208:211], v27 offset:27744
  ds_read_b128 v[212:215], v28 offset:28256
  s_nop 9
  v_exp_f32 v112, v112
  v_exp_f32 v113, v113
  v_exp_f32 v114, v114
  v_exp_f32 v115, v115
  v_exp_f32 v116, v116
  v_exp_f32 v117, v117
  v_exp_f32 v118, v118
  v_exp_f32 v119, v119
  v_exp_f32 v120, v120
  v_exp_f32 v121, v121
  v_exp_f32 v122, v122
  v_exp_f32 v123, v123
  v_exp_f32 v124, v124
  v_exp_f32 v125, v125
  v_exp_f32 v126, v126
  v_exp_f32 v127, v127
  v_cvt_pk_bf16_f32 v112, v112, v113
  v_cvt_pk_bf16_f32 v113, v114, v115
  v_cvt_pk_bf16_f32 v114, v116, v117
  v_cvt_pk_bf16_f32 v115, v118, v119
  v_cvt_pk_bf16_f32 v116, v120, v121
  v_cvt_pk_bf16_f32 v117, v122, v123
  v_cvt_pk_bf16_f32 v118, v124, v125
  v_cvt_pk_bf16_f32 v119, v126, v127
  s_waitcnt lgkmcnt(1)
  v_mfma_f32_32x32x16_bf16 v[224:239], v[208:211], v[112:115], v[224:239]
  s_waitcnt lgkmcnt(0)
  v_mfma_f32_32x32x16_bf16 v[224:239], v[212:215], v[116:119], v[224:239]
  s_nop 15
  v_mfma_f32_32x32x16_bf16 v[96:111], v[68:71], v[20:23], v[192:207]
  ds_read_b128 v[208:211], v27 offset:31856
  ds_read_b128 v[212:215], v28 offset:32368
  s_nop 9
  v_exp_f32 v96, v96
  v_exp_f32 v97, v97
  v_exp_f32 v98, v98
  v_exp_f32 v99, v99
  v_exp_f32 v100, v100
  v_exp_f32 v101, v101
  v_exp_f32 v102, v102
  v_exp_f32 v103, v103
  v_exp_f32 v104, v104
  v_exp_f32 v105, v105
  v_exp_f32 v106, v106
  v_exp_f32 v107, v107
  v_exp_f32 v108, v108
  v_exp_f32 v109, v109
  v_exp_f32 v110, v110
  v_exp_f32 v111, v111
  v_cvt_pk_bf16_f32 v96, v96, v97
  v_cvt_pk_bf16_f32 v97, v98, v99
  v_cvt_pk_bf16_f32 v98, v100, v101
  v_cvt_pk_bf16_f32 v99, v102, v103
  v_cvt_pk_bf16_f32 v100, v104, v105
  v_cvt_pk_bf16_f32 v101, v106, v107
  v_cvt_pk_bf16_f32 v102, v108, v109
  v_cvt_pk_bf16_f32 v103, v110, v111
  s_waitcnt lgkmcnt(1)
  v_mfma_f32_32x32x16_bf16 v[224:239], v[208:211], v[96:99], v[224:239]
  s_waitcnt lgkmcnt(0)
  v_mfma_f32_32x32x16_bf16 v[224:239], v[212:215], v[100:103], v[224:239]
  s_nop 15
  v_rcp_f32 v31, v232
  s_nop 0
  v_mul_f32 v224, v224, v31
  v_mul_f32 v225, v225, v31
  v_mul_f32 v226, v226, v31
  v_mul_f32 v227, v227, v31
  v_mul_f32 v228, v228, v31
  v_mul_f32 v229, v229, v31
  v_mul_f32 v230, v230, v31
  v_mul_f32 v231, v231, v31
  v_cvt_pk_bf16_f32 v232, v224, v225
  v_cvt_pk_bf16_f32 v233, v226, v227
  v_cvt_pk_bf16_f32 v234, v228, v229
  v_cvt_pk_bf16_f32 v235, v230, v231
  buffer_store_dwordx4 v[232:235], v1, s[28:31], s54 offen offset:1024 sc1
  s_waitcnt vmcnt(0)
  v_mov_b32 v56, 0
  s_branch L36
L37:
  s_waitcnt vmcnt(0)
  buffer_store_dword v14, off, s[28:31], s52 sc1
  s_branch L38
L39:
  s_mov_b32 s39, s36
  s_cmp_eq_u32 s51, 0
  s_cbranch_scc1 L43
L42:
  s_add_u32 s39, s39, 64
  s_and_b32 s44, s39, 448
  s_cbranch_scc0 L43
  s_buffer_load_dwordx2 s[44:45], s[28:31], s39 offset:0
  s_waitcnt lgkmcnt(0)
  s_nand_b32 s44, s44, s45
  s_cbranch_scc0 L40
  s_branch L42
L43:
  s_mov_b32 s7, 30000
L41:
  buffer_load_dword v53, v7, s[28:31], s53 offen sc1
  s_waitcnt vmcnt(0)
  v_cmp_gt_u32 vcc, 1, v53
  s_cbranch_vccz L40
  s_sub_u32 s7, s7, 1
  s_cbranch_scc0 L41
  s_endpgm
L45:
  s_waitcnt vmcnt(0)
  buffer_store_dword v14, off, s[28:31], s52 sc1
  s_branch L46
L51:
  s_mov_b32 s39, s38
  s_cmp_eq_u32 s51, 0
  s_cbranch_scc1 L55
L54:
  s_add_u32 s39, s39, 64
  s_and_b32 s44, s39, 448
  s_cbranch_scc0 L55
  s_buffer_load_dwordx4 s[44:47], s[28:31], s39 offset:3072
  s_waitcnt lgkmcnt(0)
  s_nand_b64 s[44:45], s[44:45], s[46:47]
  s_cbranch_scc0 L52
  s_branch L54
L55:
  s_mov_b32 s7, 30000
L53:
  buffer_load_dword v14, v6, s[28:31], s53 offen sc1
  s_waitcnt vmcnt(0)
  v_cmp_gt_u32 vcc, 3, v14
  s_cbranch_vccz L52
  s_sub_u32 s7, s7, 1
  s_cbranch_scc0 L53
  s_endpgm
L56:
  buffer_store_dword v14, off, s[28:31], s52 sc1
  s_branch L57
L58:
  s_mov_b32 s39, s37
  s_cmp_eq_u32 s51, 0
  s_cbranch_scc1 L62
L61:
  s_add_u32 s39, s39, 64
  s_and_b32 s44, s39, 192
  s_cbranch_scc0 L62
  s_buffer_load_dwordx4 s[44:47], s[28:31], s39 offset:1024
  s_waitcnt lgkmcnt(0)
  s_or_b32 s47, s47, 0xffff0000
  s_nand_b64 s[44:45], s[44:45], s[46:47]
  s_cbranch_scc0 L59
  s_branch L61
L62:
  s_mov_b32 s7, 30000
L60:
  buffer_load_dword v13, v8, s[28:31], s53 offen sc1
  s_waitcnt vmcnt(0)
  v_cmp_gt_u32 vcc, 4, v13
  s_cbranch_vccz L59
  s_sub_u32 s7, s7, 1
  s_cbranch_scc0 L60
  s_endpgm
L63:
  buffer_store_dword v14, off, s[28:31], s52 sc1
  s_branch L64
L65:
  s_mov_b32 s39, s37
  s_cmp_eq_u32 s51, 0
  s_cbranch_scc1 L69
L68:
  s_add_u32 s39, s39, 64
  s_and_b32 s44, s39, 192
  s_cbranch_scc0 L69
  s_buffer_load_dwordx4 s[44:47], s[28:31], s39 offset:1536
  s_waitcnt lgkmcnt(0)
  s_or_b32 s47, s47, 0xffff0000
  s_nand_b64 s[44:45], s[44:45], s[46:47]
  s_cbranch_scc0 L66
  s_branch L68
L69:
  s_mov_b32 s7, 30000
L67:
  buffer_load_dword v13, v8, s[28:31], s53 offen sc1
  s_waitcnt vmcnt(0)
  v_cmp_gt_u32 vcc, 5, v13
  s_cbranch_vccz L66
  s_sub_u32 s7, s7, 1
  s_cbranch_scc0 L67
  s_endpgm
L70:
  buffer_store_dword v14, off, s[28:31], s52 sc1
  s_branch L71
L72:
  s_mov_b32 s39, s37
  s_cmp_eq_u32 s51, 0
  s_cbranch_scc1 L76
L75:
  s_add_u32 s39, s39, 64
  s_and_b32 s44, s39, 192
  s_cbranch_scc0 L76
  s_buffer_load_dwordx4 s[44:47], s[28:31], s39 offset:2048
  s_waitcnt lgkmcnt(0)
  s_or_b32 s47, s47, 0xffff0000
  s_nand_b64 s[44:45], s[44:45], s[46:47]
  s_cbranch_scc0 L73
  s_branch L75
L76:
  s_mov_b32 s7, 30000
L74:
  buffer_load_dword v13, v8, s[28:31], s53 offen sc1
  s_waitcnt vmcnt(0)
  v_cmp_gt_u32 vcc, 6, v13
  s_cbranch_vccz L73
  s_sub_u32 s7, s7, 1
  s_cbranch_scc0 L74
  s_endpgm
L77:
  buffer_store_dword v14, off, s[28:31], s52 sc1
  s_branch L78
L79:
  s_mov_b32 s39, s37
  s_cmp_eq_u32 s51, 0
  s_cbranch_scc1 L83
L82:
  s_add_u32 s39, s39, 64
  s_and_b32 s44, s39, 192
  s_cbranch_scc0 L83
  s_buffer_load_dwordx4 s[44:47], s[28:31], s39 offset:2560
  s_waitcnt lgkmcnt(0)
  s_or_b32 s47, s47, 0xffff0000
  s_nand_b64 s[44:45], s[44:45], s[46:47]
  s_cbranch_scc0 L80
  s_branch L82
L83:
  s_mov_b32 s7, 30000
L81:
  buffer_load_dword v13, v8, s[28:31], s53 offen sc1
  s_waitcnt vmcnt(0)
  v_cmp_gt_u32 vcc, 7, v13
  s_cbranch_vccz L80
  s_sub_u32 s7, s7, 1
  s_cbranch_scc0 L81
  s_endpgm
L84:
  s_mov_b32 s39, s37
  s_cmp_eq_u32 s51, 0
  s_cbranch_scc1 L88
L87:
  s_add_u32 s39, s39, 64
  s_and_b32 s44, s39, 192
  s_cbranch_scc0 L88
  s_buffer_load_dwordx4 s[44:47], s[28:31], s39 offset:1024
  s_waitcnt lgkmcnt(0)
  s_or_b32 s47, s47, 0xffff0000
  s_nand_b64 s[44:45], s[44:45], s[46:47]
  s_cbranch_scc0 L85
  s_branch L87
L88:
  s_mov_b32 s7, 30000
L86:
  buffer_load_dword v13, v8, s[28:31], s53 offen sc1
  s_waitcnt vmcnt(0)
  v_cmp_gt_u32 vcc, 4, v13
  s_cbranch_vccz L85
  s_sub_u32 s7, s7, 1
  s_cbranch_scc0 L86
  s_endpgm
L47:
  s_bfe_u32 s96, s2, 0x20003
  s_lshl_b32 s96, s96, 2
  s_add_u32 s96, s96, s6
  s_mul_i32 s96, s96, 12288
  v_lshrrev_b32 v13, 4, v0
  v_mul_u32_u24 v13, 3072, v13
  v_and_b32 v14, 15, v0
  v_lshl_add_u32 v13, v14, 7, v13
  s_mov_b32 s57, 1073741824
  s_mov_b32 s58, 1073741824
  v_add_u32 v15, 159232, v1
  s_add_u32 s97, s96, 0
  buffer_load_dword v14, v13, s[12:15], s97 offen offset:1024
  s_add_u32 s97, s96, 393216
  buffer_load_dword v14, v13, s[12:15], s97 offen offset:1024
  s_add_u32 s97, s96, 786432
  buffer_load_dword v14, v13, s[12:15], s97 offen offset:1024
  s_add_u32 s97, s96, 1179648
  buffer_load_dword v14, v13, s[12:15], s97 offen offset:1024
  s_add_u32 s97, s96, 196608
  buffer_load_dword v14, v13, s[12:15], s97 offen offset:1024
  s_add_u32 s97, s96, 589824
  buffer_load_dword v14, v13, s[12:15], s97 offen offset:1024
  s_add_u32 s97, s96, 983040
  buffer_load_dword v14, v13, s[12:15], s97 offen offset:1024
  s_add_u32 s97, s96, 1376256
  buffer_load_dword v14, v13, s[12:15], s97 offen offset:1024
  v_lshrrev_b32 v13, 3, v0
  v_mul_u32_u24 v13, 3072, v13
  v_and_b32 v16, 7, v0
  v_lshl_add_u32 v13, v16, 7, v13
  s_lshl_b32 s96, s96, 1
  s_add_u32 s97, s96, 0
  buffer_load_dword v14, v13, s[12:15], s97 offen
  s_add_u32 s97, s96, 393216
  buffer_load_dword v14, v13, s[12:15], s97 offen
  s_add_u32 s97, s96, 786432
  buffer_load_dword v14, v13, s[12:15], s97 offen
  s_add_u32 s97, s96, 1179648
  buffer_load_dword v14, v13, s[12:15], s97 offen
  s_lshl_b32 s96, s6, 12
  v_and_b32 v16, 31, v0
  v_lshl_add_u32 v16, v16, 7, s96
  v_min_u32 v16, L_p3_1-L_p1_1, v16
  s_getpc_b64 s[96:97]
L49:
  s_sub_u32 s96, s96, L49-L_p1_1
  s_subb_u32 s97, s97, 0
  global_load_dword v14, v16, s[96:97]
  s_lshl_b32 s96, s6, 13
  v_add_u32 v13, s96, v5
  s_lshr_b32 s96, s6, 1
  s_lshl_b32 s96, s96, 9
  s_and_b32 s97, s6, 1
  s_lshl_b32 s97, s97, 3
  s_add_u32 s96, s96, s97
  s_add_u32 s96, s96, 156160
  v_and_b32 v123, 0x1f0, v1
  v_add_u32 v123, s96, v123
  s_waitcnt lgkmcnt(0)
  s_barrier
  s_lshr_b32 s96, s6, 1
  s_mul_i32 s96, s96, 57344
  s_and_b32 s97, s6, 1
  s_lshl_b32 s97, s97, 10
  s_add_u32 s96, s96, s97
  s_add_u32 s96, s96, 12582912
  s_lshl_b32 s59, s49, 17
  s_xor_b32 s63, s59, 0x20000
  s_add_u32 s59, s59, s96
  s_add_u32 s63, s63, s96
  s_buffer_load_dwordx4 s[44:47], s[28:31], s37 offset:1024
  s_waitcnt lgkmcnt(0)
  s_or_b32 s47, s47, 0xffff0000
  s_nand_b64 s[44:45], s[44:45], s[46:47]
  s_cbranch_scc1 L84
L85:
  s_add_u32 s96, s59, 0
  buffer_load_dwordx4 v[128:131], v1, s[28:31], s96 offen sc1
  s_add_u32 s96, s63, 0
  buffer_load_dwordx4 v[132:135], v1, s[28:31], s96 offen sc1
  s_add_u32 s96, s59, 8192
  buffer_load_dwordx4 v[136:139], v1, s[28:31], s96 offen sc1
  s_add_u32 s96, s63, 8192
  buffer_load_dwordx4 v[140:143], v1, s[28:31], s96 offen sc1
  s_add_u32 s96, s59, 16384
  buffer_load_dwordx4 v[144:147], v1, s[28:31], s96 offen sc1
  s_add_u32 s96, s63, 16384
  buffer_load_dwordx4 v[148:151], v1, s[28:31], s96 offen sc1
  s_add_u32 s96, s59, 24576
  buffer_load_dwordx4 v[152:155], v1, s[28:31], s96 offen sc1
  s_add_u32 s96, s63, 24576
  buffer_load_dwordx4 v[156:159], v1, s[28:31], s96 offen sc1
  s_add_u32 s96, s59, 32768
  buffer_load_dwordx4 v[160:163], v1, s[28:31], s96 offen sc1
  s_add_u32 s96, s63, 32768
  buffer_load_dwordx4 v[164:167], v1, s[28:31], s96 offen sc1
  s_add_u32 s96, s59, 40960
  buffer_load_dwordx4 v[168:171], v1, s[28:31], s96 offen sc1
  s_add_u32 s96, s63, 40960
  buffer_load_dwordx4 v[172:175], v1, s[28:31], s96 offen sc1
  s_add_u32 s96, s59, 49152
  buffer_load_dwordx4 v[176:179], v1, s[28:31], s96 offen sc1
  s_add_u32 s96, s63, 49152
  buffer_load_dwordx4 v[180:183], v1, s[28:31], s96 offen sc1
  s_buffer_load_dwordx4 s[44:47], s[28:31], s37 offset:1536
  s_mul_i32 s61, s6, 98304
  s_lshl_b32 s62, s5, 6
  s_add_u32 s61, s61, s62
  s_lshl_b32 s62, s6, 11
  s_add_u32 s61, s61, 1024
  s_xor_b32 s60, s0, 0
  s_mul_i32 s60, s60, 393216
  s_add_u32 m0, s62, 0
  s_add_u32 s60, s60, s61
  buffer_load_dwordx4 v10, s[12:15], s60 offen offset:0 lds
  s_add_u32 s60, s60, 48128
  buffer_load_dwordx4 v10, s[12:15], s60 offen offset:1024 lds
  s_xor_b32 s60, s0, 0
  s_mul_i32 s60, s60, 393216
  s_add_u32 m0, s62, 31744
  s_add_u32 s60, s60, s61
  buffer_load_dwordx4 v10, s[12:15], s60 offen offset:1024 lds
  s_add_u32 s60, s60, 48128
  buffer_load_dwordx4 v10, s[12:15], s60 offen offset:2048 lds
  s_xor_b32 s60, s0, 1
  s_mul_i32 s60, s60, 393216
  s_add_u32 m0, s62, 8192
  s_add_u32 s60, s60, s61
  buffer_load_dwordx4 v10, s[12:15], s60 offen offset:0 lds
  s_add_u32 s60, s60, 48128
  buffer_load_dwordx4 v10, s[12:15], s60 offen offset:1024 lds
  s_xor_b32 s60, s0, 1
  s_mul_i32 s60, s60, 393216
  s_add_u32 m0, s62, 39936
  s_add_u32 s60, s60, s61
  buffer_load_dwordx4 v10, s[12:15], s60 offen offset:1024 lds
  s_add_u32 s60, s60, 48128
  buffer_load_dwordx4 v10, s[12:15], s60 offen offset:2048 lds
  s_xor_b32 s60, s0, 2
  s_mul_i32 s60, s60, 393216
  s_add_u32 m0, s62, 16384
  s_add_u32 s60, s60, s61
  buffer_load_dwordx4 v10, s[12:15], s60 offen offset:0 lds
  s_add_u32 s60, s60, 48128
  buffer_load_dwordx4 v10, s[12:15], s60 offen offset:1024 lds
  s_xor_b32 s60, s0, 2
  s_mul_i32 s60, s60, 393216
  s_add_u32 m0, s62, 48128
  s_add_u32 s60, s60, s61
  buffer_load_dwordx4 v10, s[12:15], s60 offen offset:1024 lds
  s_add_u32 s60, s60, 48128
  buffer_load_dwordx4 v10, s[12:15], s60 offen offset:2048 lds
  s_xor_b32 s60, s0, 3
  s_mul_i32 s60, s60, 393216
  s_add_u32 m0, s62, 24576
  s_add_u32 s60, s60, s61
  buffer_load_dwordx4 v10, s[12:15], s60 offen offset:0 lds
  s_add_u32 s60, s60, 48128
  buffer_load_dwordx4 v10, s[12:15], s60 offen offset:1024 lds
  s_xor_b32 s60, s0, 3
  s_mul_i32 s60, s60, 393216
  s_add_u32 m0, s62, 56320
  s_add_u32 s60, s60, s61
  buffer_load_dwordx4 v10, s[12:15], s60 offen offset:1024 lds
  s_add_u32 s60, s60, 48128
  buffer_load_dwordx4 v10, s[12:15], s60 offen offset:2048 lds
  s_branch L48
L89:
  buffer_store_dwordx4 v[16:19], v1, s[32:35], s55 offen sc1
  s_branch L90
L91:
  buffer_store_dwordx4 v[20:23], v1, s[32:35], s55 offen offset:1024 sc1
  s_branch L92
L93:
  buffer_store_dword v24, v15, s[28:31], s56 offen sc1
  s_branch L94
L95:
  s_waitcnt vmcnt(0)
  buffer_store_dword v14, off, s[28:31], s52 sc1
  s_branch L96
L98:
  s_mov_b32 s39, s38
  s_cmp_eq_u32 s51, 0
  s_cbranch_scc1 L102
L101:
  s_add_u32 s39, s39, 64
  s_and_b32 s44, s39, 448
  s_cbranch_scc0 L102
  s_buffer_load_dwordx4 s[44:47], s[28:31], s39 offset:3584
  s_waitcnt lgkmcnt(0)
  s_nand_b64 s[44:45], s[44:45], s[46:47]
  s_cbranch_scc0 L99
  s_branch L101
L102:
  s_mov_b32 s7, 30000
L100:
  buffer_load_dword v14, v6, s[28:31], s53 offen sc1
  s_waitcnt vmcnt(0)
  v_cmp_gt_u32 vcc, 8, v14
  s_cbranch_vccz L99
  s_sub_u32 s7, s7, 1
  s_cbranch_scc0 L100
  s_endpgm
L105:
  s_sub_u32 s7, s7, 1
  s_cbranch_scc1 L104
  buffer_load_dwordx4 v[128:131], v96, s[28:31], s61 offen offset:0 sc1
  buffer_load_dwordx4 v[132:135], v1, s[28:31], s62 offen offset:1024 sc1
  buffer_load_dwordx4 v[136:139], v96, s[28:31], s61 offen offset:2048 sc1
  buffer_load_dwordx4 v[140:143], v1, s[28:31], s62 offen offset:3072 sc1
  buffer_load_dwordx4 v[144:147], v97, s[28:31], s63 offen offset:0 sc1
  buffer_load_dwordx4 v[148:151], v1, s[28:31], s59 offen offset:1024 sc1
  buffer_load_dwordx4 v[152:155], v97, s[28:31], s63 offen offset:2048 sc1
  buffer_load_dwordx4 v[156:159], v1, s[28:31], s59 offen offset:3072 sc1
  s_branch L103
L107:
  ds_read_b128 v[40:43], v24 offset:0
  ds_read_b128 v[44:47], v24 offset:4112
  ds_read_b128 v[48:51], v24 offset:8224
  ds_read_b128 v[52:55], v24 offset:12336
  ds_read_b128 v[56:59], v24 offset:16448
  s_waitcnt vmcnt(19)
  ds_read_b128 v[60:63], v24 offset:20560
  ds_read_b128 v[64:67], v24 offset:24672
  ds_read_b128 v[68:71], v24 offset:28784
  ds_read_b128 v[72:75], v24 offset:32896
  s_waitcnt lgkmcnt(0)
  v_mfma_f32_32x32x16_bf16 v[96:111], v[72:75], v[16:19], 0
  v_mfma_f32_32x32x16_bf16 v[112:127], v[40:43], v[16:19], 0
  s_nop 11
  v_cndmask_b32_e64 v112, v112, v96, s[64:65]
  v_cndmask_b32_e64 v113, v113, v97, s[66:67]
  v_cndmask_b32_e64 v114, v114, v98, s[68:69]
  v_cndmask_b32_e64 v115, v115, v99, s[70:71]
  v_cndmask_b32_e64 v116, v116, v100, s[72:73]
  v_cndmask_b32_e64 v117, v117, v101, s[74:75]
  v_cndmask_b32_e64 v118, v118, v102, s[76:77]
  v_cndmask_b32_e64 v119, v119, v103, s[78:79]
  v_cndmask_b32_e64 v120, v120, v104, s[80:81]
  v_cndmask_b32_e64 v121, v121, v105, s[82:83]
  v_cndmask_b32_e64 v122, v122, v106, s[84:85]
  v_cndmask_b32_e64 v123, v123, v107, s[86:87]
  v_cndmask_b32_e64 v124, v124, v108, s[88:89]
  v_cndmask_b32_e64 v125, v125, v109, s[90:91]
  v_cndmask_b32_e64 v126, v126, v110, s[92:93]
  v_cndmask_b32_e64 v127, v127, v111, s[94:95]
  v_mov_b32 v29, v112
  v_max3_f32 v29, v29, v112, v113
  v_max3_f32 v29, v29, v114, v115
  v_max3_f32 v29, v29, v116, v117
  v_max3_f32 v29, v29, v118, v119
  v_max3_f32 v29, v29, v120, v121
  v_max3_f32 v29, v29, v122, v123
  v_max3_f32 v29, v29, v124, v125
  v_max3_f32 v29, v29, v126, v127
  v_mfma_f32_32x32x16_bf16 v[96:111], v[44:47], v[16:19], 0
  s_nop 11
  v_max3_f32 v29, v29, v96, v97
  v_max3_f32 v29, v29, v98, v99
  v_max3_f32 v29, v29, v100, v101
  v_max3_f32 v29, v29, v102, v103
  v_max3_f32 v29, v29, v104, v105
  v_max3_f32 v29, v29, v106, v107
  v_max3_f32 v29, v29, v108, v109
  v_max3_f32 v29, v29, v110, v111
  v_mfma_f32_32x32x16_bf16 v[112:127], v[48:51], v[16:19], 0
  s_nop 11
  v_max3_f32 v29, v29, v112, v113
  v_max3_f32 v29, v29, v114, v115
  v_max3_f32 v29, v29, v116, v117
  v_max3_f32 v29, v29, v118, v119
  v_max3_f32 v29, v29, v120, v121
  v_max3_f32 v29, v29, v122, v123
  v_max3_f32 v29, v29, v124, v125
  v_max3_f32 v29, v29, v126, v127
  v_mfma_f32_32x32x16_bf16 v[96:111], v[52:55], v[16:19], 0
  s_nop 11
  v_max3_f32 v29, v29, v96, v97
  v_max3_f32 v29, v29, v98, v99
  v_max3_f32 v29, v29, v100, v101
  v_max3_f32 v29, v29, v102, v103
  v_max3_f32 v29, v29, v104, v105
  v_max3_f32 v29, v29, v106, v107
  v_max3_f32 v29, v29, v108, v109
  v_max3_f32 v29, v29, v110, v111
  v_mfma_f32_32x32x16_bf16 v[112:127], v[56:59], v[16:19], 0
  s_nop 11
  v_max3_f32 v29, v29, v112, v113
  v_max3_f32 v29, v29, v114, v115
  v_max3_f32 v29, v29, v116, v117
  v_max3_f32 v29, v29, v118, v119
  v_max3_f32 v29, v29, v120, v121
  v_max3_f32 v29, v29, v122, v123
  v_max3_f32 v29, v29, v124, v125
  v_max3_f32 v29, v29, v126, v127
  v_mfma_f32_32x32x16_bf16 v[96:111], v[60:63], v[16:19], 0
  s_nop 11
  v_max3_f32 v29, v29, v96, v97
  v_max3_f32 v29, v29, v98, v99
  v_max3_f32 v29, v29, v100, v101
  v_max3_f32 v29, v29, v102, v103
  v_max3_f32 v29, v29, v104, v105
  v_max3_f32 v29, v29, v106, v107
  v_max3_f32 v29, v29, v108, v109
  v_max3_f32 v29, v29, v110, v111
  v_mfma_f32_32x32x16_bf16 v[112:127], v[64:67], v[16:19], 0
  s_nop 11
  v_max3_f32 v29, v29, v112, v113
  v_max3_f32 v29, v29, v114, v115
  v_max3_f32 v29, v29, v116, v117
  v_max3_f32 v29, v29, v118, v119
  v_max3_f32 v29, v29, v120, v121
  v_max3_f32 v29, v29, v122, v123
  v_max3_f32 v29, v29, v124, v125
  v_max3_f32 v29, v29, v126, v127
  v_mfma_f32_32x32x16_bf16 v[96:111], v[68:71], v[16:19], 0
  s_nop 11
  v_max3_f32 v29, v29, v96, v97
  v_max3_f32 v29, v29, v98, v99
  v_max3_f32 v29, v29, v100, v101
  v_max3_f32 v29, v29, v102, v103
  v_max3_f32 v29, v29, v104, v105
  v_max3_f32 v29, v29, v106, v107
  v_max3_f32 v29, v29, v108, v109
  v_max3_f32 v29, v29, v110, v111
  v_mov_b32 v31, v29
  s_nop 1
  v_permlane32_swap_b32 v29, v31
  v_max_f32 v29, v29, v31
  v_sub_f32 v192, 0, v29
  v_sub_f32 v193, 0, v29
  v_sub_f32 v194, 0, v29
  v_sub_f32 v195, 0, v29
  v_sub_f32 v196, 0, v29
  v_sub_f32 v197, 0, v29
  v_sub_f32 v198, 0, v29
  v_sub_f32 v199, 0, v29
  v_sub_f32 v200, 0, v29
  v_sub_f32 v201, 0, v29
  v_sub_f32 v202, 0, v29
  v_sub_f32 v203, 0, v29
  v_sub_f32 v204, 0, v29
  v_sub_f32 v205, 0, v29
  v_sub_f32 v206, 0, v29
  v_sub_f32 v207, 0, v29
  s_nop 1
  v_mfma_f32_32x32x16_bf16 v[96:111], v[72:75], v[16:19], v[192:207]
  v_mfma_f32_32x32x16_bf16 v[112:127], v[40:43], v[16:19], v[192:207]
  s_nop 11
  v_cndmask_b32_e64 v112, v112, v96, s[64:65]
  v_cndmask_b32_e64 v113, v113, v97, s[66:67]
  v_cndmask_b32_e64 v114, v114, v98, s[68:69]
  v_cndmask_b32_e64 v115, v115, v99, s[70:71]
  v_cndmask_b32_e64 v116, v116, v100, s[72:73]
  v_cndmask_b32_e64 v117, v117, v101, s[74:75]
  v_cndmask_b32_e64 v118, v118, v102, s[76:77]
  v_cndmask_b32_e64 v119, v119, v103, s[78:79]
  v_cndmask_b32_e64 v120, v120, v104, s[80:81]
  v_cndmask_b32_e64 v121, v121, v105, s[82:83]
  v_cndmask_b32_e64 v122, v122, v106, s[84:85]
  v_cndmask_b32_e64 v123, v123, v107, s[86:87]
  v_cndmask_b32_e64 v124, v124, v108, s[88:89]
  v_cndmask_b32_e64 v125, v125, v109, s[90:91]
  v_cndmask_b32_e64 v126, v126, v110, s[92:93]
  v_cndmask_b32_e64 v127, v127, v111, s[94:95]
  ds_read_b128 v[208:211], v25 offset:1024
  ds_read_b128 v[212:215], v26 offset:1536
  v_exp_f32 v112, v112
  v_exp_f32 v113, v113
  v_exp_f32 v114, v114
  v_exp_f32 v115, v115
  v_exp_f32 v116, v116
  v_exp_f32 v117, v117
  v_exp_f32 v118, v118
  v_exp_f32 v119, v119
  v_exp_f32 v120, v120
  v_exp_f32 v121, v121
  v_exp_f32 v122, v122
  v_exp_f32 v123, v123
  v_exp_f32 v124, v124
  v_exp_f32 v125, v125
  v_exp_f32 v126, v126
  v_exp_f32 v127, v127
  v_cvt_pk_bf16_f32 v112, v112, v113
  v_cvt_pk_bf16_f32 v113, v114, v115
  v_cvt_pk_bf16_f32 v114, v116, v117
  v_cvt_pk_bf16_f32 v115, v118, v119
  v_cvt_pk_bf16_f32 v116, v120, v121
  v_cvt_pk_bf16_f32 v117, v122, v123
  v_cvt_pk_bf16_f32 v118, v124, v125
  v_cvt_pk_bf16_f32 v119, v126, v127
  ds_read_b128 v[216:219], v25 offset:33920
  ds_read_b128 v[220:223], v26 offset:34432
  v_and_b32 v120, v112, v32
  v_xor_b32 v112, v112, v120
  v_and_b32 v121, v113, v33
  v_xor_b32 v113, v113, v121
  v_and_b32 v122, v114, v34
  v_xor_b32 v114, v114, v122
  v_and_b32 v123, v115, v35
  v_xor_b32 v115, v115, v123
  v_and_b32 v124, v116, v36
  v_xor_b32 v116, v116, v124
  v_and_b32 v125, v117, v37
  v_xor_b32 v117, v117, v125
  v_and_b32 v126, v118, v38
  v_xor_b32 v118, v118, v126
  v_and_b32 v127, v119, v39
  v_xor_b32 v119, v119, v127
  s_waitcnt lgkmcnt(1)
  v_mfma_f32_32x32x16_bf16 v[224:239], v[216:219], v[120:123], 0
  s_waitcnt lgkmcnt(0)
  v_mfma_f32_32x32x16_bf16 v[224:239], v[220:223], v[124:127], v[224:239]
  v_mfma_f32_32x32x16_bf16 v[224:239], v[208:211], v[112:115], v[224:239]
  v_mfma_f32_32x32x16_bf16 v[224:239], v[212:215], v[116:119], v[224:239]
  s_nop 15
  v_mfma_f32_32x32x16_bf16 v[96:111], v[44:47], v[16:19], v[192:207]
  ds_read_b128 v[208:211], v25 offset:5136
  ds_read_b128 v[212:215], v26 offset:5648
  s_nop 9
  v_exp_f32 v96, v96
  v_exp_f32 v97, v97
  v_exp_f32 v98, v98
  v_exp_f32 v99, v99
  v_exp_f32 v100, v100
  v_exp_f32 v101, v101
  v_exp_f32 v102, v102
  v_exp_f32 v103, v103
  v_exp_f32 v104, v104
  v_exp_f32 v105, v105
  v_exp_f32 v106, v106
  v_exp_f32 v107, v107
  v_exp_f32 v108, v108
  v_exp_f32 v109, v109
  v_exp_f32 v110, v110
  v_exp_f32 v111, v111
  v_cvt_pk_bf16_f32 v96, v96, v97
  v_cvt_pk_bf16_f32 v97, v98, v99
  v_cvt_pk_bf16_f32 v98, v100, v101
  v_cvt_pk_bf16_f32 v99, v102, v103
  v_cvt_pk_bf16_f32 v100, v104, v105
  v_cvt_pk_bf16_f32 v101, v106, v107
  v_cvt_pk_bf16_f32 v102, v108, v109
  v_cvt_pk_bf16_f32 v103, v110, v111
  s_waitcnt lgkmcnt(1)
  v_mfma_f32_32x32x16_bf16 v[224:239], v[208:211], v[96:99], v[224:239]
  s_waitcnt lgkmcnt(0)
  v_mfma_f32_32x32x16_bf16 v[224:239], v[212:215], v[100:103], v[224:239]
  s_nop 15
  v_mfma_f32_32x32x16_bf16 v[112:127], v[48:51], v[16:19], v[192:207]
  ds_read_b128 v[208:211], v25 offset:9248
  ds_read_b128 v[212:215], v26 offset:9760
  s_nop 9
  v_exp_f32 v112, v112
  v_exp_f32 v113, v113
  v_exp_f32 v114, v114
  v_exp_f32 v115, v115
  v_exp_f32 v116, v116
  v_exp_f32 v117, v117
  v_exp_f32 v118, v118
  v_exp_f32 v119, v119
  v_exp_f32 v120, v120
  v_exp_f32 v121, v121
  v_exp_f32 v122, v122
  v_exp_f32 v123, v123
  v_exp_f32 v124, v124
  v_exp_f32 v125, v125
  v_exp_f32 v126, v126
  v_exp_f32 v127, v127
  v_cvt_pk_bf16_f32 v112, v112, v113
  v_cvt_pk_bf16_f32 v113, v114, v115
  v_cvt_pk_bf16_f32 v114, v116, v117
  v_cvt_pk_bf16_f32 v115, v118, v119
  v_cvt_pk_bf16_f32 v116, v120, v121
  v_cvt_pk_bf16_f32 v117, v122, v123
  v_cvt_pk_bf16_f32 v118, v124, v125
  v_cvt_pk_bf16_f32 v119, v126, v127
  s_waitcnt lgkmcnt(1)
  v_mfma_f32_32x32x16_bf16 v[224:239], v[208:211], v[112:115], v[224:239]
  s_waitcnt lgkmcnt(0)
  v_mfma_f32_32x32x16_bf16 v[224:239], v[212:215], v[116:119], v[224:239]
  s_nop 15
  v_mfma_f32_32x32x16_bf16 v[96:111], v[52:55], v[16:19], v[192:207]
  ds_read_b128 v[208:211], v25 offset:13360
  ds_read_b128 v[212:215], v26 offset:13872
  s_nop 9
  v_exp_f32 v96, v96
  v_exp_f32 v97, v97
  v_exp_f32 v98, v98
  v_exp_f32 v99, v99
  v_exp_f32 v100, v100
  v_exp_f32 v101, v101
  v_exp_f32 v102, v102
  v_exp_f32 v103, v103
  v_exp_f32 v104, v104
  v_exp_f32 v105, v105
  v_exp_f32 v106, v106
  v_exp_f32 v107, v107
  v_exp_f32 v108, v108
  v_exp_f32 v109, v109
  v_exp_f32 v110, v110
  v_exp_f32 v111, v111
  v_cvt_pk_bf16_f32 v96, v96, v97
  v_cvt_pk_bf16_f32 v97, v98, v99
  v_cvt_pk_bf16_f32 v98, v100, v101
  v_cvt_pk_bf16_f32 v99, v102, v103
  v_cvt_pk_bf16_f32 v100, v104, v105
  v_cvt_pk_bf16_f32 v101, v106, v107
  v_cvt_pk_bf16_f32 v102, v108, v109
  v_cvt_pk_bf16_f32 v103, v110, v111
  s_waitcnt lgkmcnt(1)
  v_mfma_f32_32x32x16_bf16 v[224:239], v[208:211], v[96:99], v[224:239]
  s_waitcnt lgkmcnt(0)
  v_mfma_f32_32x32x16_bf16 v[224:239], v[212:215], v[100:103], v[224:239]
  s_nop 15
  v_mfma_f32_32x32x16_bf16 v[112:127], v[56:59], v[16:19], v[192:207]
  ds_read_b128 v[208:211], v25 offset:17472
  ds_read_b128 v[212:215], v26 offset:17984
  s_nop 9
  v_exp_f32 v112, v112
  v_exp_f32 v113, v113
  v_exp_f32 v114, v114
  v_exp_f32 v115, v115
  v_exp_f32 v116, v116
  v_exp_f32 v117, v117
  v_exp_f32 v118, v118
  v_exp_f32 v119, v119
  v_exp_f32 v120, v120
  v_exp_f32 v121, v121
  v_exp_f32 v122, v122
  v_exp_f32 v123, v123
  v_exp_f32 v124, v124
  v_exp_f32 v125, v125
  v_exp_f32 v126, v126
  v_exp_f32 v127, v127
  v_cvt_pk_bf16_f32 v112, v112, v113
  v_cvt_pk_bf16_f32 v113, v114, v115
  v_cvt_pk_bf16_f32 v114, v116, v117
  v_cvt_pk_bf16_f32 v115, v118, v119
  v_cvt_pk_bf16_f32 v116, v120, v121
  v_cvt_pk_bf16_f32 v117, v122, v123
  v_cvt_pk_bf16_f32 v118, v124, v125
  v_cvt_pk_bf16_f32 v119, v126, v127
  s_waitcnt lgkmcnt(1)
  v_mfma_f32_32x32x16_bf16 v[224:239], v[208:211], v[112:115], v[224:239]
  s_waitcnt lgkmcnt(0)
  v_mfma_f32_32x32x16_bf16 v[224:239], v[212:215], v[116:119], v[224:239]
  s_nop 15
  v_mfma_f32_32x32x16_bf16 v[96:111], v[60:63], v[16:19], v[192:207]
  ds_read_b128 v[208:211], v25 offset:21584
  ds_read_b128 v[212:215], v26 offset:22096
  s_nop 9
  v_exp_f32 v96, v96
  v_exp_f32 v97, v97
  v_exp_f32 v98, v98
  v_exp_f32 v99, v99
  v_exp_f32 v100, v100
  v_exp_f32 v101, v101
  v_exp_f32 v102, v102
  v_exp_f32 v103, v103
  v_exp_f32 v104, v104
  v_exp_f32 v105, v105
  v_exp_f32 v106, v106
  v_exp_f32 v107, v107
  v_exp_f32 v108, v108
  v_exp_f32 v109, v109
  v_exp_f32 v110, v110
  v_exp_f32 v111, v111
  v_cvt_pk_bf16_f32 v96, v96, v97
  v_cvt_pk_bf16_f32 v97, v98, v99
  v_cvt_pk_bf16_f32 v98, v100, v101
  v_cvt_pk_bf16_f32 v99, v102, v103
  v_cvt_pk_bf16_f32 v100, v104, v105
  v_cvt_pk_bf16_f32 v101, v106, v107
  v_cvt_pk_bf16_f32 v102, v108, v109
  v_cvt_pk_bf16_f32 v103, v110, v111
  s_waitcnt lgkmcnt(1)
  v_mfma_f32_32x32x16_bf16 v[224:239], v[208:211], v[96:99], v[224:239]
  s_waitcnt lgkmcnt(0)
  v_mfma_f32_32x32x16_bf16 v[224:239], v[212:215], v[100:103], v[224:239]
  s_nop 15
  v_mfma_f32_32x32x16_bf16 v[112:127], v[64:67], v[16:19], v[192:207]
  ds_read_b128 v[208:211], v25 offset:25696
  ds_read_b128 v[212:215], v26 offset:26208
  s_nop 9
  v_exp_f32 v112, v112
  v_exp_f32 v113, v113
  v_exp_f32 v114, v114
  v_exp_f32 v115, v115
  v_exp_f32 v116, v116
  v_exp_f32 v117, v117
  v_exp_f32 v118, v118
  v_exp_f32 v119, v119
  v_exp_f32 v120, v120
  v_exp_f32 v121, v121
  v_exp_f32 v122, v122
  v_exp_f32 v123, v123
  v_exp_f32 v124, v124
  v_exp_f32 v125, v125
  v_exp_f32 v126, v126
  v_exp_f32 v127, v127
  v_cvt_pk_bf16_f32 v112, v112, v113
  v_cvt_pk_bf16_f32 v113, v114, v115
  v_cvt_pk_bf16_f32 v114, v116, v117
  v_cvt_pk_bf16_f32 v115, v118, v119
  v_cvt_pk_bf16_f32 v116, v120, v121
  v_cvt_pk_bf16_f32 v117, v122, v123
  v_cvt_pk_bf16_f32 v118, v124, v125
  v_cvt_pk_bf16_f32 v119, v126, v127
  s_waitcnt lgkmcnt(1)
  v_mfma_f32_32x32x16_bf16 v[224:239], v[208:211], v[112:115], v[224:239]
  s_waitcnt lgkmcnt(0)
  v_mfma_f32_32x32x16_bf16 v[224:239], v[212:215], v[116:119], v[224:239]
  s_nop 15
  v_mfma_f32_32x32x16_bf16 v[96:111], v[68:71], v[16:19], v[192:207]
  ds_read_b128 v[208:211], v25 offset:29808
  ds_read_b128 v[212:215], v26 offset:30320
  s_nop 9
  v_exp_f32 v96, v96
  v_exp_f32 v97, v97
  v_exp_f32 v98, v98
  v_exp_f32 v99, v99
  v_exp_f32 v100, v100
  v_exp_f32 v101, v101
  v_exp_f32 v102, v102
  v_exp_f32 v103, v103
  v_exp_f32 v104, v104
  v_exp_f32 v105, v105
  v_exp_f32 v106, v106
  v_exp_f32 v107, v107
  v_exp_f32 v108, v108
  v_exp_f32 v109, v109
  v_exp_f32 v110, v110
  v_exp_f32 v111, v111
  v_cvt_pk_bf16_f32 v96, v96, v97
  v_cvt_pk_bf16_f32 v97, v98, v99
  v_cvt_pk_bf16_f32 v98, v100, v101
  v_cvt_pk_bf16_f32 v99, v102, v103
  v_cvt_pk_bf16_f32 v100, v104, v105
  v_cvt_pk_bf16_f32 v101, v106, v107
  v_cvt_pk_bf16_f32 v102, v108, v109
  v_cvt_pk_bf16_f32 v103, v110, v111
  s_waitcnt lgkmcnt(1)
  v_mfma_f32_32x32x16_bf16 v[224:239], v[208:211], v[96:99], v[224:239]
  s_waitcnt lgkmcnt(0)
  v_mfma_f32_32x32x16_bf16 v[224:239], v[212:215], v[100:103], v[224:239]
  s_nop 15
  v_rcp_f32 v31, v232
  s_nop 0
  v_mul_f32 v224, v224, v31
  v_mul_f32 v225, v225, v31
  v_mul_f32 v226, v226, v31
  v_mul_f32 v227, v227, v31
  v_mul_f32 v228, v228, v31
  v_mul_f32 v229, v229, v31
  v_mul_f32 v230, v230, v31
  v_mul_f32 v231, v231, v31
  v_cvt_pk_bf16_f32 v232, v224, v225
  v_cvt_pk_bf16_f32 v233, v226, v227
  v_cvt_pk_bf16_f32 v234, v228, v229
  v_cvt_pk_bf16_f32 v235, v230, v231
  buffer_store_dwordx4 v[232:235], v1, s[28:31], s54 offen offset:0 sc1
  ds_read_b128 v[40:43], v24 offset:2048
  ds_read_b128 v[44:47], v24 offset:6160
  ds_read_b128 v[48:51], v24 offset:10272
  ds_read_b128 v[52:55], v24 offset:14384
  ds_read_b128 v[56:59], v24 offset:18496
  ds_read_b128 v[60:63], v24 offset:22608
  ds_read_b128 v[64:67], v24 offset:26720
  ds_read_b128 v[68:71], v24 offset:30832
  ds_read_b128 v[72:75], v24 offset:34944
  s_waitcnt lgkmcnt(0)
  v_mfma_f32_32x32x16_bf16 v[96:111], v[72:75], v[20:23], 0
  v_mfma_f32_32x32x16_bf16 v[112:127], v[40:43], v[20:23], 0
  s_nop 11
  v_cndmask_b32_e64 v112, v112, v96, s[64:65]
  v_cndmask_b32_e64 v113, v113, v97, s[66:67]
  v_cndmask_b32_e64 v114, v114, v98, s[68:69]
  v_cndmask_b32_e64 v115, v115, v99, s[70:71]
  v_cndmask_b32_e64 v116, v116, v100, s[72:73]
  v_cndmask_b32_e64 v117, v117, v101, s[74:75]
  v_cndmask_b32_e64 v118, v118, v102, s[76:77]
  v_cndmask_b32_e64 v119, v119, v103, s[78:79]
  v_cndmask_b32_e64 v120, v120, v104, s[80:81]
  v_cndmask_b32_e64 v121, v121, v105, s[82:83]
  v_cndmask_b32_e64 v122, v122, v106, s[84:85]
  v_cndmask_b32_e64 v123, v123, v107, s[86:87]
  v_cndmask_b32_e64 v124, v124, v108, s[88:89]
  v_cndmask_b32_e64 v125, v125, v109, s[90:91]
  v_cndmask_b32_e64 v126, v126, v110, s[92:93]
  v_cndmask_b32_e64 v127, v127, v111, s[94:95]
  v_mov_b32 v29, v112
  v_max3_f32 v29, v29, v112, v113
  v_max3_f32 v29, v29, v114, v115
  v_max3_f32 v29, v29, v116, v117
  v_max3_f32 v29, v29, v118, v119
  v_max3_f32 v29, v29, v120, v121
  v_max3_f32 v29, v29, v122, v123
  v_max3_f32 v29, v29, v124, v125
  v_max3_f32 v29, v29, v126, v127
  v_mfma_f32_32x32x16_bf16 v[96:111], v[44:47], v[20:23], 0
  s_nop 11
  v_max3_f32 v29, v29, v96, v97
  v_max3_f32 v29, v29, v98, v99
  v_max3_f32 v29, v29, v100, v101
  v_max3_f32 v29, v29, v102, v103
  v_max3_f32 v29, v29, v104, v105
  v_max3_f32 v29, v29, v106, v107
  v_max3_f32 v29, v29, v108, v109
  v_max3_f32 v29, v29, v110, v111
  v_mfma_f32_32x32x16_bf16 v[112:127], v[48:51], v[20:23], 0
  s_nop 11
  v_max3_f32 v29, v29, v112, v113
  v_max3_f32 v29, v29, v114, v115
  v_max3_f32 v29, v29, v116, v117
  v_max3_f32 v29, v29, v118, v119
  v_max3_f32 v29, v29, v120, v121
  v_max3_f32 v29, v29, v122, v123
  v_max3_f32 v29, v29, v124, v125
  v_max3_f32 v29, v29, v126, v127
  v_mfma_f32_32x32x16_bf16 v[96:111], v[52:55], v[20:23], 0
  s_nop 11
  v_max3_f32 v29, v29, v96, v97
  v_max3_f32 v29, v29, v98, v99
  v_max3_f32 v29, v29, v100, v101
  v_max3_f32 v29, v29, v102, v103
  v_max3_f32 v29, v29, v104, v105
  v_max3_f32 v29, v29, v106, v107
  v_max3_f32 v29, v29, v108, v109
  v_max3_f32 v29, v29, v110, v111
  v_mfma_f32_32x32x16_bf16 v[112:127], v[56:59], v[20:23], 0
  s_nop 11
  v_max3_f32 v29, v29, v112, v113
  v_max3_f32 v29, v29, v114, v115
  v_max3_f32 v29, v29, v116, v117
  v_max3_f32 v29, v29, v118, v119
  v_max3_f32 v29, v29, v120, v121
  v_max3_f32 v29, v29, v122, v123
  v_max3_f32 v29, v29, v124, v125
  v_max3_f32 v29, v29, v126, v127
  v_mfma_f32_32x32x16_bf16 v[96:111], v[60:63], v[20:23], 0
  s_nop 11
  v_max3_f32 v29, v29, v96, v97
  v_max3_f32 v29, v29, v98, v99
  v_max3_f32 v29, v29, v100, v101
  v_max3_f32 v29, v29, v102, v103
  v_max3_f32 v29, v29, v104, v105
  v_max3_f32 v29, v29, v106, v107
  v_max3_f32 v29, v29, v108, v109
  v_max3_f32 v29, v29, v110, v111
  v_mfma_f32_32x32x16_bf16 v[112:127], v[64:67], v[20:23], 0
  s_nop 11
  v_max3_f32 v29, v29, v112, v113
  v_max3_f32 v29, v29, v114, v115
  v_max3_f32 v29, v29, v116, v117
  v_max3_f32 v29, v29, v118, v119
  v_max3_f32 v29, v29, v120, v121
  v_max3_f32 v29, v29, v122, v123
  v_max3_f32 v29, v29, v124, v125
  v_max3_f32 v29, v29, v126, v127
  v_mfma_f32_32x32x16_bf16 v[96:111], v[68:71], v[20:23], 0
  s_nop 11
  v_max3_f32 v29, v29, v96, v97
  v_max3_f32 v29, v29, v98, v99
  v_max3_f32 v29, v29, v100, v101
  v_max3_f32 v29, v29, v102, v103
  v_max3_f32 v29, v29, v104, v105
  v_max3_f32 v29, v29, v106, v107
  v_max3_f32 v29, v29, v108, v109
  v_max3_f32 v29, v29, v110, v111
  v_mov_b32 v31, v29
  s_nop 1
  v_permlane32_swap_b32 v29, v31
  v_max_f32 v29, v29, v31
  v_sub_f32 v192, 0, v29
  v_sub_f32 v193, 0, v29
  v_sub_f32 v194, 0, v29
  v_sub_f32 v195, 0, v29
  v_sub_f32 v196, 0, v29
  v_sub_f32 v197, 0, v29
  v_sub_f32 v198, 0, v29
  v_sub_f32 v199, 0, v29
  v_sub_f32 v200, 0, v29
  v_sub_f32 v201, 0, v29
  v_sub_f32 v202, 0, v29
  v_sub_f32 v203, 0, v29
  v_sub_f32 v204, 0, v29
  v_sub_f32 v205, 0, v29
  v_sub_f32 v206, 0, v29
  v_sub_f32 v207, 0, v29
  s_nop 1
  v_mfma_f32_32x32x16_bf16 v[96:111], v[72:75], v[20:23], v[192:207]
  v_mfma_f32_32x32x16_bf16 v[112:127], v[40:43], v[20:23], v[192:207]
  s_nop 11
  v_cndmask_b32_e64 v112, v112, v96, s[64:65]
  v_cndmask_b32_e64 v113, v113, v97, s[66:67]
  v_cndmask_b32_e64 v114, v114, v98, s[68:69]
  v_cndmask_b32_e64 v115, v115, v99, s[70:71]
  v_cndmask_b32_e64 v116, v116, v100, s[72:73]
  v_cndmask_b32_e64 v117, v117, v101, s[74:75]
  v_cndmask_b32_e64 v118, v118, v102, s[76:77]
  v_cndmask_b32_e64 v119, v119, v103, s[78:79]
  v_cndmask_b32_e64 v120, v120, v104, s[80:81]
  v_cndmask_b32_e64 v121, v121, v105, s[82:83]
  v_cndmask_b32_e64 v122, v122, v106, s[84:85]
  v_cndmask_b32_e64 v123, v123, v107, s[86:87]
  v_cndmask_b32_e64 v124, v124, v108, s[88:89]
  v_cndmask_b32_e64 v125, v125, v109, s[90:91]
  v_cndmask_b32_e64 v126, v126, v110, s[92:93]
  v_cndmask_b32_e64 v127, v127, v111, s[94:95]
  ds_read_b128 v[208:211], v27 offset:3072
  ds_read_b128 v[212:215], v28 offset:3584
  v_exp_f32 v112, v112
  v_exp_f32 v113, v113
  v_exp_f32 v114, v114
  v_exp_f32 v115, v115
  v_exp_f32 v116, v116
  v_exp_f32 v117, v117
  v_exp_f32 v118, v118
  v_exp_f32 v119, v119
  v_exp_f32 v120, v120
  v_exp_f32 v121, v121
  v_exp_f32 v122, v122
  v_exp_f32 v123, v123
  v_exp_f32 v124, v124
  v_exp_f32 v125, v125
  v_exp_f32 v126, v126
  v_exp_f32 v127, v127
  v_cvt_pk_bf16_f32 v112, v112, v113
  v_cvt_pk_bf16_f32 v113, v114, v115
  v_cvt_pk_bf16_f32 v114, v116, v117
  v_cvt_pk_bf16_f32 v115, v118, v119
  v_cvt_pk_bf16_f32 v116, v120, v121
  v_cvt_pk_bf16_f32 v117, v122, v123
  v_cvt_pk_bf16_f32 v118, v124, v125
  v_cvt_pk_bf16_f32 v119, v126, v127
  ds_read_b128 v[216:219], v27 offset:35968
  ds_read_b128 v[220:223], v28 offset:36480
  v_and_b32 v120, v112, v32
  v_xor_b32 v112, v112, v120
  v_and_b32 v121, v113, v33
  v_xor_b32 v113, v113, v121
  v_and_b32 v122, v114, v34
  v_xor_b32 v114, v114, v122
  v_and_b32 v123, v115, v35
  v_xor_b32 v115, v115, v123
  v_and_b32 v124, v116, v36
  v_xor_b32 v116, v116, v124
  v_and_b32 v125, v117, v37
  v_xor_b32 v117, v117, v125
  v_and_b32 v126, v118, v38
  v_xor_b32 v118, v118, v126
  v_and_b32 v127, v119, v39
  v_xor_b32 v119, v119, v127
  s_waitcnt lgkmcnt(1)
  v_mfma_f32_32x32x16_bf16 v[224:239], v[216:219], v[120:123], 0
  s_waitcnt lgkmcnt(0)
  v_mfma_f32_32x32x16_bf16 v[224:239], v[220:223], v[124:127], v[224:239]
  v_mfma_f32_32x32x16_bf16 v[224:239], v[208:211], v[112:115], v[224:239]
  v_mfma_f32_32x32x16_bf16 v[224:239], v[212:215], v[116:119], v[224:239]
  s_nop 15
  v_mfma_f32_32x32x16_bf16 v[96:111], v[44:47], v[20:23], v[192:207]
  ds_read_b128 v[208:211], v27 offset:7184
  ds_read_b128 v[212:215], v28 offset:7696
  s_nop 9
  v_exp_f32 v96, v96
  v_exp_f32 v97, v97
  v_exp_f32 v98, v98
  v_exp_f32 v99, v99
  v_exp_f32 v100, v100
  v_exp_f32 v101, v101
  v_exp_f32 v102, v102
  v_exp_f32 v103, v103
  v_exp_f32 v104, v104
  v_exp_f32 v105, v105
  v_exp_f32 v106, v106
  v_exp_f32 v107, v107
  v_exp_f32 v108, v108
  v_exp_f32 v109, v109
  v_exp_f32 v110, v110
  v_exp_f32 v111, v111
  v_cvt_pk_bf16_f32 v96, v96, v97
  v_cvt_pk_bf16_f32 v97, v98, v99
  v_cvt_pk_bf16_f32 v98, v100, v101
  v_cvt_pk_bf16_f32 v99, v102, v103
  v_cvt_pk_bf16_f32 v100, v104, v105
  v_cvt_pk_bf16_f32 v101, v106, v107
  v_cvt_pk_bf16_f32 v102, v108, v109
  v_cvt_pk_bf16_f32 v103, v110, v111
  s_waitcnt lgkmcnt(1)
  v_mfma_f32_32x32x16_bf16 v[224:239], v[208:211], v[96:99], v[224:239]
  s_waitcnt lgkmcnt(0)
  v_mfma_f32_32x32x16_bf16 v[224:239], v[212:215], v[100:103], v[224:239]
  s_nop 15
  v_mfma_f32_32x32x16_bf16 v[112:127], v[48:51], v[20:23], v[192:207]
  ds_read_b128 v[208:211], v27 offset:11296
  ds_read_b128 v[212:215], v28 offset:11808
  s_nop 9
  v_exp_f32 v112, v112
  v_exp_f32 v113, v113
  v_exp_f32 v114, v114
  v_exp_f32 v115, v115
  v_exp_f32 v116, v116
  v_exp_f32 v117, v117
  v_exp_f32 v118, v118
  v_exp_f32 v119, v119
  v_exp_f32 v120, v120
  v_exp_f32 v121, v121
  v_exp_f32 v122, v122
  v_exp_f32 v123, v123
  v_exp_f32 v124, v124
  v_exp_f32 v125, v125
  v_exp_f32 v126, v126
  v_exp_f32 v127, v127
  v_cvt_pk_bf16_f32 v112, v112, v113
  v_cvt_pk_bf16_f32 v113, v114, v115
  v_cvt_pk_bf16_f32 v114, v116, v117
  v_cvt_pk_bf16_f32 v115, v118, v119
  v_cvt_pk_bf16_f32 v116, v120, v121
  v_cvt_pk_bf16_f32 v117, v122, v123
  v_cvt_pk_bf16_f32 v118, v124, v125
  v_cvt_pk_bf16_f32 v119, v126, v127
  s_waitcnt lgkmcnt(1)
  v_mfma_f32_32x32x16_bf16 v[224:239], v[208:211], v[112:115], v[224:239]
  s_waitcnt lgkmcnt(0)
  v_mfma_f32_32x32x16_bf16 v[224:239], v[212:215], v[116:119], v[224:239]
  s_nop 15
  v_mfma_f32_32x32x16_bf16 v[96:111], v[52:55], v[20:23], v[192:207]
  ds_read_b128 v[208:211], v27 offset:15408
  ds_read_b128 v[212:215], v28 offset:15920
  s_nop 9
  v_exp_f32 v96, v96
  v_exp_f32 v97, v97
  v_exp_f32 v98, v98
  v_exp_f32 v99, v99
  v_exp_f32 v100, v100
  v_exp_f32 v101, v101
  v_exp_f32 v102, v102
  v_exp_f32 v103, v103
  v_exp_f32 v104, v104
  v_exp_f32 v105, v105
  v_exp_f32 v106, v106
  v_exp_f32 v107, v107
  v_exp_f32 v108, v108
  v_exp_f32 v109, v109
  v_exp_f32 v110, v110
  v_exp_f32 v111, v111
  v_cvt_pk_bf16_f32 v96, v96, v97
  v_cvt_pk_bf16_f32 v97, v98, v99
  v_cvt_pk_bf16_f32 v98, v100, v101
  v_cvt_pk_bf16_f32 v99, v102, v103
  v_cvt_pk_bf16_f32 v100, v104, v105
  v_cvt_pk_bf16_f32 v101, v106, v107
  v_cvt_pk_bf16_f32 v102, v108, v109
  v_cvt_pk_bf16_f32 v103, v110, v111
  s_waitcnt lgkmcnt(1)
  v_mfma_f32_32x32x16_bf16 v[224:239], v[208:211], v[96:99], v[224:239]
  s_waitcnt lgkmcnt(0)
  v_mfma_f32_32x32x16_bf16 v[224:239], v[212:215], v[100:103], v[224:239]
  s_nop 15
  v_mfma_f32_32x32x16_bf16 v[112:127], v[56:59], v[20:23], v[192:207]
  ds_read_b128 v[208:211], v27 offset:19520
  ds_read_b128 v[212:215], v28 offset:20032
  s_nop 9
  v_exp_f32 v112, v112
  v_exp_f32 v113, v113
  v_exp_f32 v114, v114
  v_exp_f32 v115, v115
  v_exp_f32 v116, v116
  v_exp_f32 v117, v117
  v_exp_f32 v118, v118
  v_exp_f32 v119, v119
  v_exp_f32 v120, v120
  v_exp_f32 v121, v121
  v_exp_f32 v122, v122
  v_exp_f32 v123, v123
  v_exp_f32 v124, v124
  v_exp_f32 v125, v125
  v_exp_f32 v126, v126
  v_exp_f32 v127, v127
  v_cvt_pk_bf16_f32 v112, v112, v113
  v_cvt_pk_bf16_f32 v113, v114, v115
  v_cvt_pk_bf16_f32 v114, v116, v117
  v_cvt_pk_bf16_f32 v115, v118, v119
  v_cvt_pk_bf16_f32 v116, v120, v121
  v_cvt_pk_bf16_f32 v117, v122, v123
  v_cvt_pk_bf16_f32 v118, v124, v125
  v_cvt_pk_bf16_f32 v119, v126, v127
  s_waitcnt lgkmcnt(1)
  v_mfma_f32_32x32x16_bf16 v[224:239], v[208:211], v[112:115], v[224:239]
  s_waitcnt lgkmcnt(0)
  v_mfma_f32_32x32x16_bf16 v[224:239], v[212:215], v[116:119], v[224:239]
  s_nop 15
  v_mfma_f32_32x32x16_bf16 v[96:111], v[60:63], v[20:23], v[192:207]
  ds_read_b128 v[208:211], v27 offset:23632
  ds_read_b128 v[212:215], v28 offset:24144
  s_nop 9
  v_exp_f32 v96, v96
  v_exp_f32 v97, v97
  v_exp_f32 v98, v98
  v_exp_f32 v99, v99
  v_exp_f32 v100, v100
  v_exp_f32 v101, v101
  v_exp_f32 v102, v102
  v_exp_f32 v103, v103
  v_exp_f32 v104, v104
  v_exp_f32 v105, v105
  v_exp_f32 v106, v106
  v_exp_f32 v107, v107
  v_exp_f32 v108, v108
  v_exp_f32 v109, v109
  v_exp_f32 v110, v110
  v_exp_f32 v111, v111
  v_cvt_pk_bf16_f32 v96, v96, v97
  v_cvt_pk_bf16_f32 v97, v98, v99
  v_cvt_pk_bf16_f32 v98, v100, v101
  v_cvt_pk_bf16_f32 v99, v102, v103
  v_cvt_pk_bf16_f32 v100, v104, v105
  v_cvt_pk_bf16_f32 v101, v106, v107
  v_cvt_pk_bf16_f32 v102, v108, v109
  v_cvt_pk_bf16_f32 v103, v110, v111
  s_waitcnt lgkmcnt(1)
  v_mfma_f32_32x32x16_bf16 v[224:239], v[208:211], v[96:99], v[224:239]
  s_waitcnt lgkmcnt(0)
  v_mfma_f32_32x32x16_bf16 v[224:239], v[212:215], v[100:103], v[224:239]
  s_nop 15
  v_mfma_f32_32x32x16_bf16 v[112:127], v[64:67], v[20:23], v[192:207]
  ds_read_b128 v[208:211], v27 offset:27744
  ds_read_b128 v[212:215], v28 offset:28256
  s_nop 9
  v_exp_f32 v112, v112
  v_exp_f32 v113, v113
  v_exp_f32 v114, v114
  v_exp_f32 v115, v115
  v_exp_f32 v116, v116
  v_exp_f32 v117, v117
  v_exp_f32 v118, v118
  v_exp_f32 v119, v119
  v_exp_f32 v120, v120
  v_exp_f32 v121, v121
  v_exp_f32 v122, v122
  v_exp_f32 v123, v123
  v_exp_f32 v124, v124
  v_exp_f32 v125, v125
  v_exp_f32 v126, v126
  v_exp_f32 v127, v127
  v_cvt_pk_bf16_f32 v112, v112, v113
  v_cvt_pk_bf16_f32 v113, v114, v115
  v_cvt_pk_bf16_f32 v114, v116, v117
  v_cvt_pk_bf16_f32 v115, v118, v119
  v_cvt_pk_bf16_f32 v116, v120, v121
  v_cvt_pk_bf16_f32 v117, v122, v123
  v_cvt_pk_bf16_f32 v118, v124, v125
  v_cvt_pk_bf16_f32 v119, v126, v127
  s_waitcnt lgkmcnt(1)
  v_mfma_f32_32x32x16_bf16 v[224:239], v[208:211], v[112:115], v[224:239]
  s_waitcnt lgkmcnt(0)
  v_mfma_f32_32x32x16_bf16 v[224:239], v[212:215], v[116:119], v[224:239]
  s_nop 15
  v_mfma_f32_32x32x16_bf16 v[96:111], v[68:71], v[20:23], v[192:207]
  ds_read_b128 v[208:211], v27 offset:31856
  ds_read_b128 v[212:215], v28 offset:32368
  s_nop 9
  v_exp_f32 v96, v96
  v_exp_f32 v97, v97
  v_exp_f32 v98, v98
  v_exp_f32 v99, v99
  v_exp_f32 v100, v100
  v_exp_f32 v101, v101
  v_exp_f32 v102, v102
  v_exp_f32 v103, v103
  v_exp_f32 v104, v104
  v_exp_f32 v105, v105
  v_exp_f32 v106, v106
  v_exp_f32 v107, v107
  v_exp_f32 v108, v108
  v_exp_f32 v109, v109
  v_exp_f32 v110, v110
  v_exp_f32 v111, v111
  v_cvt_pk_bf16_f32 v96, v96, v97
  v_cvt_pk_bf16_f32 v97, v98, v99
  v_cvt_pk_bf16_f32 v98, v100, v101
  v_cvt_pk_bf16_f32 v99, v102, v103
  v_cvt_pk_bf16_f32 v100, v104, v105
  v_cvt_pk_bf16_f32 v101, v106, v107
  v_cvt_pk_bf16_f32 v102, v108, v109
  v_cvt_pk_bf16_f32 v103, v110, v111
  s_waitcnt lgkmcnt(1)
  v_mfma_f32_32x32x16_bf16 v[224:239], v[208:211], v[96:99], v[224:239]
  s_waitcnt lgkmcnt(0)
  v_mfma_f32_32x32x16_bf16 v[224:239], v[212:215], v[100:103], v[224:239]
  s_nop 15
  v_rcp_f32 v31, v232
  s_nop 0
  v_mul_f32 v224, v224, v31
  v_mul_f32 v225, v225, v31
  v_mul_f32 v226, v226, v31
  v_mul_f32 v227, v227, v31
  v_mul_f32 v228, v228, v31
  v_mul_f32 v229, v229, v31
  v_mul_f32 v230, v230, v31
  v_mul_f32 v231, v231, v31
  v_cvt_pk_bf16_f32 v232, v224, v225
  v_cvt_pk_bf16_f32 v233, v226, v227
  v_cvt_pk_bf16_f32 v234, v228, v229
  v_cvt_pk_bf16_f32 v235, v230, v231
  buffer_store_dwordx4 v[232:235], v1, s[28:31], s54 offen offset:1024 sc1
  s_waitcnt vmcnt(0)
  v_mov_b32 v56, 0
  s_branch L108
L109:
  s_waitcnt vmcnt(0)
  buffer_store_dword v14, off, s[28:31], s52 sc1
  s_branch L110
L111:
  s_mov_b32 s39, s36
  s_cmp_eq_u32 s51, 0
  s_cbranch_scc1 L115
L114:
  s_add_u32 s39, s39, 64
  s_and_b32 s44, s39, 448
  s_cbranch_scc0 L115
  s_buffer_load_dwordx2 s[44:45], s[28:31], s39 offset:512
  s_waitcnt lgkmcnt(0)
  s_nand_b32 s44, s44, s45
  s_cbranch_scc0 L112
  s_branch L114
L115:
  s_mov_b32 s7, 30000
L113:
  buffer_load_dword v53, v7, s[28:31], s53 offen sc1
  s_waitcnt vmcnt(0)
  v_cmp_gt_u32 vcc, 17, v53
  s_cbranch_vccz L112
  s_sub_u32 s7, s7, 1
  s_cbranch_scc0 L113
  s_endpgm
L117:
  buffer_store_dwordx4 v[80:83], v1, s[32:35], s55 offen sc1
  s_branch L118
L119:
  buffer_store_dwordx4 v[84:87], v1, s[32:35], s55 offen offset:1024 sc1
  s_branch L120
L121:
  buffer_store_dword v88, v15, s[28:31], s56 offen sc1
  s_branch L122
L123:
  s_waitcnt vmcnt(0)
  buffer_store_dword v14, off, s[28:31], s52 sc1
  s_branch L124
L126:
  s_mov_b32 s39, s38
  s_cmp_eq_u32 s51, 0
  s_cbranch_scc1 L130
L129:
  s_add_u32 s39, s39, 64
  s_and_b32 s44, s39, 448
  s_cbranch_scc0 L130
  s_buffer_load_dwordx4 s[44:47], s[28:31], s39 offset:7168
  s_waitcnt lgkmcnt(0)
  s_nand_b64 s[44:45], s[44:45], s[46:47]
  s_cbranch_scc0 L127
  s_branch L129
L130:
  s_mov_b32 s7, 30000
L128:
  buffer_load_dword v14, v6, s[28:31], s53 offen sc1
  s_waitcnt vmcnt(0)
  v_cmp_gt_u32 vcc, 19, v14
  s_cbranch_vccz L127
  s_sub_u32 s7, s7, 1
  s_cbranch_scc0 L128
  s_endpgm
L131:
  buffer_store_dword v14, off, s[28:31], s52 sc1
  s_branch L132
L133:
  s_mov_b32 s39, s37
  s_cmp_eq_u32 s51, 0
  s_cbranch_scc1 L137
L136:
  s_add_u32 s39, s39, 64
  s_and_b32 s44, s39, 192
  s_cbranch_scc0 L137
  s_buffer_load_dwordx4 s[44:47], s[28:31], s39 offset:5120
  s_waitcnt lgkmcnt(0)
  s_or_b32 s47, s47, 0xffff0000
  s_nand_b64 s[44:45], s[44:45], s[46:47]
  s_cbranch_scc0 L134
  s_branch L136
L137:
  s_mov_b32 s7, 30000
L135:
  buffer_load_dword v13, v8, s[28:31], s53 offen sc1
  s_waitcnt vmcnt(0)
  v_cmp_gt_u32 vcc, 20, v13
  s_cbranch_vccz L134
  s_sub_u32 s7, s7, 1
  s_cbranch_scc0 L135
  s_endpgm
L138:
  buffer_store_dword v14, off, s[28:31], s52 sc1
  s_branch L139
L140:
  s_mov_b32 s39, s37
  s_cmp_eq_u32 s51, 0
  s_cbranch_scc1 L144
L143:
  s_add_u32 s39, s39, 64
  s_and_b32 s44, s39, 192
  s_cbranch_scc0 L144
  s_buffer_load_dwordx4 s[44:47], s[28:31], s39 offset:5632
  s_waitcnt lgkmcnt(0)
  s_or_b32 s47, s47, 0xffff0000
  s_nand_b64 s[44:45], s[44:45], s[46:47]
  s_cbranch_scc0 L141
  s_branch L143
L144:
  s_mov_b32 s7, 30000
L142:
  buffer_load_dword v13, v8, s[28:31], s53 offen sc1
  s_waitcnt vmcnt(0)
  v_cmp_gt_u32 vcc, 21, v13
  s_cbranch_vccz L141
  s_sub_u32 s7, s7, 1
  s_cbranch_scc0 L142
  s_endpgm
L145:
  buffer_store_dword v14, off, s[28:31], s52 sc1
  s_branch L146
L147:
  s_mov_b32 s39, s37
  s_cmp_eq_u32 s51, 0
  s_cbranch_scc1 L151
L150:
  s_add_u32 s39, s39, 64
  s_and_b32 s44, s39, 192
  s_cbranch_scc0 L151
  s_buffer_load_dwordx4 s[44:47], s[28:31], s39 offset:6144
  s_waitcnt lgkmcnt(0)
  s_or_b32 s47, s47, 0xffff0000
  s_nand_b64 s[44:45], s[44:45], s[46:47]
  s_cbranch_scc0 L148
  s_branch L150
L151:
  s_mov_b32 s7, 30000
L149:
  buffer_load_dword v13, v8, s[28:31], s53 offen sc1
  s_waitcnt vmcnt(0)
  v_cmp_gt_u32 vcc, 22, v13
  s_cbranch_vccz L148
  s_sub_u32 s7, s7, 1
  s_cbranch_scc0 L149
  s_endpgm
L152:
  buffer_store_dword v14, off, s[28:31], s52 sc1
  s_branch L153
L154:
  s_mov_b32 s39, s37
  s_cmp_eq_u32 s51, 0
  s_cbranch_scc1 L158
L157:
  s_add_u32 s39, s39, 64
  s_and_b32 s44, s39, 192
  s_cbranch_scc0 L158
  s_buffer_load_dwordx4 s[44:47], s[28:31], s39 offset:6656
  s_waitcnt lgkmcnt(0)
  s_or_b32 s47, s47, 0xffff0000
  s_nand_b64 s[44:45], s[44:45], s[46:47]
  s_cbranch_scc0 L155
  s_branch L157
L158:
  s_mov_b32 s7, 30000
L156:
  buffer_load_dword v13, v8, s[28:31], s53 offen sc1
  s_waitcnt vmcnt(0)
  v_cmp_gt_u32 vcc, 23, v13
  s_cbranch_vccz L155
  s_sub_u32 s7, s7, 1
  s_cbranch_scc0 L156
  s_endpgm
L_ce:
  s_endpgm
.section .rodata,"a"
.p2align 6
.amdhsa_kernel interleave_layers__sliding_block__mixer_channel_mlp__prompt_kernel
  .amdhsa_next_free_vgpr 512
  .amdhsa_next_free_sgpr 102
  .amdhsa_accum_offset 256
  .amdhsa_group_segment_fixed_size 0
  .amdhsa_kernarg_size 88
  .amdhsa_user_sgpr_count 2
  .amdhsa_user_sgpr_kernarg_segment_ptr 1
  .amdhsa_system_sgpr_workgroup_id_x 1
.end_amdhsa_kernel
```
